```python
import torch

def _softmax(x, axis=-1):
    return torch.softmax(x, dim=axis)
def _gelu(x):
    return torch.nn.functional.gelu(x, approximate="tanh")
def _silu(x):
    return torch.nn.functional.silu(x)
def _sigmoid(x):
    return torch.sigmoid(x)
def _layernorm(x, axis=-1, eps=1e-5):
    m = x.mean(dim=axis, keepdim=True)
    v = x.var(dim=axis, keepdim=True, unbiased=False)
    return (x - m) / torch.sqrt(v + eps)
def _scatter_add(tgt, idx, src, axis=0):
    return tgt.clone().index_add_(axis, idx, src)
def _segment_sum(src, seg, n):
    out = torch.zeros((n,) + src.shape[1:], dtype=src.dtype)
    return out.index_add_(0, seg, src)
def _pad(x, pw):
    flat = tuple(v for pair in reversed(pw) for v in pair)
    return torch.nn.functional.pad(x, flat)

kernel_name = 'standalone__dense_activation_silu__prompt'

def setup_inputs():

    _w = (lambda a: (lambda t: t.to(torch.bfloat16) if t.is_floating_point() else t)(torch.as_tensor(a)))
    B, S, D, F = 1, 2048, 1024, 3584
    return {
        "x": _w((lambda *s: torch.randn(*s, dtype=torch.bfloat16) * 0.1)(B, S, D)),
        "w1": _w((lambda *s: torch.randn(*s, dtype=torch.bfloat16) * 3.2)(D, F) * (D ** -0.5)),
        "w2": _w((lambda *s: torch.randn(*s, dtype=torch.bfloat16) * 3.2)(F, D) * (F ** -0.5)),
    }

def reference(x, w1, w2):
    h = torch.einsum("bsd,df->bsf", x, w1)
    h = _silu(h)
    out = torch.einsum("bsf,fd->bsd", h, w2)
    return out
```

```asm
; @launch grid=(256,1,1) block=(256,1,1) lds=163840
.amdgcn_target "amdgcn-amd-amdhsa--gfx950"
.text
.globl standalone__dense_activation_silu__prompt_kernel
.p2align 8
.type standalone__dense_activation_silu__prompt_kernel,@function
standalone__dense_activation_silu__prompt_kernel:
s_cmp_ge_u32 s2, 256
s_cbranch_scc1 L_exit
s_load_dwordx4 s[4:7], s[0:1], 0
s_load_dwordx4 s[8:11], s[0:1], 16
s_load_dwordx4 s[12:15], s[0:1], 32
v_lshrrev_b32 v1, 6, v0
s_and_b32 s46, s2, 7
v_readfirstlane_b32 s36, v1
s_lshr_b32 s47, s2, 3
s_lshr_b32 s101, s46, 1
s_lshl_b32 s37, s101, 2
s_lshr_b32 s48, s47, 3
s_add_u32 s37, s37, s48
s_and_b32 s42, s46, 1
s_lshl_b32 s38, s42, 3
s_and_b32 s55, s47, 7
s_add_u32 s38, s38, s55
s_mov_b32 s43, 0
s_add_u32 s43, s43, s55
s_and_b32 s49, s101, 0
s_add_u32 s43, s43, s49
s_and_b32 s43, s43, 7
v_and_b32 v0, 63, v0
s_add_u32 s39, s55, s48
s_and_b32 s39, s39, 1
s_lshl_b32 s39, s39, 1
s_add_u32 s49, s101, s42
s_and_b32 s49, s49, 1
s_add_u32 s39, s39, s49
s_lshl_b32 s39, s39, 2
s_and_b32 s49, s101, 2
s_add_u32 s39, s39, s49
s_and_b32 s50, s38, 1
s_mul_i32 s51, s38, 448
s_lshl_b32 s49, s50, 6
s_sub_u32 s51, s51, s49
s_lshl_b32 s49, s50, 8
s_add_u32 s58, s51, s49
s_sub_u32 s59, s51, s49
s_add_u32 s59, s59, 256
v_lshrrev_b32 v3, 4, v0
v_bfe_u32 v4, v0, 1, 3
v_and_b32 v5, 1, v0
v_lshlrev_b32 v5, 4, v5
s_mul_i32 s47, s36, 114688
v_mul_u32_u24 v8, 7168, v3
v_add3_u32 v8, v8, v5, s47
v_xor_b32 v6, v4, v3
v_lshl_add_u32 v192, v6, 5, v8
v_add_u32 v193, 27648, v192
v_xor_b32 v6, 4, v6
v_lshl_add_u32 v6, v6, 5, v8
v_add_u32 v194, 55296, v6
v_add_u32 v195, 82944, v6
v_lshrrev_b32 v3, 3, v0
v_and_b32 v4, 7, v0
v_lshrrev_b32 v5, 1, v3
v_xor_b32 v6, v4, v5
s_lshl_b32 s46, s37, 2
s_add_u32 s46, s46, s36
s_lshl_b32 s47, s46, 16
v_lshl_add_u32 v3, v3, 11, s47
v_lshl_add_u32 v188, v6, 4, v3
v_add_u32 v190, 30720, v188
v_xor_b32 v6, 4, v6
v_lshl_add_u32 v6, v6, 4, v3
v_add_u32 v189, 15360, v6
v_add_u32 v191, 46080, v6
s_lshl_b32 s44, s36, 12
s_mul_i32 s45, s36, 20480
s_add_u32 s45, s45, 81920
s_lshl_b32 s40, s39, 7
s_waitcnt lgkmcnt(0)
s_add_u32 s20, s6, s58
s_addc_u32 s21, s7, 0
s_and_b32 s21, s21, 0xffff
s_sub_u32 s22, 7340032, s58
s_mov_b32 s23, 0x20000
s_mov_b32 s16, s4
s_and_b32 s17, s5, 0xffff
s_mov_b32 s18, 4194304
s_mov_b32 s19, 0x20000
s_add_u32 m0, s44, 0
s_mul_i32 s41, s40, 3584
buffer_load_dwordx4 v192, s[20:23], s41 offen offset:0  lds
buffer_load_dwordx4 v193, s[20:23], s41 offen offset:1024  lds
buffer_load_dwordx4 v194, s[20:23], s41 offen offset:2048  lds
buffer_load_dwordx4 v195, s[20:23], s41 offen offset:3072  lds
s_add_u32 m0, s45, 0
s_add_u32 s3, s40, 128
buffer_load_dwordx4 v188, s[16:19], s40 offen offset:0  lds
buffer_load_dwordx4 v189, s[16:19], s40 offen offset:1024  lds
buffer_load_dwordx4 v190, s[16:19], s40 offen offset:2048  lds
buffer_load_dwordx4 v191, s[16:19], s40 offen offset:3072  lds
s_and_b32 s3, s3, 2047
s_getpc_b64 s[46:47]
L_pf:
v_min_u32 v1, 3, v0
s_lshr_b32 s48, s2, 3
s_lshl_b32 s48, s48, 2
s_add_u32 s48, s48, s36
s_lshl_b32 s48, s48, 9
v_lshl_add_u32 v1, v1, 7, s48
s_mov_b32 s48, L_end-L_pf
v_min_u32 v9, s48, v1
global_load_dword v2, v9, s[46:47]
v_lshrrev_b32 v10, 4, v0
v_bfe_u32 v11, v0, 2, 2
v_and_b32 v12, 3, v0
v_lshl_add_u32 v13, v10, 3, v11
v_lshlrev_b32 v13, 8, v13
v_lshl_add_u32 v13, v12, 3, v13
v_and_b32 v14, 1, v10
v_lshl_add_u32 v14, v14, 2, v11
s_lshr_b32 s51, s101, 1
s_and_b32 s51, s51, 0
s_lshl_b32 s46, s51, 2
v_xor_b32 v7, s46, v14
v_xor_b32 v8, 0, v7
v_lshl_add_u32 v160, v8, 5, v13
v_xor_b32 v8, 1, v7
v_lshl_add_u32 v161, v8, 5, v13
v_xor_b32 v8, 2, v7
v_lshl_add_u32 v162, v8, 5, v13
v_xor_b32 v8, 3, v7
v_lshl_add_u32 v163, v8, 5, v13
v_xor_b32 v8, 4, v7
v_lshl_add_u32 v164, v8, 5, v13
v_xor_b32 v8, 5, v7
v_lshl_add_u32 v165, v8, 5, v13
v_xor_b32 v8, 6, v7
v_lshl_add_u32 v166, v8, 5, v13
v_xor_b32 v8, 7, v7
v_lshl_add_u32 v167, v8, 5, v13
v_and_b32 v4, 15, v0
v_lshrrev_b32 v5, 1, v4
v_xor_b32 v5, v5, v10
v_lshl_add_u32 v4, v4, 7, s45
v_lshl_add_u32 v196, v5, 4, v4
v_xor_b32 v5, 4, v5
v_lshl_add_u32 v197, v5, 4, v4
s_add_u32 m0, s44, 16384
s_mul_i32 s41, s3, 3584
buffer_load_dwordx4 v192, s[20:23], s41 offen offset:0  lds
v_add_u32 v168, 0x10000, v160
v_add_u32 v169, 0x10000, v161
v_add_u32 v170, 0x10000, v162
v_add_u32 v171, 0x10000, v163
v_add_u32 v172, 0x10000, v164
v_add_u32 v173, 0x10000, v165
v_add_u32 v174, 0x10000, v166
v_add_u32 v175, 0x10000, v167
s_mov_b32 s32, s14
s_and_b32 s33, s15, 0xffff
s_mov_b32 s34, 67108864
s_mov_b32 s35, 0x20000
s_add_u32 s24, s6, s59
s_addc_u32 s25, s7, 0
s_and_b32 s25, s25, 0xffff
s_sub_u32 s26, 7340032, s59
buffer_load_dwordx4 v193, s[20:23], s41 offen offset:1024  lds
s_mov_b32 s27, 0x20000
s_mov_b32 s28, s10
s_and_b32 s29, s11, 0xffff
s_mov_b32 s30, 4194304
s_mov_b32 s31, 0x20000
s_lshl_b32 s46, s43, 8
s_lshl_b32 s47, s42, 7
s_add_u32 s48, s46, s47
s_xor_b32 s47, s47, 128
s_add_u32 s47, s46, s47
s_add_u32 s92, s8, s47
s_addc_u32 s93, s9, 0
s_and_b32 s93, s93, 0xffff
s_sub_u32 s94, 7340032, s47
s_mov_b32 s95, 0x20000
s_add_u32 s96, s8, s48
s_addc_u32 s97, s9, 0
buffer_load_dwordx4 v194, s[20:23], s41 offen offset:2048  lds
s_and_b32 s97, s97, 0xffff
s_sub_u32 s98, 7340032, s48
s_mov_b32 s99, 0x20000
s_lshr_b32 s46, s2, 6
s_lshl_b32 s46, s46, 3
s_and_b32 s39, s2, 7
s_add_u32 s46, s46, s39
s_mul_i32 s46, s46, 6
s_add_u32 s46, s46, s43
s_cmp_gt_u32 s43, 1
s_subb_u32 s46, s46, 0
s_cmp_gt_u32 s43, 5
s_subb_u32 s46, s46, 0
s_lshl_b32 s46, s46, 2
s_add_u32 s46, s46, s36
s_mul_i32 s53, s46, 43
v_min_u32 v4, 42, v0
buffer_load_dwordx4 v195, s[20:23], s41 offen offset:3072  lds
v_add_u32 v4, s53, v4
v_lshrrev_b32 v5, 10, v4
v_and_b32 v4, 1023, v4
v_lshrrev_b32 v6, 2, v5
v_mul_u32_u24 v6, 3, v6
v_add_u32 v6, v6, v5
v_bfe_u32 v5, v5, 1, 1
v_mul_u32_u24 v5, 3, v5
v_add_u32 v6, v6, v5
v_lshl_add_u32 v4, v6, 10, v4
v_lshlrev_b32 v4, 7, v4
v_subrev_u32 v245, s47, v4
s_mul_i32 s39, s46, 32
s_and_b32 s46, s43, 3
s_cmp_eq_u32 s46, 1
s_cselect_b32 s46, 0x10000, s39
v_min_u32 v4, 31, v0
s_add_u32 m0, s45, 4096
s_add_u32 s40, s3, 128
buffer_load_dwordx4 v188, s[16:19], s3 offen offset:0  lds
v_add_u32 v4, s46, v4
v_lshrrev_b32 v5, 10, v4
v_and_b32 v4, 1023, v4
v_mul_u32_u24 v6, 171, v5
v_lshrrev_b32 v6, 9, v6
v_lshl_add_u32 v6, v6, 2, v5
v_add_u32 v6, 2, v6
v_lshl_add_u32 v4, v6, 10, v4
v_lshlrev_b32 v4, 7, v4
v_subrev_u32 v244, s47, v4
s_mul_i32 s46, s37, 10923
s_lshr_b32 s46, s46, 16
s_mul_i32 s46, s46, 6
s_sub_u32 s39, s37, s46
s_and_b32 s46, s43, 3
s_cmp_eq_u32 s46, 1
s_cselect_b32 s39, 99, s39
buffer_load_dwordx4 v189, s[16:19], s3 offen offset:1024  lds
v_and_b32 v4, 15, v0
v_lshlrev_b32 v4, 11, v4
v_and_b32 v5, 1, v10
v_lshl_add_u32 v4, v5, 5, v4
v_lshrrev_b32 v5, 1, v10
v_lshl_add_u32 v4, v5, 4, v4
s_lshl_b32 s46, s37, 2
s_add_u32 s46, s46, s36
s_lshl_b32 s47, s46, 16
s_add_u32 s47, s47, s48
v_add_u32 v238, s47, v4
s_mul_i32 s49, s46, 458752
v_lshrrev_b32 v4, 3, v0
s_lshl_b32 s46, s36, 1
v_add_u32 v4, s46, v4
buffer_load_dwordx4 v190, s[16:19], s3 offen offset:2048  lds
v_and_b32 v6, 7, v0
v_lshl_add_u32 v6, v6, 4, s49
v_subrev_u32 v5, 14, v4
v_min_u32 v5, v5, v4
v_cmp_le_u32 vcc, 10, v5
s_nop 1
v_addc_co_u32 v7, vcc, 0, v5, vcc
v_cmp_le_u32 vcc, 3, v5
s_nop 1
v_addc_co_u32 v7, vcc, 0, v7, vcc
v_lshl_add_u32 v7, v7, 7, v6
v_add_u32 v198, 0, v7
v_add_u32 v248, 4096, v198
v_add_u32 v4, 8, v4
v_subrev_u32 v5, 14, v4
v_min_u32 v5, v5, v4
v_cmp_le_u32 vcc, 10, v5
s_nop 1
v_addc_co_u32 v7, vcc, 0, v5, vcc
v_cmp_le_u32 vcc, 3, v5
s_nop 1
v_addc_co_u32 v7, vcc, 0, v7, vcc
v_lshl_add_u32 v7, v7, 7, v6
buffer_load_dwordx4 v191, s[16:19], s3 offen offset:3072  lds
v_add_u32 v239, 2048, v7
v_add_u32 v249, 4096, v239
s_mov_b32 s4, s12
s_and_b32 s5, s13, 0xffff
s_mov_b32 s6, 256
s_mov_b32 s7, 0x20000
s_lshl_b32 s46, s37, 1
s_add_u32 s46, s46, s42
s_lshl_b32 s46, s46, 8
s_add_u32 s46, s46, 50331648
v_mov_b32 v5, s46
s_cmp_eq_u32 s36, 0
s_cselect_b32 s8, s46, 117440512
s_add_u32 s9, s8, 8192
s_lshl_b32 s46, s2, 8
s_lshl_b32 s47, s36, 3
s_and_b32 s40, s40, 2047
s_branch L_body
L_exit:
s_endpgm
.p2align 12
L_body:
s_waitcnt vmcnt(9)
s_barrier
ds_read_b128 a[0:3], v196 offset:0
ds_read_b128 a[4:7], v196 offset:2048
ds_read_b128 a[8:11], v197 offset:0
ds_read_b128 a[12:15], v197 offset:2048
ds_read_b64_tr_b16 v[128:129], v160 offset:0
ds_read_b64_tr_b16 v[130:131], v160 offset:1024
ds_read_b64_tr_b16 v[132:133], v161 offset:0
ds_read_b64_tr_b16 v[134:135], v161 offset:1024
ds_read_b64_tr_b16 v[136:137], v162 offset:0
ds_read_b64_tr_b16 v[138:139], v162 offset:1024
ds_read_b64_tr_b16 v[140:141], v163 offset:0
ds_read_b64_tr_b16 v[142:143], v163 offset:1024
ds_read_b64_tr_b16 v[144:145], v164 offset:0
ds_read_b64_tr_b16 v[146:147], v164 offset:1024
ds_read_b64_tr_b16 v[148:149], v165 offset:0
ds_read_b64_tr_b16 v[150:151], v165 offset:1024
ds_read_b64_tr_b16 v[152:153], v166 offset:0
ds_read_b64_tr_b16 v[154:155], v166 offset:1024
ds_read_b64_tr_b16 v[156:157], v167 offset:0
ds_read_b64_tr_b16 v[158:159], v167 offset:1024
s_waitcnt lgkmcnt(8)
v_mfma_f32_16x16x32_bf16 v[16:19], v[128:131], a[0:3], 0
s_add_u32 s46, s46, s47
s_add_u32 s10, s46, 50348032
s_xor_b32 s13, s2, 1
s_lshl_b32 s46, s13, 8
s_add_u32 s46, s46, s47
s_add_u32 s11, s46, 50348032
v_and_b32 v4, 1, v0
v_lshl_add_u32 v5, v4, 13, v5
v_writelane_b32 v5, s10, 2
v_writelane_b32 v5, s10, 3
v_mfma_f32_16x16x32_bf16 v[20:23], v[128:131], a[4:7], 0
buffer_load_dword v2, v5, s[32:35], 0 offen
s_lshl_b32 s12, s2, 16
s_lshl_b32 s13, s13, 16
s_lshl_b32 s46, s36, 14
s_add_u32 s46, s46, 33554432
s_sub_u32 s46, s46, s49
s_add_u32 s12, s12, s46
s_add_u32 s13, s13, s46
s_add_u32 s14, s12, 8192
s_add_u32 s15, s13, 8192
v_and_b32 v4, 7, v0
v_lshlrev_b32 v199, 3, v4
v_mov_b32 v246, 0
s_lshl_b32 s46, s55, 3
v_mov_b32 v5, s46
v_mfma_f32_16x16x32_bf16 v[24:27], v[132:135], a[0:3], 0
v_mov_b32 v4, 117440512
v_cmp_eq_u32 vcc, 0, v0
s_nop 1
v_cndmask_b32 v1, v4, v5, vcc
v_cndmask_b32 v247, v4, v246, vcc
s_lshl_b32 s46, s50, 2
s_add_u32 s47, s46, 0
v_xor_b32 v8, s47, v14
v_lshl_add_u32 v176, v8, 5, v13
v_add_u32 v182, 0x10000, v176
s_add_u32 s47, s46, 1
v_xor_b32 v8, s47, v14
v_lshl_add_u32 v177, v8, 5, v13
v_mfma_f32_16x16x32_bf16 v[28:31], v[132:135], a[4:7], 0
v_add_u32 v183, 0x10000, v177
s_add_u32 s47, s46, 2
v_xor_b32 v8, s47, v14
v_lshl_add_u32 v178, v8, 5, v13
v_add_u32 v184, 0x10000, v178
s_add_u32 s47, s46, 3
v_xor_b32 v8, s47, v14
v_lshl_add_u32 v179, v8, 5, v13
v_add_u32 v185, 0x10000, v179
s_mul_i32 s46, s50, -2
s_add_u32 s47, s46, 4
v_xor_b32 v8, s47, v14
v_mfma_f32_16x16x32_bf16 v[32:35], v[136:139], a[0:3], 0
s_add_u32 m0, s44, 32768
s_mul_i32 s41, s40, 3584
buffer_load_dwordx4 v192, s[20:23], s41 offen offset:0  lds
v_lshl_add_u32 v180, v8, 5, v13
v_add_u32 v186, 0x10000, v180
s_add_u32 s47, s46, 5
v_xor_b32 v8, s47, v14
v_lshl_add_u32 v181, v8, 5, v13
v_add_u32 v187, 0x10000, v181
v_lshl_add_u32 v6, v10, 2, v11
v_bfe_u32 v7, v6, 1, 2
v_lshlrev_b32 v6, 7, v6
v_lshl_add_u32 v6, v12, 3, v6
v_xor_b32 v8, 0, v7
v_lshl_add_u32 v224, v8, 5, v6
v_add_u32 v228, 0x10000, v224
v_mfma_f32_16x16x32_bf16 v[36:39], v[136:139], a[4:7], 0
buffer_load_dwordx4 v193, s[20:23], s41 offen offset:1024  lds
v_add_u32 v232, 0x20000, v224
v_xor_b32 v8, 1, v7
v_lshl_add_u32 v225, v8, 5, v6
v_add_u32 v229, 0x10000, v225
v_add_u32 v233, 0x20000, v225
v_xor_b32 v8, 2, v7
v_lshl_add_u32 v226, v8, 5, v6
v_add_u32 v230, 0x10000, v226
v_add_u32 v234, 0x20000, v226
v_xor_b32 v8, 3, v7
v_lshl_add_u32 v227, v8, 5, v6
v_add_u32 v231, 0x10000, v227
v_add_u32 v235, 0x20000, v227
v_mfma_f32_16x16x32_bf16 v[40:43], v[140:143], a[0:3], 0
buffer_load_dwordx4 v194, s[20:23], s41 offen offset:2048  lds
buffer_load_dwordx4 v195, s[20:23], s41 offen offset:3072  lds
s_add_u32 m0, s45, 8192
s_add_u32 s3, s40, 128
v_lshrrev_b32 v3, 3, v0
v_bfe_u32 v4, v0, 1, 2
v_lshrrev_b32 v5, 1, v3
v_xor_b32 v4, v4, v5
v_and_b32 v5, 1, v0
v_lshlrev_b32 v5, 4, v5
v_lshl_add_u32 v4, v4, 5, v5
v_lshl_add_u32 v4, v3, 11, v4
s_lshl_b32 s46, s36, 15
v_add_u32 v236, s46, v4
v_add_u32 v237, 15360, v236
s_lshl_b32 s62, s36, 11
v_mfma_f32_16x16x32_bf16 v[44:47], v[140:143], a[4:7], 0
s_mul_i32 s46, s38, 7
s_mul_i32 s47, s50, 3
s_add_u32 s47, s47, s46
s_lshl_b32 s47, s47, 12
s_lshl_b32 s48, s51, 13
s_add_u32 s58, s47, s48
s_sub_u32 s59, s47, s48
s_add_u32 s59, s59, 8192
s_lshl_b32 s47, s50, 2
s_sub_u32 s47, s46, s47
s_add_u32 s47, s47, 4
s_lshl_b32 s47, s47, 12
s_lshl_b32 s48, s50, 12
s_waitcnt lgkmcnt(0)
v_mfma_f32_16x16x32_bf16 v[48:51], v[144:147], a[0:3], 0
buffer_load_dwordx4 v188, s[16:19], s40 offen offset:0  lds
s_add_u32 s60, s47, s48
s_lshl_b32 s48, s48, 1
s_sub_u32 s61, s47, s48
s_add_u32 s61, s61, 8192
s_mov_b32 s56, 0xbfb8aa3b
s_mov_b32 s57, 32768
v_lshrrev_b32 v3, 1, v0
s_and_b32 s46, s43, 3
s_cmp_eq_u32 s46, 1
s_cselect_b32 s100, s37, 0
s_and_b32 s100, s100, 3
s_lshl_b32 s46, s100, 1
v_add_u32 v5, s46, v3
v_mfma_f32_16x16x32_bf16 v[52:55], v[144:147], a[4:7], 0
buffer_load_dwordx4 v189, s[16:19], s40 offen offset:1024  lds
ds_read_b64_tr_b16 v[128:129], v160 offset:8192
ds_read_b64_tr_b16 v[130:131], v160 offset:9216
ds_read_b64_tr_b16 v[132:133], v161 offset:8192
ds_read_b64_tr_b16 v[134:135], v161 offset:9216
ds_read_b64_tr_b16 v[136:137], v162 offset:8192
ds_read_b64_tr_b16 v[138:139], v162 offset:9216
ds_read_b64_tr_b16 v[140:141], v163 offset:8192
ds_read_b64_tr_b16 v[142:143], v163 offset:9216
v_subrev_u32 v5, 1, v5
v_subrev_u32 v6, 7, v5
v_min_u32 v5, v5, v6
v_cmp_le_u32 vcc, s55, v5
s_nop 1
v_addc_co_u32 v5, vcc, 0, v5, vcc
v_mov_b32 v6, s55
v_cmp_eq_u32 vcc, 0, v3
s_nop 1
v_cndmask_b32 v3, v5, v6, vcc
v_and_b32 v3, 7, v3
v_lshrrev_b32 v4, 1, v3
v_mfma_f32_16x16x32_bf16 v[56:59], v[148:151], a[0:3], 0
buffer_load_dwordx4 v190, s[16:19], s40 offen offset:2048  lds
buffer_load_dwordx4 v191, s[16:19], s40 offen offset:3072  lds
s_and_b32 s3, s3, 2047
s_add_u32 m0, s44, 49152
s_mul_i32 s41, s3, 3584
v_mul_u32_u24 v4, 7, v4
v_and_b32 v3, 1, v3
v_mul_u32_u24 v3, 5, v3
v_add_u32 v4, v4, v3
v_xor_b32 v3, s51, v0
v_and_b32 v3, 1, v3
v_add_u32 v4, v4, v3
v_subrev_u32 v3, 16, v0
v_and_b32 v3, 63, v3
v_mul_u32_u24 v5, 171, v3
v_lshrrev_b32 v5, 9, v5
v_mul_u32_u24 v6, 3, v5
v_sub_u32 v3, v3, v6
v_mfma_f32_16x16x32_bf16 v[60:63], v[148:151], a[4:7], 0
s_lshr_b32 s47, s55, 1
s_and_b32 s46, s100, 3
s_add_u32 s46, s46, 2
v_add_u32 v6, s46, v5
v_subrev_u32 v7, 3, v6
v_min_u32 v6, v6, v7
v_subrev_u32 v7, 3, v6
v_min_u32 v6, v6, v7
v_cmp_le_u32 vcc, s47, v6
s_nop 1
v_addc_co_u32 v6, vcc, 0, v6, vcc
v_sub_u32 v7, 2, v3
s_cmp_eq_u32 s50, 1
s_cselect_b64 vcc, -1, 0
v_cndmask_b32 v7, v3, v7, vcc
v_mfma_f32_16x16x32_bf16 v[64:67], v[152:155], a[0:3], 0
buffer_load_dwordx4 v192, s[20:23], s41 offen offset:0  lds
v_mov_b32 v8, s47
v_cmp_eq_u32 vcc, 0, v5
s_nop 1
v_cndmask_b32 v5, v6, v8, vcc
v_cndmask_b32 v3, v3, v7, vcc
v_mul_u32_u24 v5, 7, v5
v_add3_u32 v5, v5, v3, 2
s_mul_i32 s46, s42, 28
v_cmp_gt_u32 vcc, 16, v0
s_nop 1
v_cndmask_b32 v4, v5, v4, vcc
v_mfma_f32_16x16x32_bf16 v[68:71], v[152:155], a[4:7], 0
buffer_load_dwordx4 v193, s[20:23], s41 offen offset:1024  lds
v_add_u32 v4, s46, v4
v_lshlrev_b32 v4, 13, v4
s_nop 0
v_readlane_b32 s64, v4, 0
v_readlane_b32 s65, v4, 1
v_readlane_b32 s66, v4, 2
v_readlane_b32 s67, v4, 3
v_readlane_b32 s68, v4, 4
v_readlane_b32 s69, v4, 5
v_readlane_b32 s70, v4, 6
v_readlane_b32 s71, v4, 7
v_readlane_b32 s72, v4, 8
v_mfma_f32_16x16x32_bf16 v[72:75], v[156:159], a[0:3], 0
buffer_load_dwordx4 v194, s[20:23], s41 offen offset:2048  lds
buffer_load_dwordx4 v195, s[20:23], s41 offen offset:3072  lds
s_add_u32 m0, s45, 12288
s_add_u32 s40, s3, 128
v_readlane_b32 s73, v4, 9
v_readlane_b32 s74, v4, 10
v_readlane_b32 s75, v4, 11
v_readlane_b32 s76, v4, 12
v_readlane_b32 s77, v4, 13
v_readlane_b32 s78, v4, 14
v_readlane_b32 s79, v4, 15
v_readlane_b32 s80, v4, 16
v_readlane_b32 s81, v4, 17
v_readlane_b32 s82, v4, 18
v_readlane_b32 s83, v4, 19
v_readlane_b32 s84, v4, 20
v_readlane_b32 s85, v4, 21
s_mov_b64 exec, 0
s_cmp_eq_u32 s36, 2
s_cbranch_scc1 L_pg6
s_cmp_eq_u32 s36, 1
s_cbranch_scc1 L_pg3
s_branch L_pg0
L_pg_ret:
s_mov_b64 exec, -1
v_mfma_f32_16x16x32_bf16 v[76:79], v[156:159], a[4:7], 0
v_readlane_b32 s86, v4, 22
v_readlane_b32 s87, v4, 23
v_readlane_b32 s88, v4, 24
v_readlane_b32 s89, v4, 25
v_readlane_b32 s90, v4, 26
v_readlane_b32 s91, v4, 27
s_mov_b32 s37, 0x10000
s_cmp_lt_u32 s36, 2
s_cselect_b32 s37, s37, 0xffff0000
s_mul_i32 s37, s37, s50
s_lshl_b32 s46, s50, 12
s_sub_u32 s38, s81, s46
s_waitcnt lgkmcnt(0)
v_mfma_f32_16x16x32_bf16 v[16:19], v[128:131], a[8:11], v[16:19]
buffer_load_dwordx4 v188, s[16:19], s3 offen offset:0  lds
buffer_load_dwordx4 v189, s[16:19], s3 offen offset:1024  lds
buffer_load_dwordx4 v190, s[16:19], s3 offen offset:2048  lds
buffer_load_dwordx4 v191, s[16:19], s3 offen offset:3072  lds
s_and_b32 s40, s40, 2047
v_mfma_f32_16x16x32_bf16 v[20:23], v[128:131], a[12:15], v[20:23]
s_waitcnt vmcnt(17)
s_barrier
ds_read_b64_tr_b16 v[144:145], v164 offset:8192
ds_read_b64_tr_b16 v[146:147], v164 offset:9216
ds_read_b64_tr_b16 v[148:149], v165 offset:8192
ds_read_b64_tr_b16 v[150:151], v165 offset:9216
ds_read_b64_tr_b16 v[152:153], v166 offset:8192
ds_read_b64_tr_b16 v[154:155], v166 offset:9216
ds_read_b64_tr_b16 v[156:157], v167 offset:8192
ds_read_b64_tr_b16 v[158:159], v167 offset:9216
v_mfma_f32_16x16x32_bf16 v[24:27], v[132:135], a[8:11], v[24:27]
ds_read_b64_tr_b16 v[128:129], v160 offset:16384
ds_read_b64_tr_b16 v[130:131], v160 offset:17408
v_mfma_f32_16x16x32_bf16 v[28:31], v[132:135], a[12:15], v[28:31]
ds_read_b64_tr_b16 v[132:133], v161 offset:16384
s_add_u32 m0, s44, 65536
v_mfma_f32_16x16x32_bf16 v[32:35], v[136:139], a[8:11], v[32:35]
ds_read_b128 a[16:19], v196 offset:4096
v_mfma_f32_16x16x32_bf16 v[36:39], v[136:139], a[12:15], v[36:39]
s_mul_i32 s41, s40, 3584
buffer_load_dwordx4 v192, s[20:23], s41 offen offset:0  lds
v_mfma_f32_16x16x32_bf16 v[40:43], v[140:143], a[8:11], v[40:43]
ds_read_b64_tr_b16 v[134:135], v161 offset:17408
ds_read_b64_tr_b16 v[136:137], v162 offset:16384
v_mfma_f32_16x16x32_bf16 v[44:47], v[140:143], a[12:15], v[44:47]
ds_read_b64_tr_b16 v[138:139], v162 offset:17408
s_waitcnt lgkmcnt(7)
v_mfma_f32_16x16x32_bf16 v[48:51], v[144:147], a[8:11], v[48:51]
buffer_load_dwordx4 v193, s[20:23], s41 offen offset:1024  lds
v_mfma_f32_16x16x32_bf16 v[52:55], v[144:147], a[12:15], v[52:55]
ds_read_b128 a[20:23], v196 offset:6144
ds_read_b64_tr_b16 v[140:141], v163 offset:16384
ds_read_b64_tr_b16 v[142:143], v163 offset:17408
v_mfma_f32_16x16x32_bf16 v[56:59], v[148:151], a[8:11], v[56:59]
buffer_load_dwordx4 v194, s[20:23], s41 offen offset:2048  lds
v_mfma_f32_16x16x32_bf16 v[60:63], v[148:151], a[12:15], v[60:63]
ds_read_b64_tr_b16 v[144:145], v164 offset:16384
ds_read_b64_tr_b16 v[146:147], v164 offset:17408
v_mfma_f32_16x16x32_bf16 v[64:67], v[152:155], a[8:11], v[64:67]
ds_read_b64_tr_b16 v[148:149], v165 offset:16384
ds_read_b64_tr_b16 v[150:151], v165 offset:17408
v_mfma_f32_16x16x32_bf16 v[68:71], v[152:155], a[12:15], v[68:71]
buffer_load_dwordx4 v195, s[20:23], s41 offen offset:3072  lds
v_mfma_f32_16x16x32_bf16 v[72:75], v[156:159], a[8:11], v[72:75]
ds_read_b64_tr_b16 v[152:153], v166 offset:16384
ds_read_b64_tr_b16 v[154:155], v166 offset:17408
v_mfma_f32_16x16x32_bf16 v[76:79], v[156:159], a[12:15], v[76:79]
ds_read_b64_tr_b16 v[156:157], v167 offset:16384
s_waitcnt lgkmcnt(7)
v_mfma_f32_16x16x32_bf16 v[16:19], v[128:131], a[16:19], v[16:19]
ds_read_b128 a[24:27], v197 offset:4096
v_mfma_f32_16x16x32_bf16 v[20:23], v[128:131], a[20:23], v[20:23]
ds_read_b64_tr_b16 v[158:159], v167 offset:17408
ds_read_b64_tr_b16 v[128:129], v160 offset:24576
v_mfma_f32_16x16x32_bf16 v[24:27], v[132:135], a[16:19], v[24:27]
s_add_u32 m0, s45, 16384
s_add_u32 s3, s40, 128
v_mfma_f32_16x16x32_bf16 v[28:31], v[132:135], a[20:23], v[28:31]
buffer_load_dwordx4 v188, s[16:19], s40 offen offset:0  lds
v_mfma_f32_16x16x32_bf16 v[32:35], v[136:139], a[16:19], v[32:35]
ds_read_b128 a[28:31], v197 offset:6144
v_mfma_f32_16x16x32_bf16 v[36:39], v[136:139], a[20:23], v[36:39]
buffer_load_dwordx4 v189, s[16:19], s40 offen offset:1024  lds
v_mfma_f32_16x16x32_bf16 v[40:43], v[140:143], a[16:19], v[40:43]
ds_read_b64_tr_b16 v[130:131], v160 offset:25600
ds_read_b64_tr_b16 v[132:133], v161 offset:24576
v_mfma_f32_16x16x32_bf16 v[44:47], v[140:143], a[20:23], v[44:47]
ds_read_b64_tr_b16 v[134:135], v161 offset:25600
s_waitcnt lgkmcnt(5)
v_mfma_f32_16x16x32_bf16 v[48:51], v[144:147], a[16:19], v[48:51]
ds_read_b64_tr_b16 v[136:137], v162 offset:24576
ds_read_b64_tr_b16 v[138:139], v162 offset:25600
v_mfma_f32_16x16x32_bf16 v[52:55], v[144:147], a[20:23], v[52:55]
ds_read_b64_tr_b16 v[140:141], v163 offset:24576
ds_read_b64_tr_b16 v[142:143], v163 offset:25600
v_mfma_f32_16x16x32_bf16 v[56:59], v[148:151], a[16:19], v[56:59]
buffer_load_dwordx4 v190, s[16:19], s40 offen offset:2048  lds
v_mfma_f32_16x16x32_bf16 v[60:63], v[148:151], a[20:23], v[60:63]
ds_read_b64_tr_b16 v[144:145], v164 offset:24576
ds_read_b64_tr_b16 v[146:147], v164 offset:25600
v_mfma_f32_16x16x32_bf16 v[64:67], v[152:155], a[16:19], v[64:67]
ds_read_b64_tr_b16 v[148:149], v165 offset:24576
ds_read_b64_tr_b16 v[150:151], v165 offset:25600
v_mfma_f32_16x16x32_bf16 v[68:71], v[152:155], a[20:23], v[68:71]
buffer_load_dwordx4 v191, s[16:19], s40 offen offset:3072  lds
v_mfma_f32_16x16x32_bf16 v[72:75], v[156:159], a[16:19], v[72:75]
ds_read_b64_tr_b16 v[152:153], v166 offset:24576
ds_read_b64_tr_b16 v[154:155], v166 offset:25600
v_mfma_f32_16x16x32_bf16 v[76:79], v[156:159], a[20:23], v[76:79]
ds_read_b64_tr_b16 v[156:157], v167 offset:24576
s_waitcnt lgkmcnt(7)
v_mfma_f32_16x16x32_bf16 v[16:19], v[128:131], a[24:27], v[16:19]
s_and_b32 s3, s3, 2047
ds_read_b64_tr_b16 v[158:159], v167 offset:25600
v_mfma_f32_16x16x32_bf16 v[20:23], v[128:131], a[28:31], v[20:23]
s_waitcnt vmcnt(16)
s_barrier
s_or_b32 s46, s2, s36
s_cbranch_scc0 L_mk0
L_mk_done:
v_mfma_f32_16x16x32_bf16 v[24:27], v[132:135], a[24:27], v[24:27]
ds_read_b64_tr_b16 v[128:129], v160 offset:32768
ds_read_b64_tr_b16 v[130:131], v160 offset:33792
v_mfma_f32_16x16x32_bf16 v[28:31], v[132:135], a[28:31], v[28:31]
ds_read_b64_tr_b16 v[132:133], v161 offset:32768
s_add_u32 m0, s44, 0
v_mfma_f32_16x16x32_bf16 v[32:35], v[136:139], a[24:27], v[32:35]
ds_read_b128 a[32:35], v196 offset:8192
v_mfma_f32_16x16x32_bf16 v[36:39], v[136:139], a[28:31], v[36:39]
s_mul_i32 s41, s3, 3584
buffer_load_dwordx4 v192, s[20:23], s41 offen offset:0  lds
v_mfma_f32_16x16x32_bf16 v[40:43], v[140:143], a[24:27], v[40:43]
ds_read_b64_tr_b16 v[134:135], v161 offset:33792
ds_read_b64_tr_b16 v[136:137], v162 offset:32768
v_mfma_f32_16x16x32_bf16 v[44:47], v[140:143], a[28:31], v[44:47]
s_cmp_eq_u32 s39, 0
s_cbranch_scc1 L_t0
L_t0_ok:
s_waitcnt lgkmcnt(6)
v_mfma_f32_16x16x32_bf16 v[48:51], v[144:147], a[24:27], v[48:51]
buffer_load_dwordx4 v193, s[20:23], s41 offen offset:1024  lds
v_mfma_f32_16x16x32_bf16 v[52:55], v[144:147], a[28:31], v[52:55]
ds_read_b128 a[36:39], v196 offset:10240
ds_read_b64_tr_b16 v[138:139], v162 offset:33792
ds_read_b64_tr_b16 v[140:141], v163 offset:32768
ds_read_b64_tr_b16 v[142:143], v163 offset:33792
v_mfma_f32_16x16x32_bf16 v[56:59], v[148:151], a[24:27], v[56:59]
buffer_load_dwordx4 v194, s[20:23], s41 offen offset:2048  lds
v_mfma_f32_16x16x32_bf16 v[60:63], v[148:151], a[28:31], v[60:63]
ds_read_b64_tr_b16 v[144:145], v164 offset:32768
ds_read_b64_tr_b16 v[146:147], v164 offset:33792
v_mfma_f32_16x16x32_bf16 v[64:67], v[152:155], a[24:27], v[64:67]
ds_read_b64_tr_b16 v[148:149], v165 offset:32768
ds_read_b64_tr_b16 v[150:151], v165 offset:33792
v_mfma_f32_16x16x32_bf16 v[68:71], v[152:155], a[28:31], v[68:71]
buffer_load_dwordx4 v195, s[20:23], s41 offen offset:3072  lds
v_mfma_f32_16x16x32_bf16 v[72:75], v[156:159], a[24:27], v[72:75]
ds_read_b64_tr_b16 v[152:153], v166 offset:32768
ds_read_b64_tr_b16 v[154:155], v166 offset:33792
v_mfma_f32_16x16x32_bf16 v[76:79], v[156:159], a[28:31], v[76:79]
ds_read_b64_tr_b16 v[156:157], v167 offset:32768
s_waitcnt lgkmcnt(7)
v_mfma_f32_16x16x32_bf16 v[16:19], v[128:131], a[32:35], v[16:19]
ds_read_b128 a[40:43], v197 offset:8192
v_mfma_f32_16x16x32_bf16 v[20:23], v[128:131], a[36:39], v[20:23]
ds_read_b64_tr_b16 v[158:159], v167 offset:33792
ds_read_b64_tr_b16 v[128:129], v160 offset:40960
v_mfma_f32_16x16x32_bf16 v[24:27], v[132:135], a[32:35], v[24:27]
s_add_u32 m0, s45, 0
s_add_u32 s40, s3, 128
v_mfma_f32_16x16x32_bf16 v[28:31], v[132:135], a[36:39], v[28:31]
buffer_load_dwordx4 v188, s[16:19], s3 offen offset:0  lds
v_mfma_f32_16x16x32_bf16 v[32:35], v[136:139], a[32:35], v[32:35]
ds_read_b128 a[44:47], v197 offset:10240
v_mfma_f32_16x16x32_bf16 v[36:39], v[136:139], a[36:39], v[36:39]
buffer_load_dwordx4 v189, s[16:19], s3 offen offset:1024  lds
v_mfma_f32_16x16x32_bf16 v[40:43], v[140:143], a[32:35], v[40:43]
ds_read_b64_tr_b16 v[130:131], v160 offset:41984
ds_read_b64_tr_b16 v[132:133], v161 offset:40960
v_mfma_f32_16x16x32_bf16 v[44:47], v[140:143], a[36:39], v[44:47]
ds_read_b64_tr_b16 v[134:135], v161 offset:41984
s_waitcnt lgkmcnt(5)
v_mfma_f32_16x16x32_bf16 v[48:51], v[144:147], a[32:35], v[48:51]
ds_read_b64_tr_b16 v[136:137], v162 offset:40960
ds_read_b64_tr_b16 v[138:139], v162 offset:41984
v_mfma_f32_16x16x32_bf16 v[52:55], v[144:147], a[36:39], v[52:55]
ds_read_b64_tr_b16 v[140:141], v163 offset:40960
ds_read_b64_tr_b16 v[142:143], v163 offset:41984
v_mfma_f32_16x16x32_bf16 v[56:59], v[148:151], a[32:35], v[56:59]
buffer_load_dwordx4 v190, s[16:19], s3 offen offset:2048  lds
v_mfma_f32_16x16x32_bf16 v[60:63], v[148:151], a[36:39], v[60:63]
ds_read_b64_tr_b16 v[144:145], v164 offset:40960
ds_read_b64_tr_b16 v[146:147], v164 offset:41984
v_mfma_f32_16x16x32_bf16 v[64:67], v[152:155], a[32:35], v[64:67]
ds_read_b64_tr_b16 v[148:149], v165 offset:40960
ds_read_b64_tr_b16 v[150:151], v165 offset:41984
v_mfma_f32_16x16x32_bf16 v[68:71], v[152:155], a[36:39], v[68:71]
buffer_load_dwordx4 v191, s[16:19], s3 offen offset:3072  lds
v_mfma_f32_16x16x32_bf16 v[72:75], v[156:159], a[32:35], v[72:75]
ds_read_b64_tr_b16 v[152:153], v166 offset:40960
ds_read_b64_tr_b16 v[154:155], v166 offset:41984
v_mfma_f32_16x16x32_bf16 v[76:79], v[156:159], a[36:39], v[76:79]
ds_read_b64_tr_b16 v[156:157], v167 offset:40960
s_waitcnt lgkmcnt(7)
v_mfma_f32_16x16x32_bf16 v[16:19], v[128:131], a[40:43], v[16:19]
s_and_b32 s40, s40, 2047
ds_read_b64_tr_b16 v[158:159], v167 offset:41984
v_mfma_f32_16x16x32_bf16 v[20:23], v[128:131], a[44:47], v[20:23]
s_waitcnt vmcnt(16)
s_barrier
v_mfma_f32_16x16x32_bf16 v[24:27], v[132:135], a[40:43], v[24:27]
ds_read_b64_tr_b16 v[128:129], v160 offset:49152
ds_read_b64_tr_b16 v[130:131], v160 offset:50176
v_mfma_f32_16x16x32_bf16 v[28:31], v[132:135], a[44:47], v[28:31]
ds_read_b64_tr_b16 v[132:133], v161 offset:49152
s_add_u32 m0, s44, 16384
v_mfma_f32_16x16x32_bf16 v[32:35], v[136:139], a[40:43], v[32:35]
ds_read_b128 a[48:51], v196 offset:12288
v_mfma_f32_16x16x32_bf16 v[36:39], v[136:139], a[44:47], v[36:39]
s_mul_i32 s41, s40, 3584
buffer_load_dwordx4 v192, s[20:23], s41 offen offset:0  lds
v_mfma_f32_16x16x32_bf16 v[40:43], v[140:143], a[40:43], v[40:43]
ds_read_b64_tr_b16 v[134:135], v161 offset:50176
ds_read_b64_tr_b16 v[136:137], v162 offset:49152
v_mfma_f32_16x16x32_bf16 v[44:47], v[140:143], a[44:47], v[44:47]
s_cmp_eq_u32 s39, 1
s_cbranch_scc1 L_t1
L_t1_ok:
s_waitcnt lgkmcnt(6)
v_mfma_f32_16x16x32_bf16 v[48:51], v[144:147], a[40:43], v[48:51]
buffer_load_dwordx4 v193, s[20:23], s41 offen offset:1024  lds
v_mfma_f32_16x16x32_bf16 v[52:55], v[144:147], a[44:47], v[52:55]
ds_read_b128 a[52:55], v196 offset:14336
ds_read_b64_tr_b16 v[138:139], v162 offset:50176
ds_read_b64_tr_b16 v[140:141], v163 offset:49152
ds_read_b64_tr_b16 v[142:143], v163 offset:50176
v_mfma_f32_16x16x32_bf16 v[56:59], v[148:151], a[40:43], v[56:59]
buffer_load_dwordx4 v194, s[20:23], s41 offen offset:2048  lds
v_mfma_f32_16x16x32_bf16 v[60:63], v[148:151], a[44:47], v[60:63]
ds_read_b64_tr_b16 v[144:145], v164 offset:49152
ds_read_b64_tr_b16 v[146:147], v164 offset:50176
v_mfma_f32_16x16x32_bf16 v[64:67], v[152:155], a[40:43], v[64:67]
ds_read_b64_tr_b16 v[148:149], v165 offset:49152
ds_read_b64_tr_b16 v[150:151], v165 offset:50176
v_mfma_f32_16x16x32_bf16 v[68:71], v[152:155], a[44:47], v[68:71]
buffer_load_dwordx4 v195, s[20:23], s41 offen offset:3072  lds
v_mfma_f32_16x16x32_bf16 v[72:75], v[156:159], a[40:43], v[72:75]
ds_read_b64_tr_b16 v[152:153], v166 offset:49152
ds_read_b64_tr_b16 v[154:155], v166 offset:50176
v_mfma_f32_16x16x32_bf16 v[76:79], v[156:159], a[44:47], v[76:79]
ds_read_b64_tr_b16 v[156:157], v167 offset:49152
s_waitcnt lgkmcnt(7)
v_mfma_f32_16x16x32_bf16 v[16:19], v[128:131], a[48:51], v[16:19]
ds_read_b128 a[56:59], v197 offset:12288
v_mfma_f32_16x16x32_bf16 v[20:23], v[128:131], a[52:55], v[20:23]
ds_read_b64_tr_b16 v[158:159], v167 offset:50176
ds_read_b64_tr_b16 v[128:129], v160 offset:57344
v_mfma_f32_16x16x32_bf16 v[24:27], v[132:135], a[48:51], v[24:27]
s_add_u32 m0, s45, 4096
s_add_u32 s3, s40, 128
v_mfma_f32_16x16x32_bf16 v[28:31], v[132:135], a[52:55], v[28:31]
buffer_load_dwordx4 v188, s[16:19], s40 offen offset:0  lds
v_mfma_f32_16x16x32_bf16 v[32:35], v[136:139], a[48:51], v[32:35]
ds_read_b128 a[60:63], v197 offset:14336
v_mfma_f32_16x16x32_bf16 v[36:39], v[136:139], a[52:55], v[36:39]
buffer_load_dwordx4 v189, s[16:19], s40 offen offset:1024  lds
v_mfma_f32_16x16x32_bf16 v[40:43], v[140:143], a[48:51], v[40:43]
ds_read_b64_tr_b16 v[130:131], v160 offset:58368
ds_read_b64_tr_b16 v[132:133], v161 offset:57344
v_mfma_f32_16x16x32_bf16 v[44:47], v[140:143], a[52:55], v[44:47]
ds_read_b64_tr_b16 v[134:135], v161 offset:58368
s_waitcnt lgkmcnt(5)
v_mfma_f32_16x16x32_bf16 v[48:51], v[144:147], a[48:51], v[48:51]
ds_read_b64_tr_b16 v[136:137], v162 offset:57344
ds_read_b64_tr_b16 v[138:139], v162 offset:58368
v_mfma_f32_16x16x32_bf16 v[52:55], v[144:147], a[52:55], v[52:55]
ds_read_b64_tr_b16 v[140:141], v163 offset:57344
ds_read_b64_tr_b16 v[142:143], v163 offset:58368
v_mfma_f32_16x16x32_bf16 v[56:59], v[148:151], a[48:51], v[56:59]
buffer_load_dwordx4 v190, s[16:19], s40 offen offset:2048  lds
v_mfma_f32_16x16x32_bf16 v[60:63], v[148:151], a[52:55], v[60:63]
ds_read_b64_tr_b16 v[144:145], v164 offset:57344
ds_read_b64_tr_b16 v[146:147], v164 offset:58368
v_mfma_f32_16x16x32_bf16 v[64:67], v[152:155], a[48:51], v[64:67]
ds_read_b64_tr_b16 v[148:149], v165 offset:57344
ds_read_b64_tr_b16 v[150:151], v165 offset:58368
v_mfma_f32_16x16x32_bf16 v[68:71], v[152:155], a[52:55], v[68:71]
buffer_load_dwordx4 v191, s[16:19], s40 offen offset:3072  lds
v_mfma_f32_16x16x32_bf16 v[72:75], v[156:159], a[48:51], v[72:75]
ds_read_b64_tr_b16 v[152:153], v166 offset:57344
ds_read_b64_tr_b16 v[154:155], v166 offset:58368
v_mfma_f32_16x16x32_bf16 v[76:79], v[156:159], a[52:55], v[76:79]
ds_read_b64_tr_b16 v[156:157], v167 offset:57344
s_waitcnt lgkmcnt(7)
v_mfma_f32_16x16x32_bf16 v[16:19], v[128:131], a[56:59], v[16:19]
s_and_b32 s3, s3, 2047
ds_read_b64_tr_b16 v[158:159], v167 offset:58368
v_mfma_f32_16x16x32_bf16 v[20:23], v[128:131], a[60:63], v[20:23]
s_waitcnt vmcnt(16)
s_barrier
v_mfma_f32_16x16x32_bf16 v[24:27], v[132:135], a[56:59], v[24:27]
ds_read_b64_tr_b16 v[128:129], v168 offset:0
ds_read_b64_tr_b16 v[130:131], v168 offset:1024
v_mfma_f32_16x16x32_bf16 v[28:31], v[132:135], a[60:63], v[28:31]
ds_read_b64_tr_b16 v[132:133], v169 offset:0
s_add_u32 m0, s44, 32768
v_mfma_f32_16x16x32_bf16 v[32:35], v[136:139], a[56:59], v[32:35]
ds_read_b128 a[64:67], v196 offset:16384
v_mfma_f32_16x16x32_bf16 v[36:39], v[136:139], a[60:63], v[36:39]
s_mul_i32 s41, s3, 3584
buffer_load_dwordx4 v192, s[20:23], s41 offen offset:0  lds
v_mfma_f32_16x16x32_bf16 v[40:43], v[140:143], a[56:59], v[40:43]
ds_read_b64_tr_b16 v[134:135], v169 offset:1024
ds_read_b64_tr_b16 v[136:137], v170 offset:0
v_mfma_f32_16x16x32_bf16 v[44:47], v[140:143], a[60:63], v[44:47]
s_cmp_eq_u32 s39, 2
s_cbranch_scc1 L_t2
L_t2_ok:
s_waitcnt lgkmcnt(6)
v_mfma_f32_16x16x32_bf16 v[48:51], v[144:147], a[56:59], v[48:51]
buffer_load_dwordx4 v193, s[20:23], s41 offen offset:1024  lds
v_mfma_f32_16x16x32_bf16 v[52:55], v[144:147], a[60:63], v[52:55]
ds_read_b128 a[68:71], v196 offset:18432
ds_read_b64_tr_b16 v[138:139], v170 offset:1024
ds_read_b64_tr_b16 v[140:141], v171 offset:0
ds_read_b64_tr_b16 v[142:143], v171 offset:1024
v_mfma_f32_16x16x32_bf16 v[56:59], v[148:151], a[56:59], v[56:59]
buffer_load_dwordx4 v194, s[20:23], s41 offen offset:2048  lds
v_mfma_f32_16x16x32_bf16 v[60:63], v[148:151], a[60:63], v[60:63]
ds_read_b64_tr_b16 v[144:145], v172 offset:0
ds_read_b64_tr_b16 v[146:147], v172 offset:1024
v_mfma_f32_16x16x32_bf16 v[64:67], v[152:155], a[56:59], v[64:67]
ds_read_b64_tr_b16 v[148:149], v173 offset:0
ds_read_b64_tr_b16 v[150:151], v173 offset:1024
v_mfma_f32_16x16x32_bf16 v[68:71], v[152:155], a[60:63], v[68:71]
L_pg0:
s_cbranch_execz L_pg1
ds_read_b64_tr_b16 v[152:153], v174 offset:0
v_mfma_f32_16x16x32_bf16 v[72:75], v[156:159], a[56:59], v[72:75]
buffer_load_dwordx4 v195, s[20:23], s41 offen offset:3072  lds
v_mfma_f32_16x16x32_bf16 v[76:79], v[156:159], a[60:63], v[76:79]
ds_read_b64_tr_b16 v[154:155], v174 offset:1024
s_waitcnt lgkmcnt(6)
v_mfma_f32_16x16x32_bf16 v[16:19], v[128:131], a[64:67], v[16:19]
ds_read_b128 a[72:75], v197 offset:16384
v_mfma_f32_16x16x32_bf16 v[20:23], v[128:131], a[68:71], v[20:23]
ds_read_b64_tr_b16 v[156:157], v175 offset:0
ds_read_b64_tr_b16 v[158:159], v175 offset:1024
v_mfma_f32_16x16x32_bf16 v[24:27], v[132:135], a[64:67], v[24:27]
s_add_u32 m0, s45, 8192
s_add_u32 s40, s3, 128
v_mfma_f32_16x16x32_bf16 v[28:31], v[132:135], a[68:71], v[28:31]
buffer_load_dwordx4 v188, s[16:19], s3 offen offset:0  lds
v_mfma_f32_16x16x32_bf16 v[32:35], v[136:139], a[64:67], v[32:35]
ds_read_b128 a[76:79], v197 offset:18432
v_mfma_f32_16x16x32_bf16 v[36:39], v[136:139], a[68:71], v[36:39]
buffer_load_dwordx4 v189, s[16:19], s3 offen offset:1024  lds
v_mfma_f32_16x16x32_bf16 v[40:43], v[140:143], a[64:67], v[40:43]
ds_read_b64_tr_b16 v[128:129], v168 offset:8192
ds_read_b64_tr_b16 v[130:131], v168 offset:9216
v_mfma_f32_16x16x32_bf16 v[44:47], v[140:143], a[68:71], v[44:47]
ds_read_b64_tr_b16 v[132:133], v169 offset:8192
s_waitcnt lgkmcnt(4)
v_mfma_f32_16x16x32_bf16 v[48:51], v[144:147], a[64:67], v[48:51]
ds_read_b64_tr_b16 v[134:135], v169 offset:9216
ds_read_b64_tr_b16 v[136:137], v170 offset:8192
v_mfma_f32_16x16x32_bf16 v[52:55], v[144:147], a[68:71], v[52:55]
ds_read_b64_tr_b16 v[138:139], v170 offset:9216
ds_read_b64_tr_b16 v[140:141], v171 offset:8192
ds_read_b64_tr_b16 v[142:143], v171 offset:9216
v_mfma_f32_16x16x32_bf16 v[56:59], v[148:151], a[64:67], v[56:59]
buffer_load_dwordx4 v190, s[16:19], s3 offen offset:2048  lds
v_mfma_f32_16x16x32_bf16 v[60:63], v[148:151], a[68:71], v[60:63]
ds_read_b64_tr_b16 v[144:145], v172 offset:8192
ds_read_b64_tr_b16 v[146:147], v172 offset:9216
v_mfma_f32_16x16x32_bf16 v[64:67], v[152:155], a[64:67], v[64:67]
ds_read_b64_tr_b16 v[148:149], v173 offset:8192
ds_read_b64_tr_b16 v[150:151], v173 offset:9216
v_mfma_f32_16x16x32_bf16 v[68:71], v[152:155], a[68:71], v[68:71]
buffer_load_dwordx4 v191, s[16:19], s3 offen offset:3072  lds
v_mfma_f32_16x16x32_bf16 v[72:75], v[156:159], a[64:67], v[72:75]
ds_read_b64_tr_b16 v[152:153], v174 offset:8192
ds_read_b64_tr_b16 v[154:155], v174 offset:9216
v_mfma_f32_16x16x32_bf16 v[76:79], v[156:159], a[68:71], v[76:79]
ds_read_b64_tr_b16 v[156:157], v175 offset:8192
s_waitcnt lgkmcnt(7)
v_mfma_f32_16x16x32_bf16 v[16:19], v[128:131], a[72:75], v[16:19]
s_and_b32 s40, s40, 2047
ds_read_b64_tr_b16 v[158:159], v175 offset:9216
v_mfma_f32_16x16x32_bf16 v[20:23], v[128:131], a[76:79], v[20:23]
s_waitcnt vmcnt(16)
s_barrier
v_mfma_f32_16x16x32_bf16 v[24:27], v[132:135], a[72:75], v[24:27]
ds_read_b64_tr_b16 v[128:129], v160 offset:0
ds_read_b64_tr_b16 v[130:131], v160 offset:1024
v_mfma_f32_16x16x32_bf16 v[28:31], v[132:135], a[76:79], v[28:31]
ds_read_b64_tr_b16 v[132:133], v161 offset:0
s_add_u32 m0, s44, 49152
v_mfma_f32_16x16x32_bf16 v[32:35], v[136:139], a[72:75], v[32:35]
ds_read_b128 a[80:83], v196 offset:0
v_mfma_f32_16x16x32_bf16 v[36:39], v[136:139], a[76:79], v[36:39]
s_mul_i32 s41, s40, 3584
buffer_load_dwordx4 v192, s[20:23], s41 offen offset:0  lds
v_mfma_f32_16x16x32_bf16 v[40:43], v[140:143], a[72:75], v[40:43]
ds_read_b64_tr_b16 v[134:135], v161 offset:1024
ds_read_b64_tr_b16 v[136:137], v162 offset:0
v_mfma_f32_16x16x32_bf16 v[44:47], v[140:143], a[76:79], v[44:47]
s_cmp_eq_u32 s39, 3
s_cbranch_scc1 L_t3
L_t3_ok:
s_waitcnt lgkmcnt(6)
v_mfma_f32_16x16x32_bf16 v[48:51], v[144:147], a[72:75], v[48:51]
buffer_load_dwordx4 v193, s[20:23], s41 offen offset:1024  lds
v_mfma_f32_16x16x32_bf16 v[52:55], v[144:147], a[76:79], v[52:55]
ds_read_b128 a[84:87], v196 offset:2048
ds_read_b64_tr_b16 v[138:139], v162 offset:1024
ds_read_b64_tr_b16 v[140:141], v163 offset:0
ds_read_b64_tr_b16 v[142:143], v163 offset:1024
v_mfma_f32_16x16x32_bf16 v[56:59], v[148:151], a[72:75], v[56:59]
buffer_load_dwordx4 v194, s[20:23], s41 offen offset:2048  lds
v_mfma_f32_16x16x32_bf16 v[60:63], v[148:151], a[76:79], v[60:63]
ds_read_b64_tr_b16 v[144:145], v164 offset:0
ds_read_b64_tr_b16 v[146:147], v164 offset:1024
v_mfma_f32_16x16x32_bf16 v[64:67], v[152:155], a[72:75], v[64:67]
ds_read_b64_tr_b16 v[148:149], v165 offset:0
ds_read_b64_tr_b16 v[150:151], v165 offset:1024
v_mfma_f32_16x16x32_bf16 v[68:71], v[152:155], a[76:79], v[68:71]
buffer_load_dwordx4 v195, s[20:23], s41 offen offset:3072  lds
v_mfma_f32_16x16x32_bf16 v[72:75], v[156:159], a[72:75], v[72:75]
ds_read_b64_tr_b16 v[152:153], v166 offset:0
ds_read_b64_tr_b16 v[154:155], v166 offset:1024
v_mfma_f32_16x16x32_bf16 v[76:79], v[156:159], a[76:79], v[76:79]
ds_read_b64_tr_b16 v[156:157], v167 offset:0
s_waitcnt lgkmcnt(7)
v_mfma_f32_16x16x32_bf16 v[16:19], v[128:131], a[80:83], v[16:19]
ds_read_b128 a[88:91], v197 offset:0
v_mfma_f32_16x16x32_bf16 v[20:23], v[128:131], a[84:87], v[20:23]
ds_read_b64_tr_b16 v[158:159], v167 offset:1024
ds_read_b64_tr_b16 v[128:129], v160 offset:8192
v_mfma_f32_16x16x32_bf16 v[24:27], v[132:135], a[80:83], v[24:27]
s_add_u32 m0, s45, 12288
s_add_u32 s3, s40, 128
v_mfma_f32_16x16x32_bf16 v[28:31], v[132:135], a[84:87], v[28:31]
buffer_load_dwordx4 v188, s[16:19], s40 offen offset:0  lds
v_mfma_f32_16x16x32_bf16 v[32:35], v[136:139], a[80:83], v[32:35]
ds_read_b128 a[92:95], v197 offset:2048
v_mfma_f32_16x16x32_bf16 v[36:39], v[136:139], a[84:87], v[36:39]
buffer_load_dwordx4 v189, s[16:19], s40 offen offset:1024  lds
v_mfma_f32_16x16x32_bf16 v[40:43], v[140:143], a[80:83], v[40:43]
ds_read_b64_tr_b16 v[130:131], v160 offset:9216
ds_read_b64_tr_b16 v[132:133], v161 offset:8192
v_mfma_f32_16x16x32_bf16 v[44:47], v[140:143], a[84:87], v[44:47]
ds_read_b64_tr_b16 v[134:135], v161 offset:9216
s_waitcnt lgkmcnt(5)
v_mfma_f32_16x16x32_bf16 v[48:51], v[144:147], a[80:83], v[48:51]
ds_read_b64_tr_b16 v[136:137], v162 offset:8192
ds_read_b64_tr_b16 v[138:139], v162 offset:9216
v_mfma_f32_16x16x32_bf16 v[52:55], v[144:147], a[84:87], v[52:55]
ds_read_b64_tr_b16 v[140:141], v163 offset:8192
ds_read_b64_tr_b16 v[142:143], v163 offset:9216
v_mfma_f32_16x16x32_bf16 v[56:59], v[148:151], a[80:83], v[56:59]
buffer_load_dwordx4 v190, s[16:19], s40 offen offset:2048  lds
v_mfma_f32_16x16x32_bf16 v[60:63], v[148:151], a[84:87], v[60:63]
ds_read_b64_tr_b16 v[144:145], v164 offset:8192
ds_read_b64_tr_b16 v[146:147], v164 offset:9216
v_mfma_f32_16x16x32_bf16 v[64:67], v[152:155], a[80:83], v[64:67]
ds_read_b64_tr_b16 v[148:149], v165 offset:8192
ds_read_b64_tr_b16 v[150:151], v165 offset:9216
v_mfma_f32_16x16x32_bf16 v[68:71], v[152:155], a[84:87], v[68:71]
buffer_load_dwordx4 v191, s[16:19], s40 offen offset:3072  lds
v_mfma_f32_16x16x32_bf16 v[72:75], v[156:159], a[80:83], v[72:75]
ds_read_b64_tr_b16 v[152:153], v166 offset:8192
ds_read_b64_tr_b16 v[154:155], v166 offset:9216
v_mfma_f32_16x16x32_bf16 v[76:79], v[156:159], a[84:87], v[76:79]
ds_read_b64_tr_b16 v[156:157], v167 offset:8192
s_waitcnt lgkmcnt(7)
v_mfma_f32_16x16x32_bf16 v[16:19], v[128:131], a[88:91], v[16:19]
s_and_b32 s3, s3, 2047
ds_read_b64_tr_b16 v[158:159], v167 offset:9216
v_mfma_f32_16x16x32_bf16 v[20:23], v[128:131], a[92:95], v[20:23]
s_waitcnt vmcnt(16)
s_barrier
v_mfma_f32_16x16x32_bf16 v[24:27], v[132:135], a[88:91], v[24:27]
ds_read_b64_tr_b16 v[128:129], v160 offset:16384
ds_read_b64_tr_b16 v[130:131], v160 offset:17408
v_mfma_f32_16x16x32_bf16 v[28:31], v[132:135], a[92:95], v[28:31]
ds_read_b64_tr_b16 v[132:133], v161 offset:16384
s_add_u32 m0, s44, 65536
v_mfma_f32_16x16x32_bf16 v[32:35], v[136:139], a[88:91], v[32:35]
ds_read_b128 a[96:99], v196 offset:4096
v_mfma_f32_16x16x32_bf16 v[36:39], v[136:139], a[92:95], v[36:39]
s_mul_i32 s41, s3, 3584
buffer_load_dwordx4 v192, s[20:23], s41 offen offset:0  lds
v_mfma_f32_16x16x32_bf16 v[40:43], v[140:143], a[88:91], v[40:43]
ds_read_b64_tr_b16 v[134:135], v161 offset:17408
ds_read_b64_tr_b16 v[136:137], v162 offset:16384
v_mfma_f32_16x16x32_bf16 v[44:47], v[140:143], a[92:95], v[44:47]
s_cmp_eq_u32 s39, 4
s_cbranch_scc1 L_t4
L_t4_ok:
s_waitcnt lgkmcnt(6)
v_mfma_f32_16x16x32_bf16 v[48:51], v[144:147], a[88:91], v[48:51]
buffer_load_dwordx4 v193, s[20:23], s41 offen offset:1024  lds
v_mfma_f32_16x16x32_bf16 v[52:55], v[144:147], a[92:95], v[52:55]
ds_read_b128 a[100:103], v196 offset:6144
ds_read_b64_tr_b16 v[138:139], v162 offset:17408
ds_read_b64_tr_b16 v[140:141], v163 offset:16384
ds_read_b64_tr_b16 v[142:143], v163 offset:17408
v_mfma_f32_16x16x32_bf16 v[56:59], v[148:151], a[88:91], v[56:59]
buffer_load_dwordx4 v194, s[20:23], s41 offen offset:2048  lds
v_mfma_f32_16x16x32_bf16 v[60:63], v[148:151], a[92:95], v[60:63]
ds_read_b64_tr_b16 v[144:145], v164 offset:16384
ds_read_b64_tr_b16 v[146:147], v164 offset:17408
v_mfma_f32_16x16x32_bf16 v[64:67], v[152:155], a[88:91], v[64:67]
ds_read_b64_tr_b16 v[148:149], v165 offset:16384
ds_read_b64_tr_b16 v[150:151], v165 offset:17408
v_mfma_f32_16x16x32_bf16 v[68:71], v[152:155], a[92:95], v[68:71]
buffer_load_dwordx4 v195, s[20:23], s41 offen offset:3072  lds
v_mfma_f32_16x16x32_bf16 v[72:75], v[156:159], a[88:91], v[72:75]
ds_read_b64_tr_b16 v[152:153], v166 offset:16384
ds_read_b64_tr_b16 v[154:155], v166 offset:17408
v_mfma_f32_16x16x32_bf16 v[76:79], v[156:159], a[92:95], v[76:79]
ds_read_b64_tr_b16 v[156:157], v167 offset:16384
s_waitcnt lgkmcnt(7)
v_mfma_f32_16x16x32_bf16 v[16:19], v[128:131], a[96:99], v[16:19]
ds_read_b128 a[104:107], v197 offset:4096
v_mfma_f32_16x16x32_bf16 v[20:23], v[128:131], a[100:103], v[20:23]
ds_read_b64_tr_b16 v[158:159], v167 offset:17408
ds_read_b64_tr_b16 v[128:129], v160 offset:24576
v_mfma_f32_16x16x32_bf16 v[24:27], v[132:135], a[96:99], v[24:27]
s_add_u32 m0, s45, 16384
s_add_u32 s40, s3, 128
v_mfma_f32_16x16x32_bf16 v[28:31], v[132:135], a[100:103], v[28:31]
buffer_load_dwordx4 v188, s[16:19], s3 offen offset:0  lds
v_mfma_f32_16x16x32_bf16 v[32:35], v[136:139], a[96:99], v[32:35]
ds_read_b128 a[108:111], v197 offset:6144
v_mfma_f32_16x16x32_bf16 v[36:39], v[136:139], a[100:103], v[36:39]
buffer_load_dwordx4 v189, s[16:19], s3 offen offset:1024  lds
v_mfma_f32_16x16x32_bf16 v[40:43], v[140:143], a[96:99], v[40:43]
ds_read_b64_tr_b16 v[130:131], v160 offset:25600
ds_read_b64_tr_b16 v[132:133], v161 offset:24576
v_mfma_f32_16x16x32_bf16 v[44:47], v[140:143], a[100:103], v[44:47]
ds_read_b64_tr_b16 v[134:135], v161 offset:25600
s_waitcnt lgkmcnt(5)
v_mfma_f32_16x16x32_bf16 v[48:51], v[144:147], a[96:99], v[48:51]
ds_read_b64_tr_b16 v[136:137], v162 offset:24576
ds_read_b64_tr_b16 v[138:139], v162 offset:25600
v_mfma_f32_16x16x32_bf16 v[52:55], v[144:147], a[100:103], v[52:55]
ds_read_b64_tr_b16 v[140:141], v163 offset:24576
ds_read_b64_tr_b16 v[142:143], v163 offset:25600
v_mfma_f32_16x16x32_bf16 v[56:59], v[148:151], a[96:99], v[56:59]
buffer_load_dwordx4 v190, s[16:19], s3 offen offset:2048  lds
v_mfma_f32_16x16x32_bf16 v[60:63], v[148:151], a[100:103], v[60:63]
ds_read_b64_tr_b16 v[144:145], v164 offset:24576
ds_read_b64_tr_b16 v[146:147], v164 offset:25600
v_mfma_f32_16x16x32_bf16 v[64:67], v[152:155], a[96:99], v[64:67]
ds_read_b64_tr_b16 v[148:149], v165 offset:24576
ds_read_b64_tr_b16 v[150:151], v165 offset:25600
v_mfma_f32_16x16x32_bf16 v[68:71], v[152:155], a[100:103], v[68:71]
buffer_load_dwordx4 v191, s[16:19], s3 offen offset:3072  lds
v_mfma_f32_16x16x32_bf16 v[72:75], v[156:159], a[96:99], v[72:75]
ds_read_b64_tr_b16 v[152:153], v166 offset:24576
ds_read_b64_tr_b16 v[154:155], v166 offset:25600
v_mfma_f32_16x16x32_bf16 v[76:79], v[156:159], a[100:103], v[76:79]
ds_read_b64_tr_b16 v[156:157], v167 offset:24576
s_waitcnt lgkmcnt(7)
v_mfma_f32_16x16x32_bf16 v[16:19], v[128:131], a[104:107], v[16:19]
s_and_b32 s40, s40, 2047
ds_read_b64_tr_b16 v[158:159], v167 offset:25600
v_mfma_f32_16x16x32_bf16 v[20:23], v[128:131], a[108:111], v[20:23]
s_waitcnt vmcnt(16)
s_barrier
v_mfma_f32_16x16x32_bf16 v[24:27], v[132:135], a[104:107], v[24:27]
ds_read_b64_tr_b16 v[128:129], v160 offset:32768
ds_read_b64_tr_b16 v[130:131], v160 offset:33792
v_mfma_f32_16x16x32_bf16 v[28:31], v[132:135], a[108:111], v[28:31]
ds_read_b64_tr_b16 v[132:133], v161 offset:32768
s_add_u32 m0, s44, 0
v_mfma_f32_16x16x32_bf16 v[32:35], v[136:139], a[104:107], v[32:35]
ds_read_b128 a[112:115], v196 offset:8192
v_mfma_f32_16x16x32_bf16 v[36:39], v[136:139], a[108:111], v[36:39]
s_mul_i32 s41, s40, 3584
buffer_load_dwordx4 v192, s[20:23], s41 offen offset:0  lds
v_mfma_f32_16x16x32_bf16 v[40:43], v[140:143], a[104:107], v[40:43]
ds_read_b64_tr_b16 v[134:135], v161 offset:33792
ds_read_b64_tr_b16 v[136:137], v162 offset:32768
v_mfma_f32_16x16x32_bf16 v[44:47], v[140:143], a[108:111], v[44:47]
s_cmp_eq_u32 s39, 5
s_cbranch_scc1 L_t5
L_t5_ok:
s_waitcnt lgkmcnt(6)
v_mfma_f32_16x16x32_bf16 v[48:51], v[144:147], a[104:107], v[48:51]
buffer_load_dwordx4 v193, s[20:23], s41 offen offset:1024  lds
v_mfma_f32_16x16x32_bf16 v[52:55], v[144:147], a[108:111], v[52:55]
ds_read_b128 a[116:119], v196 offset:10240
ds_read_b64_tr_b16 v[138:139], v162 offset:33792
ds_read_b64_tr_b16 v[140:141], v163 offset:32768
ds_read_b64_tr_b16 v[142:143], v163 offset:33792
v_mfma_f32_16x16x32_bf16 v[56:59], v[148:151], a[104:107], v[56:59]
buffer_load_dwordx4 v194, s[20:23], s41 offen offset:2048  lds
v_mfma_f32_16x16x32_bf16 v[60:63], v[148:151], a[108:111], v[60:63]
ds_read_b64_tr_b16 v[144:145], v164 offset:32768
ds_read_b64_tr_b16 v[146:147], v164 offset:33792
v_mfma_f32_16x16x32_bf16 v[64:67], v[152:155], a[104:107], v[64:67]
ds_read_b64_tr_b16 v[148:149], v165 offset:32768
ds_read_b64_tr_b16 v[150:151], v165 offset:33792
v_mfma_f32_16x16x32_bf16 v[68:71], v[152:155], a[108:111], v[68:71]
buffer_load_dwordx4 v195, s[20:23], s41 offen offset:3072  lds
v_mfma_f32_16x16x32_bf16 v[72:75], v[156:159], a[104:107], v[72:75]
ds_read_b64_tr_b16 v[152:153], v166 offset:32768
ds_read_b64_tr_b16 v[154:155], v166 offset:33792
v_mfma_f32_16x16x32_bf16 v[76:79], v[156:159], a[108:111], v[76:79]
ds_read_b64_tr_b16 v[156:157], v167 offset:32768
s_waitcnt lgkmcnt(7)
v_mfma_f32_16x16x32_bf16 v[16:19], v[128:131], a[112:115], v[16:19]
ds_read_b128 a[120:123], v197 offset:8192
v_mfma_f32_16x16x32_bf16 v[20:23], v[128:131], a[116:119], v[20:23]
ds_read_b64_tr_b16 v[158:159], v167 offset:33792
ds_read_b64_tr_b16 v[128:129], v160 offset:40960
v_mfma_f32_16x16x32_bf16 v[24:27], v[132:135], a[112:115], v[24:27]
s_add_u32 m0, s45, 0
s_add_u32 s3, s40, 128
v_mfma_f32_16x16x32_bf16 v[28:31], v[132:135], a[116:119], v[28:31]
buffer_load_dwordx4 v188, s[16:19], s40 offen offset:0  lds
v_mfma_f32_16x16x32_bf16 v[32:35], v[136:139], a[112:115], v[32:35]
ds_read_b128 a[124:127], v197 offset:10240
v_mfma_f32_16x16x32_bf16 v[36:39], v[136:139], a[116:119], v[36:39]
buffer_load_dwordx4 v189, s[16:19], s40 offen offset:1024  lds
v_mfma_f32_16x16x32_bf16 v[40:43], v[140:143], a[112:115], v[40:43]
ds_read_b64_tr_b16 v[130:131], v160 offset:41984
ds_read_b64_tr_b16 v[132:133], v161 offset:40960
v_mfma_f32_16x16x32_bf16 v[44:47], v[140:143], a[116:119], v[44:47]
ds_read_b64_tr_b16 v[134:135], v161 offset:41984
s_waitcnt lgkmcnt(5)
v_mfma_f32_16x16x32_bf16 v[48:51], v[144:147], a[112:115], v[48:51]
ds_read_b64_tr_b16 v[136:137], v162 offset:40960
ds_read_b64_tr_b16 v[138:139], v162 offset:41984
v_mfma_f32_16x16x32_bf16 v[52:55], v[144:147], a[116:119], v[52:55]
ds_read_b64_tr_b16 v[140:141], v163 offset:40960
ds_read_b64_tr_b16 v[142:143], v163 offset:41984
v_mfma_f32_16x16x32_bf16 v[56:59], v[148:151], a[112:115], v[56:59]
buffer_load_dwordx4 v190, s[16:19], s40 offen offset:2048  lds
v_mfma_f32_16x16x32_bf16 v[60:63], v[148:151], a[116:119], v[60:63]
ds_read_b64_tr_b16 v[144:145], v164 offset:40960
ds_read_b64_tr_b16 v[146:147], v164 offset:41984
v_mfma_f32_16x16x32_bf16 v[64:67], v[152:155], a[112:115], v[64:67]
ds_read_b64_tr_b16 v[148:149], v165 offset:40960
ds_read_b64_tr_b16 v[150:151], v165 offset:41984
v_mfma_f32_16x16x32_bf16 v[68:71], v[152:155], a[116:119], v[68:71]
buffer_load_dwordx4 v191, s[16:19], s40 offen offset:3072  lds
v_mfma_f32_16x16x32_bf16 v[72:75], v[156:159], a[112:115], v[72:75]
ds_read_b64_tr_b16 v[152:153], v166 offset:40960
ds_read_b64_tr_b16 v[154:155], v166 offset:41984
v_mfma_f32_16x16x32_bf16 v[76:79], v[156:159], a[116:119], v[76:79]
ds_read_b64_tr_b16 v[156:157], v167 offset:40960
s_waitcnt lgkmcnt(7)
v_mfma_f32_16x16x32_bf16 v[16:19], v[128:131], a[120:123], v[16:19]
s_and_b32 s3, s3, 2047
ds_read_b64_tr_b16 v[158:159], v167 offset:41984
v_mfma_f32_16x16x32_bf16 v[20:23], v[128:131], a[124:127], v[20:23]
s_waitcnt vmcnt(16)
s_barrier
v_mfma_f32_16x16x32_bf16 v[24:27], v[132:135], a[120:123], v[24:27]
ds_read_b64_tr_b16 v[128:129], v160 offset:49152
ds_read_b64_tr_b16 v[130:131], v160 offset:50176
v_mfma_f32_16x16x32_bf16 v[28:31], v[132:135], a[124:127], v[28:31]
ds_read_b64_tr_b16 v[132:133], v161 offset:49152
s_add_u32 m0, s44, 16384
v_mfma_f32_16x16x32_bf16 v[32:35], v[136:139], a[120:123], v[32:35]
ds_read_b128 a[128:131], v196 offset:12288
v_mfma_f32_16x16x32_bf16 v[36:39], v[136:139], a[124:127], v[36:39]
s_mul_i32 s41, s3, 3584
buffer_load_dwordx4 v192, s[20:23], s41 offen offset:0  lds
v_mfma_f32_16x16x32_bf16 v[40:43], v[140:143], a[120:123], v[40:43]
ds_read_b64_tr_b16 v[134:135], v161 offset:50176
ds_read_b64_tr_b16 v[136:137], v162 offset:49152
v_mfma_f32_16x16x32_bf16 v[44:47], v[140:143], a[124:127], v[44:47]
ds_read_b64_tr_b16 v[138:139], v162 offset:50176
s_waitcnt lgkmcnt(7)
v_mfma_f32_16x16x32_bf16 v[48:51], v[144:147], a[120:123], v[48:51]
buffer_load_dwordx4 v193, s[20:23], s41 offen offset:1024  lds
v_mfma_f32_16x16x32_bf16 v[52:55], v[144:147], a[124:127], v[52:55]
ds_read_b128 a[132:135], v196 offset:14336
ds_read_b64_tr_b16 v[140:141], v163 offset:49152
ds_read_b64_tr_b16 v[142:143], v163 offset:50176
v_mfma_f32_16x16x32_bf16 v[56:59], v[148:151], a[120:123], v[56:59]
buffer_load_dwordx4 v194, s[20:23], s41 offen offset:2048  lds
v_mfma_f32_16x16x32_bf16 v[60:63], v[148:151], a[124:127], v[60:63]
ds_read_b64_tr_b16 v[144:145], v164 offset:49152
ds_read_b64_tr_b16 v[146:147], v164 offset:50176
v_mfma_f32_16x16x32_bf16 v[64:67], v[152:155], a[120:123], v[64:67]
ds_read_b64_tr_b16 v[148:149], v165 offset:49152
ds_read_b64_tr_b16 v[150:151], v165 offset:50176
v_mfma_f32_16x16x32_bf16 v[68:71], v[152:155], a[124:127], v[68:71]
buffer_load_dwordx4 v195, s[20:23], s41 offen offset:3072  lds
v_mfma_f32_16x16x32_bf16 v[72:75], v[156:159], a[120:123], v[72:75]
ds_read_b64_tr_b16 v[152:153], v166 offset:49152
ds_read_b64_tr_b16 v[154:155], v166 offset:50176
v_mfma_f32_16x16x32_bf16 v[76:79], v[156:159], a[124:127], v[76:79]
ds_read_b64_tr_b16 v[156:157], v167 offset:49152
s_waitcnt lgkmcnt(7)
v_mfma_f32_16x16x32_bf16 v[16:19], v[128:131], a[128:131], v[16:19]
ds_read_b128 a[136:139], v197 offset:12288
v_mfma_f32_16x16x32_bf16 v[20:23], v[128:131], a[132:135], v[20:23]
ds_read_b64_tr_b16 v[158:159], v167 offset:50176
ds_read_b64_tr_b16 v[128:129], v160 offset:57344
v_mfma_f32_16x16x32_bf16 v[24:27], v[132:135], a[128:131], v[24:27]
s_add_u32 m0, s45, 4096
s_add_u32 s40, s3, 128
v_mfma_f32_16x16x32_bf16 v[28:31], v[132:135], a[132:135], v[28:31]
buffer_load_dwordx4 v188, s[16:19], s3 offen offset:0  lds
v_mfma_f32_16x16x32_bf16 v[32:35], v[136:139], a[128:131], v[32:35]
ds_read_b128 a[140:143], v197 offset:14336
v_mfma_f32_16x16x32_bf16 v[36:39], v[136:139], a[132:135], v[36:39]
buffer_load_dwordx4 v189, s[16:19], s3 offen offset:1024  lds
v_mfma_f32_16x16x32_bf16 v[40:43], v[140:143], a[128:131], v[40:43]
ds_read_b64_tr_b16 v[130:131], v160 offset:58368
ds_read_b64_tr_b16 v[132:133], v161 offset:57344
v_mfma_f32_16x16x32_bf16 v[44:47], v[140:143], a[132:135], v[44:47]
ds_read_b64_tr_b16 v[134:135], v161 offset:58368
s_waitcnt lgkmcnt(5)
v_mfma_f32_16x16x32_bf16 v[48:51], v[144:147], a[128:131], v[48:51]
ds_read_b64_tr_b16 v[136:137], v162 offset:57344
ds_read_b64_tr_b16 v[138:139], v162 offset:58368
v_mfma_f32_16x16x32_bf16 v[52:55], v[144:147], a[132:135], v[52:55]
ds_read_b64_tr_b16 v[140:141], v163 offset:57344
ds_read_b64_tr_b16 v[142:143], v163 offset:58368
v_mfma_f32_16x16x32_bf16 v[56:59], v[148:151], a[128:131], v[56:59]
buffer_load_dwordx4 v190, s[16:19], s3 offen offset:2048  lds
v_mfma_f32_16x16x32_bf16 v[60:63], v[148:151], a[132:135], v[60:63]
ds_read_b64_tr_b16 v[144:145], v164 offset:57344
ds_read_b64_tr_b16 v[146:147], v164 offset:58368
v_mfma_f32_16x16x32_bf16 v[64:67], v[152:155], a[128:131], v[64:67]
ds_read_b64_tr_b16 v[148:149], v165 offset:57344
ds_read_b64_tr_b16 v[150:151], v165 offset:58368
v_mfma_f32_16x16x32_bf16 v[68:71], v[152:155], a[132:135], v[68:71]
buffer_load_dwordx4 v191, s[16:19], s3 offen offset:3072  lds
v_mfma_f32_16x16x32_bf16 v[72:75], v[156:159], a[128:131], v[72:75]
ds_read_b64_tr_b16 v[152:153], v166 offset:57344
ds_read_b64_tr_b16 v[154:155], v166 offset:58368
v_mfma_f32_16x16x32_bf16 v[76:79], v[156:159], a[132:135], v[76:79]
ds_read_b64_tr_b16 v[156:157], v167 offset:57344
s_waitcnt lgkmcnt(7)
v_mfma_f32_16x16x32_bf16 v[16:19], v[128:131], a[136:139], v[16:19]
s_and_b32 s40, s40, 2047
ds_read_b64_tr_b16 v[158:159], v167 offset:58368
v_mfma_f32_16x16x32_bf16 v[20:23], v[128:131], a[140:143], v[20:23]
s_waitcnt vmcnt(16)
s_barrier
v_mfma_f32_16x16x32_bf16 v[24:27], v[132:135], a[136:139], v[24:27]
ds_read_b64_tr_b16 v[128:129], v168 offset:0
ds_read_b64_tr_b16 v[130:131], v168 offset:1024
v_mfma_f32_16x16x32_bf16 v[28:31], v[132:135], a[140:143], v[28:31]
ds_read_b64_tr_b16 v[132:133], v169 offset:0
s_add_u32 m0, s44, 32768
v_mfma_f32_16x16x32_bf16 v[32:35], v[136:139], a[136:139], v[32:35]
ds_read_b128 a[144:147], v196 offset:16384
v_mfma_f32_16x16x32_bf16 v[36:39], v[136:139], a[140:143], v[36:39]
s_mul_i32 s41, s40, 3584
buffer_load_dwordx4 v192, s[20:23], s41 offen offset:0  lds
v_mfma_f32_16x16x32_bf16 v[40:43], v[140:143], a[136:139], v[40:43]
ds_read_b64_tr_b16 v[134:135], v169 offset:1024
ds_read_b64_tr_b16 v[136:137], v170 offset:0
v_mfma_f32_16x16x32_bf16 v[44:47], v[140:143], a[140:143], v[44:47]
ds_read_b64_tr_b16 v[138:139], v170 offset:1024
s_waitcnt lgkmcnt(7)
v_mfma_f32_16x16x32_bf16 v[48:51], v[144:147], a[136:139], v[48:51]
buffer_load_dwordx4 v193, s[20:23], s41 offen offset:1024  lds
v_mfma_f32_16x16x32_bf16 v[52:55], v[144:147], a[140:143], v[52:55]
ds_read_b128 a[148:151], v196 offset:18432
ds_read_b64_tr_b16 v[140:141], v171 offset:0
ds_read_b64_tr_b16 v[142:143], v171 offset:1024
v_mfma_f32_16x16x32_bf16 v[56:59], v[148:151], a[136:139], v[56:59]
buffer_load_dwordx4 v194, s[20:23], s41 offen offset:2048  lds
v_mfma_f32_16x16x32_bf16 v[60:63], v[148:151], a[140:143], v[60:63]
ds_read_b64_tr_b16 v[144:145], v172 offset:0
ds_read_b64_tr_b16 v[146:147], v172 offset:1024
v_mfma_f32_16x16x32_bf16 v[64:67], v[152:155], a[136:139], v[64:67]
ds_read_b64_tr_b16 v[148:149], v173 offset:0
ds_read_b64_tr_b16 v[150:151], v173 offset:1024
v_mfma_f32_16x16x32_bf16 v[68:71], v[152:155], a[140:143], v[68:71]
buffer_load_dwordx4 v195, s[20:23], s41 offen offset:3072  lds
v_mfma_f32_16x16x32_bf16 v[72:75], v[156:159], a[136:139], v[72:75]
ds_read_b64_tr_b16 v[152:153], v174 offset:0
ds_read_b64_tr_b16 v[154:155], v174 offset:1024
v_mfma_f32_16x16x32_bf16 v[76:79], v[156:159], a[140:143], v[76:79]
ds_read_b64_tr_b16 v[156:157], v175 offset:0
s_waitcnt lgkmcnt(7)
v_mfma_f32_16x16x32_bf16 v[16:19], v[128:131], a[144:147], v[16:19]
ds_read_b128 a[152:155], v197 offset:16384
v_mfma_f32_16x16x32_bf16 v[20:23], v[128:131], a[148:151], v[20:23]
ds_read_b64_tr_b16 v[158:159], v175 offset:1024
ds_read_b64_tr_b16 v[128:129], v168 offset:8192
v_mfma_f32_16x16x32_bf16 v[24:27], v[132:135], a[144:147], v[24:27]
s_add_u32 m0, s45, 8192
s_add_u32 s3, s40, 128
v_mfma_f32_16x16x32_bf16 v[28:31], v[132:135], a[148:151], v[28:31]
buffer_load_dwordx4 v188, s[16:19], s40 offen offset:0  lds
v_mfma_f32_16x16x32_bf16 v[32:35], v[136:139], a[144:147], v[32:35]
ds_read_b128 a[156:159], v197 offset:18432
v_mfma_f32_16x16x32_bf16 v[36:39], v[136:139], a[148:151], v[36:39]
buffer_load_dwordx4 v189, s[16:19], s40 offen offset:1024  lds
v_mfma_f32_16x16x32_bf16 v[40:43], v[140:143], a[144:147], v[40:43]
ds_read_b64_tr_b16 v[130:131], v168 offset:9216
ds_read_b64_tr_b16 v[132:133], v169 offset:8192
v_mfma_f32_16x16x32_bf16 v[44:47], v[140:143], a[148:151], v[44:47]
ds_read_b64_tr_b16 v[134:135], v169 offset:9216
s_waitcnt lgkmcnt(5)
v_mfma_f32_16x16x32_bf16 v[48:51], v[144:147], a[144:147], v[48:51]
ds_read_b64_tr_b16 v[136:137], v170 offset:8192
ds_read_b64_tr_b16 v[138:139], v170 offset:9216
v_mfma_f32_16x16x32_bf16 v[52:55], v[144:147], a[148:151], v[52:55]
ds_read_b64_tr_b16 v[140:141], v171 offset:8192
ds_read_b64_tr_b16 v[142:143], v171 offset:9216
v_mfma_f32_16x16x32_bf16 v[56:59], v[148:151], a[144:147], v[56:59]
buffer_load_dwordx4 v190, s[16:19], s40 offen offset:2048  lds
v_mfma_f32_16x16x32_bf16 v[60:63], v[148:151], a[148:151], v[60:63]
ds_read_b64_tr_b16 v[144:145], v172 offset:8192
ds_read_b64_tr_b16 v[146:147], v172 offset:9216
v_mfma_f32_16x16x32_bf16 v[64:67], v[152:155], a[144:147], v[64:67]
ds_read_b64_tr_b16 v[148:149], v173 offset:8192
ds_read_b64_tr_b16 v[150:151], v173 offset:9216
v_mfma_f32_16x16x32_bf16 v[68:71], v[152:155], a[148:151], v[68:71]
buffer_load_dwordx4 v191, s[16:19], s40 offen offset:3072  lds
v_mfma_f32_16x16x32_bf16 v[72:75], v[156:159], a[144:147], v[72:75]
ds_read_b64_tr_b16 v[152:153], v174 offset:8192
ds_read_b64_tr_b16 v[154:155], v174 offset:9216
v_mfma_f32_16x16x32_bf16 v[76:79], v[156:159], a[148:151], v[76:79]
ds_read_b64_tr_b16 v[156:157], v175 offset:8192
s_waitcnt lgkmcnt(7)
v_mfma_f32_16x16x32_bf16 v[16:19], v[128:131], a[152:155], v[16:19]
s_and_b32 s3, s3, 2047
ds_read_b64_tr_b16 v[158:159], v175 offset:9216
v_mfma_f32_16x16x32_bf16 v[20:23], v[128:131], a[156:159], v[20:23]
s_waitcnt vmcnt(16)
s_barrier
v_mfma_f32_16x16x32_bf16 v[24:27], v[132:135], a[152:155], v[24:27]
ds_read_b64_tr_b16 v[128:129], v160 offset:0
ds_read_b64_tr_b16 v[130:131], v160 offset:1024
v_mfma_f32_16x16x32_bf16 v[28:31], v[132:135], a[156:159], v[28:31]
ds_read_b64_tr_b16 v[132:133], v161 offset:0
s_add_u32 m0, s44, 49152
v_mfma_f32_16x16x32_bf16 v[32:35], v[136:139], a[152:155], v[32:35]
ds_read_b128 a[160:163], v196 offset:0
v_mfma_f32_16x16x32_bf16 v[36:39], v[136:139], a[156:159], v[36:39]
s_mul_i32 s41, s3, 3584
buffer_load_dwordx4 v192, s[20:23], s41 offen offset:0  lds
v_mfma_f32_16x16x32_bf16 v[40:43], v[140:143], a[152:155], v[40:43]
ds_read_b64_tr_b16 v[134:135], v161 offset:1024
ds_read_b64_tr_b16 v[136:137], v162 offset:0
v_mfma_f32_16x16x32_bf16 v[44:47], v[140:143], a[156:159], v[44:47]
ds_read_b64_tr_b16 v[138:139], v162 offset:1024
s_waitcnt lgkmcnt(7)
v_mfma_f32_16x16x32_bf16 v[48:51], v[144:147], a[152:155], v[48:51]
buffer_load_dwordx4 v193, s[20:23], s41 offen offset:1024  lds
v_mfma_f32_16x16x32_bf16 v[52:55], v[144:147], a[156:159], v[52:55]
ds_read_b128 a[164:167], v196 offset:2048
ds_read_b64_tr_b16 v[140:141], v163 offset:0
ds_read_b64_tr_b16 v[142:143], v163 offset:1024
v_mfma_f32_16x16x32_bf16 v[56:59], v[148:151], a[152:155], v[56:59]
buffer_load_dwordx4 v194, s[20:23], s41 offen offset:2048  lds
v_mfma_f32_16x16x32_bf16 v[60:63], v[148:151], a[156:159], v[60:63]
ds_read_b64_tr_b16 v[144:145], v164 offset:0
ds_read_b64_tr_b16 v[146:147], v164 offset:1024
v_mfma_f32_16x16x32_bf16 v[64:67], v[152:155], a[152:155], v[64:67]
ds_read_b64_tr_b16 v[148:149], v165 offset:0
ds_read_b64_tr_b16 v[150:151], v165 offset:1024
v_mfma_f32_16x16x32_bf16 v[68:71], v[152:155], a[156:159], v[68:71]
buffer_load_dwordx4 v195, s[20:23], s41 offen offset:3072  lds
v_mfma_f32_16x16x32_bf16 v[72:75], v[156:159], a[152:155], v[72:75]
ds_read_b64_tr_b16 v[152:153], v166 offset:0
ds_read_b64_tr_b16 v[154:155], v166 offset:1024
v_mfma_f32_16x16x32_bf16 v[76:79], v[156:159], a[156:159], v[76:79]
ds_read_b64_tr_b16 v[156:157], v167 offset:0
s_waitcnt lgkmcnt(7)
v_mfma_f32_16x16x32_bf16 v[16:19], v[128:131], a[160:163], v[16:19]
L_pg1:
s_cbranch_execz L_pg2
ds_read_b64_tr_b16 v[158:159], v167 offset:1024
v_mfma_f32_16x16x32_bf16 v[20:23], v[128:131], a[164:167], v[20:23]
ds_read_b128 a[168:171], v197 offset:0
v_mfma_f32_16x16x32_bf16 v[24:27], v[132:135], a[160:163], v[24:27]
s_add_u32 m0, s45, 12288
s_add_u32 s40, s3, 128
v_mfma_f32_16x16x32_bf16 v[28:31], v[132:135], a[164:167], v[28:31]
buffer_load_dwordx4 v188, s[16:19], s3 offen offset:0  lds
v_mfma_f32_16x16x32_bf16 v[32:35], v[136:139], a[160:163], v[32:35]
ds_read_b128 a[172:175], v197 offset:2048
v_mfma_f32_16x16x32_bf16 v[36:39], v[136:139], a[164:167], v[36:39]
buffer_load_dwordx4 v189, s[16:19], s3 offen offset:1024  lds
v_mfma_f32_16x16x32_bf16 v[40:43], v[140:143], a[160:163], v[40:43]
ds_read_b64_tr_b16 v[128:129], v160 offset:8192
ds_read_b64_tr_b16 v[130:131], v160 offset:9216
v_mfma_f32_16x16x32_bf16 v[44:47], v[140:143], a[164:167], v[44:47]
ds_read_b64_tr_b16 v[132:133], v161 offset:8192
s_waitcnt lgkmcnt(5)
v_mfma_f32_16x16x32_bf16 v[48:51], v[144:147], a[160:163], v[48:51]
ds_read_b64_tr_b16 v[134:135], v161 offset:9216
ds_read_b64_tr_b16 v[136:137], v162 offset:8192
v_mfma_f32_16x16x32_bf16 v[52:55], v[144:147], a[164:167], v[52:55]
ds_read_b64_tr_b16 v[138:139], v162 offset:9216
ds_read_b64_tr_b16 v[140:141], v163 offset:8192
ds_read_b64_tr_b16 v[142:143], v163 offset:9216
v_mfma_f32_16x16x32_bf16 v[56:59], v[148:151], a[160:163], v[56:59]
buffer_load_dwordx4 v190, s[16:19], s3 offen offset:2048  lds
v_mfma_f32_16x16x32_bf16 v[60:63], v[148:151], a[164:167], v[60:63]
ds_read_b64_tr_b16 v[144:145], v164 offset:8192
ds_read_b64_tr_b16 v[146:147], v164 offset:9216
v_mfma_f32_16x16x32_bf16 v[64:67], v[152:155], a[160:163], v[64:67]
ds_read_b64_tr_b16 v[148:149], v165 offset:8192
ds_read_b64_tr_b16 v[150:151], v165 offset:9216
v_mfma_f32_16x16x32_bf16 v[68:71], v[152:155], a[164:167], v[68:71]
buffer_load_dwordx4 v191, s[16:19], s3 offen offset:3072  lds
v_mfma_f32_16x16x32_bf16 v[72:75], v[156:159], a[160:163], v[72:75]
ds_read_b64_tr_b16 v[152:153], v166 offset:8192
ds_read_b64_tr_b16 v[154:155], v166 offset:9216
v_mfma_f32_16x16x32_bf16 v[76:79], v[156:159], a[164:167], v[76:79]
ds_read_b64_tr_b16 v[156:157], v167 offset:8192
s_waitcnt lgkmcnt(7)
v_mfma_f32_16x16x32_bf16 v[16:19], v[128:131], a[168:171], v[16:19]
s_and_b32 s40, s40, 2047
ds_read_b64_tr_b16 v[158:159], v167 offset:9216
v_mfma_f32_16x16x32_bf16 v[20:23], v[128:131], a[172:175], v[20:23]
s_waitcnt vmcnt(16)
s_barrier
v_mfma_f32_16x16x32_bf16 v[24:27], v[132:135], a[168:171], v[24:27]
ds_read_b64_tr_b16 v[128:129], v160 offset:16384
ds_read_b64_tr_b16 v[130:131], v160 offset:17408
v_mfma_f32_16x16x32_bf16 v[28:31], v[132:135], a[172:175], v[28:31]
ds_read_b64_tr_b16 v[132:133], v161 offset:16384
s_add_u32 m0, s44, 65536
v_mfma_f32_16x16x32_bf16 v[32:35], v[136:139], a[168:171], v[32:35]
ds_read_b128 a[176:179], v196 offset:4096
v_mfma_f32_16x16x32_bf16 v[36:39], v[136:139], a[172:175], v[36:39]
s_mul_i32 s41, s40, 3584
buffer_load_dwordx4 v192, s[20:23], s41 offen offset:0  lds
v_mfma_f32_16x16x32_bf16 v[40:43], v[140:143], a[168:171], v[40:43]
ds_read_b64_tr_b16 v[134:135], v161 offset:17408
ds_read_b64_tr_b16 v[136:137], v162 offset:16384
v_mfma_f32_16x16x32_bf16 v[44:47], v[140:143], a[172:175], v[44:47]
ds_read_b64_tr_b16 v[138:139], v162 offset:17408
s_waitcnt lgkmcnt(7)
v_mfma_f32_16x16x32_bf16 v[48:51], v[144:147], a[168:171], v[48:51]
buffer_load_dwordx4 v193, s[20:23], s41 offen offset:1024  lds
v_mfma_f32_16x16x32_bf16 v[52:55], v[144:147], a[172:175], v[52:55]
ds_read_b128 a[180:183], v196 offset:6144
ds_read_b64_tr_b16 v[140:141], v163 offset:16384
ds_read_b64_tr_b16 v[142:143], v163 offset:17408
v_mfma_f32_16x16x32_bf16 v[56:59], v[148:151], a[168:171], v[56:59]
buffer_load_dwordx4 v194, s[20:23], s41 offen offset:2048  lds
v_mfma_f32_16x16x32_bf16 v[60:63], v[148:151], a[172:175], v[60:63]
ds_read_b64_tr_b16 v[144:145], v164 offset:16384
ds_read_b64_tr_b16 v[146:147], v164 offset:17408
v_mfma_f32_16x16x32_bf16 v[64:67], v[152:155], a[168:171], v[64:67]
ds_read_b64_tr_b16 v[148:149], v165 offset:16384
ds_read_b64_tr_b16 v[150:151], v165 offset:17408
v_mfma_f32_16x16x32_bf16 v[68:71], v[152:155], a[172:175], v[68:71]
buffer_load_dwordx4 v195, s[20:23], s41 offen offset:3072  lds
v_mfma_f32_16x16x32_bf16 v[72:75], v[156:159], a[168:171], v[72:75]
ds_read_b64_tr_b16 v[152:153], v166 offset:16384
ds_read_b64_tr_b16 v[154:155], v166 offset:17408
v_mfma_f32_16x16x32_bf16 v[76:79], v[156:159], a[172:175], v[76:79]
ds_read_b64_tr_b16 v[156:157], v167 offset:16384
s_waitcnt lgkmcnt(7)
v_mfma_f32_16x16x32_bf16 v[16:19], v[128:131], a[176:179], v[16:19]
ds_read_b128 a[184:187], v197 offset:4096
v_mfma_f32_16x16x32_bf16 v[20:23], v[128:131], a[180:183], v[20:23]
ds_read_b64_tr_b16 v[158:159], v167 offset:17408
ds_read_b64_tr_b16 v[128:129], v160 offset:24576
v_mfma_f32_16x16x32_bf16 v[24:27], v[132:135], a[176:179], v[24:27]
s_add_u32 m0, s45, 16384
s_add_u32 s3, s40, 128
v_mfma_f32_16x16x32_bf16 v[28:31], v[132:135], a[180:183], v[28:31]
buffer_load_dwordx4 v188, s[16:19], s40 offen offset:0  lds
v_mfma_f32_16x16x32_bf16 v[32:35], v[136:139], a[176:179], v[32:35]
ds_read_b128 a[188:191], v197 offset:6144
v_mfma_f32_16x16x32_bf16 v[36:39], v[136:139], a[180:183], v[36:39]
buffer_load_dwordx4 v189, s[16:19], s40 offen offset:1024  lds
v_mfma_f32_16x16x32_bf16 v[40:43], v[140:143], a[176:179], v[40:43]
ds_read_b64_tr_b16 v[130:131], v160 offset:25600
ds_read_b64_tr_b16 v[132:133], v161 offset:24576
v_mfma_f32_16x16x32_bf16 v[44:47], v[140:143], a[180:183], v[44:47]
ds_read_b64_tr_b16 v[134:135], v161 offset:25600
s_waitcnt lgkmcnt(5)
v_mfma_f32_16x16x32_bf16 v[48:51], v[144:147], a[176:179], v[48:51]
ds_read_b64_tr_b16 v[136:137], v162 offset:24576
ds_read_b64_tr_b16 v[138:139], v162 offset:25600
v_mfma_f32_16x16x32_bf16 v[52:55], v[144:147], a[180:183], v[52:55]
ds_read_b64_tr_b16 v[140:141], v163 offset:24576
ds_read_b64_tr_b16 v[142:143], v163 offset:25600
v_mfma_f32_16x16x32_bf16 v[56:59], v[148:151], a[176:179], v[56:59]
buffer_load_dwordx4 v190, s[16:19], s40 offen offset:2048  lds
v_mfma_f32_16x16x32_bf16 v[60:63], v[148:151], a[180:183], v[60:63]
ds_read_b64_tr_b16 v[144:145], v164 offset:24576
ds_read_b64_tr_b16 v[146:147], v164 offset:25600
v_mfma_f32_16x16x32_bf16 v[64:67], v[152:155], a[176:179], v[64:67]
ds_read_b64_tr_b16 v[148:149], v165 offset:24576
ds_read_b64_tr_b16 v[150:151], v165 offset:25600
v_mfma_f32_16x16x32_bf16 v[68:71], v[152:155], a[180:183], v[68:71]
buffer_load_dwordx4 v191, s[16:19], s40 offen offset:3072  lds
v_mfma_f32_16x16x32_bf16 v[72:75], v[156:159], a[176:179], v[72:75]
ds_read_b64_tr_b16 v[152:153], v166 offset:24576
ds_read_b64_tr_b16 v[154:155], v166 offset:25600
v_mfma_f32_16x16x32_bf16 v[76:79], v[156:159], a[180:183], v[76:79]
ds_read_b64_tr_b16 v[156:157], v167 offset:24576
s_waitcnt lgkmcnt(7)
v_mfma_f32_16x16x32_bf16 v[16:19], v[128:131], a[184:187], v[16:19]
s_and_b32 s3, s3, 2047
ds_read_b64_tr_b16 v[158:159], v167 offset:25600
v_mfma_f32_16x16x32_bf16 v[20:23], v[128:131], a[188:191], v[20:23]
s_waitcnt vmcnt(16)
s_barrier
v_mfma_f32_16x16x32_bf16 v[24:27], v[132:135], a[184:187], v[24:27]
ds_read_b64_tr_b16 v[128:129], v160 offset:32768
ds_read_b64_tr_b16 v[130:131], v160 offset:33792
v_mfma_f32_16x16x32_bf16 v[28:31], v[132:135], a[188:191], v[28:31]
ds_read_b64_tr_b16 v[132:133], v161 offset:32768
s_add_u32 m0, s44, 0
v_mfma_f32_16x16x32_bf16 v[32:35], v[136:139], a[184:187], v[32:35]
ds_read_b128 a[192:195], v196 offset:8192
v_mfma_f32_16x16x32_bf16 v[36:39], v[136:139], a[188:191], v[36:39]
s_mul_i32 s41, s3, 3584
buffer_load_dwordx4 v192, s[20:23], s41 offen offset:0  lds
v_mfma_f32_16x16x32_bf16 v[40:43], v[140:143], a[184:187], v[40:43]
ds_read_b64_tr_b16 v[134:135], v161 offset:33792
ds_read_b64_tr_b16 v[136:137], v162 offset:32768
v_mfma_f32_16x16x32_bf16 v[44:47], v[140:143], a[188:191], v[44:47]
ds_read_b64_tr_b16 v[138:139], v162 offset:33792
s_waitcnt lgkmcnt(7)
v_mfma_f32_16x16x32_bf16 v[48:51], v[144:147], a[184:187], v[48:51]
buffer_load_dwordx4 v193, s[20:23], s41 offen offset:1024  lds
v_mfma_f32_16x16x32_bf16 v[52:55], v[144:147], a[188:191], v[52:55]
ds_read_b128 a[196:199], v196 offset:10240
ds_read_b64_tr_b16 v[140:141], v163 offset:32768
ds_read_b64_tr_b16 v[142:143], v163 offset:33792
v_mfma_f32_16x16x32_bf16 v[56:59], v[148:151], a[184:187], v[56:59]
buffer_load_dwordx4 v194, s[20:23], s41 offen offset:2048  lds
v_mfma_f32_16x16x32_bf16 v[60:63], v[148:151], a[188:191], v[60:63]
ds_read_b64_tr_b16 v[144:145], v164 offset:32768
ds_read_b64_tr_b16 v[146:147], v164 offset:33792
v_mfma_f32_16x16x32_bf16 v[64:67], v[152:155], a[184:187], v[64:67]
ds_read_b64_tr_b16 v[148:149], v165 offset:32768
ds_read_b64_tr_b16 v[150:151], v165 offset:33792
v_mfma_f32_16x16x32_bf16 v[68:71], v[152:155], a[188:191], v[68:71]
buffer_load_dwordx4 v195, s[20:23], s41 offen offset:3072  lds
v_mfma_f32_16x16x32_bf16 v[72:75], v[156:159], a[184:187], v[72:75]
ds_read_b64_tr_b16 v[152:153], v166 offset:32768
ds_read_b64_tr_b16 v[154:155], v166 offset:33792
v_mfma_f32_16x16x32_bf16 v[76:79], v[156:159], a[188:191], v[76:79]
ds_read_b64_tr_b16 v[156:157], v167 offset:32768
s_waitcnt lgkmcnt(7)
v_mfma_f32_16x16x32_bf16 v[16:19], v[128:131], a[192:195], v[16:19]
ds_read_b128 a[200:203], v197 offset:8192
v_mfma_f32_16x16x32_bf16 v[20:23], v[128:131], a[196:199], v[20:23]
ds_read_b64_tr_b16 v[158:159], v167 offset:33792
ds_read_b64_tr_b16 v[128:129], v160 offset:40960
v_mfma_f32_16x16x32_bf16 v[24:27], v[132:135], a[192:195], v[24:27]
s_add_u32 m0, s45, 0
s_add_u32 s40, s3, 128
v_mfma_f32_16x16x32_bf16 v[28:31], v[132:135], a[196:199], v[28:31]
buffer_load_dwordx4 v188, s[16:19], s3 offen offset:0  lds
v_mfma_f32_16x16x32_bf16 v[32:35], v[136:139], a[192:195], v[32:35]
ds_read_b128 a[204:207], v197 offset:10240
v_mfma_f32_16x16x32_bf16 v[36:39], v[136:139], a[196:199], v[36:39]
buffer_load_dwordx4 v189, s[16:19], s3 offen offset:1024  lds
v_mfma_f32_16x16x32_bf16 v[40:43], v[140:143], a[192:195], v[40:43]
ds_read_b64_tr_b16 v[130:131], v160 offset:41984
ds_read_b64_tr_b16 v[132:133], v161 offset:40960
v_mfma_f32_16x16x32_bf16 v[44:47], v[140:143], a[196:199], v[44:47]
ds_read_b64_tr_b16 v[134:135], v161 offset:41984
s_waitcnt lgkmcnt(5)
v_mfma_f32_16x16x32_bf16 v[48:51], v[144:147], a[192:195], v[48:51]
ds_read_b64_tr_b16 v[136:137], v162 offset:40960
ds_read_b64_tr_b16 v[138:139], v162 offset:41984
v_mfma_f32_16x16x32_bf16 v[52:55], v[144:147], a[196:199], v[52:55]
ds_read_b64_tr_b16 v[140:141], v163 offset:40960
ds_read_b64_tr_b16 v[142:143], v163 offset:41984
v_mfma_f32_16x16x32_bf16 v[56:59], v[148:151], a[192:195], v[56:59]
buffer_load_dwordx4 v190, s[16:19], s3 offen offset:2048  lds
v_mfma_f32_16x16x32_bf16 v[60:63], v[148:151], a[196:199], v[60:63]
ds_read_b64_tr_b16 v[144:145], v164 offset:40960
ds_read_b64_tr_b16 v[146:147], v164 offset:41984
v_mfma_f32_16x16x32_bf16 v[64:67], v[152:155], a[192:195], v[64:67]
ds_read_b64_tr_b16 v[148:149], v165 offset:40960
ds_read_b64_tr_b16 v[150:151], v165 offset:41984
v_mfma_f32_16x16x32_bf16 v[68:71], v[152:155], a[196:199], v[68:71]
buffer_load_dwordx4 v191, s[16:19], s3 offen offset:3072  lds
v_mfma_f32_16x16x32_bf16 v[72:75], v[156:159], a[192:195], v[72:75]
ds_read_b64_tr_b16 v[152:153], v166 offset:40960
ds_read_b64_tr_b16 v[154:155], v166 offset:41984
v_mfma_f32_16x16x32_bf16 v[76:79], v[156:159], a[196:199], v[76:79]
ds_read_b64_tr_b16 v[156:157], v167 offset:40960
s_waitcnt lgkmcnt(7)
v_mfma_f32_16x16x32_bf16 v[16:19], v[128:131], a[200:203], v[16:19]
s_and_b32 s40, s40, 2047
ds_read_b64_tr_b16 v[158:159], v167 offset:41984
v_mfma_f32_16x16x32_bf16 v[20:23], v[128:131], a[204:207], v[20:23]
s_waitcnt vmcnt(16)
s_barrier
v_mfma_f32_16x16x32_bf16 v[24:27], v[132:135], a[200:203], v[24:27]
ds_read_b64_tr_b16 v[128:129], v160 offset:49152
ds_read_b64_tr_b16 v[130:131], v160 offset:50176
v_mfma_f32_16x16x32_bf16 v[28:31], v[132:135], a[204:207], v[28:31]
ds_read_b64_tr_b16 v[132:133], v161 offset:49152
s_add_u32 m0, s44, 16384
v_mfma_f32_16x16x32_bf16 v[32:35], v[136:139], a[200:203], v[32:35]
ds_read_b128 a[208:211], v196 offset:12288
v_mfma_f32_16x16x32_bf16 v[36:39], v[136:139], a[204:207], v[36:39]
s_mul_i32 s41, s40, 3584
buffer_load_dwordx4 v192, s[24:27], s41 offen offset:0  lds
v_mfma_f32_16x16x32_bf16 v[40:43], v[140:143], a[200:203], v[40:43]
ds_read_b64_tr_b16 v[134:135], v161 offset:50176
ds_read_b64_tr_b16 v[136:137], v162 offset:49152
v_mfma_f32_16x16x32_bf16 v[44:47], v[140:143], a[204:207], v[44:47]
ds_read_b64_tr_b16 v[138:139], v162 offset:50176
s_waitcnt lgkmcnt(7)
v_mfma_f32_16x16x32_bf16 v[48:51], v[144:147], a[200:203], v[48:51]
ds_read_b128 a[212:215], v196 offset:14336
v_mfma_f32_16x16x32_bf16 v[52:55], v[144:147], a[204:207], v[52:55]
ds_read_b64_tr_b16 v[140:141], v163 offset:49152
ds_read_b64_tr_b16 v[142:143], v163 offset:50176
v_mfma_f32_16x16x32_bf16 v[56:59], v[148:151], a[200:203], v[56:59]
buffer_load_dwordx4 v193, s[24:27], s41 offen offset:1024  lds
v_mfma_f32_16x16x32_bf16 v[60:63], v[148:151], a[204:207], v[60:63]
ds_read_b64_tr_b16 v[144:145], v164 offset:49152
ds_read_b64_tr_b16 v[146:147], v164 offset:50176
v_mfma_f32_16x16x32_bf16 v[64:67], v[152:155], a[200:203], v[64:67]
ds_read_b64_tr_b16 v[148:149], v165 offset:49152
ds_read_b64_tr_b16 v[150:151], v165 offset:50176
v_mfma_f32_16x16x32_bf16 v[68:71], v[152:155], a[204:207], v[68:71]
ds_read_b64_tr_b16 v[152:153], v166 offset:49152
v_mfma_f32_16x16x32_bf16 v[72:75], v[156:159], a[200:203], v[72:75]
ds_read_b64_tr_b16 v[154:155], v166 offset:50176
v_mfma_f32_16x16x32_bf16 v[76:79], v[156:159], a[204:207], v[76:79]
ds_read_b64_tr_b16 v[156:157], v167 offset:49152
s_waitcnt lgkmcnt(7)
v_mfma_f32_16x16x32_bf16 v[16:19], v[128:131], a[208:211], v[16:19]
ds_read_b128 a[216:219], v197 offset:12288
v_mfma_f32_16x16x32_bf16 v[20:23], v[128:131], a[212:215], v[20:23]
ds_read_b64_tr_b16 v[158:159], v167 offset:50176
ds_read_b64_tr_b16 v[128:129], v160 offset:57344
v_mfma_f32_16x16x32_bf16 v[24:27], v[132:135], a[208:211], v[24:27]
buffer_load_dwordx4 v194, s[24:27], s41 offen offset:2048  lds
v_mfma_f32_16x16x32_bf16 v[28:31], v[132:135], a[212:215], v[28:31]
ds_read_b64_tr_b16 v[130:131], v160 offset:58368
ds_read_b64_tr_b16 v[132:133], v161 offset:57344
v_mfma_f32_16x16x32_bf16 v[32:35], v[136:139], a[208:211], v[32:35]
ds_read_b128 a[220:223], v197 offset:14336
v_mfma_f32_16x16x32_bf16 v[36:39], v[136:139], a[212:215], v[36:39]
ds_read_b64_tr_b16 v[134:135], v161 offset:58368
ds_read_b64_tr_b16 v[136:137], v162 offset:57344
v_mfma_f32_16x16x32_bf16 v[40:43], v[140:143], a[208:211], v[40:43]
ds_read_b64_tr_b16 v[138:139], v162 offset:58368
v_mfma_f32_16x16x32_bf16 v[44:47], v[140:143], a[212:215], v[44:47]
ds_read_b64_tr_b16 v[140:141], v163 offset:57344
s_waitcnt lgkmcnt(8)
v_mfma_f32_16x16x32_bf16 v[48:51], v[144:147], a[208:211], v[48:51]
ds_read_b64_tr_b16 v[142:143], v163 offset:58368
v_mfma_f32_16x16x32_bf16 v[52:55], v[144:147], a[212:215], v[52:55]
buffer_load_dwordx4 v195, s[24:27], s41 offen offset:3072  lds
v_mfma_f32_16x16x32_bf16 v[56:59], v[148:151], a[208:211], v[56:59]
ds_read_b64_tr_b16 v[144:145], v164 offset:57344
ds_read_b64_tr_b16 v[146:147], v164 offset:58368
v_mfma_f32_16x16x32_bf16 v[60:63], v[148:151], a[212:215], v[60:63]
ds_read_b64_tr_b16 v[148:149], v165 offset:57344
v_mfma_f32_16x16x32_bf16 v[64:67], v[152:155], a[208:211], v[64:67]
ds_read_b64_tr_b16 v[150:151], v165 offset:58368
v_mfma_f32_16x16x32_bf16 v[68:71], v[152:155], a[212:215], v[68:71]
ds_read_b64_tr_b16 v[152:153], v166 offset:57344
v_mfma_f32_16x16x32_bf16 v[72:75], v[156:159], a[208:211], v[72:75]
ds_read_b64_tr_b16 v[154:155], v166 offset:58368
s_add_u32 s3, s40, 128
v_mfma_f32_16x16x32_bf16 v[76:79], v[156:159], a[212:215], v[76:79]
ds_read_b64_tr_b16 v[156:157], v167 offset:57344
s_waitcnt lgkmcnt(7)
v_mfma_f32_16x16x32_bf16 v[16:19], v[128:131], a[216:219], v[16:19]
s_and_b32 s3, s3, 2047
ds_read_b64_tr_b16 v[158:159], v167 offset:58368
v_mfma_f32_16x16x32_bf16 v[20:23], v[128:131], a[220:223], v[20:23]
s_waitcnt vmcnt(12)
s_barrier
v_mfma_f32_16x16x32_bf16 v[24:27], v[132:135], a[216:219], v[24:27]
ds_read_b64_tr_b16 v[128:129], v168 offset:0
ds_read_b64_tr_b16 v[130:131], v168 offset:1024
v_mfma_f32_16x16x32_bf16 v[28:31], v[132:135], a[220:223], v[28:31]
ds_read_b64_tr_b16 v[132:133], v169 offset:0
s_add_u32 m0, s44, 32768
v_mfma_f32_16x16x32_bf16 v[32:35], v[136:139], a[216:219], v[32:35]
ds_read_b128 a[224:227], v196 offset:16384
v_mfma_f32_16x16x32_bf16 v[36:39], v[136:139], a[220:223], v[36:39]
s_mul_i32 s41, s3, 3584
buffer_load_dwordx4 v192, s[24:27], s41 offen offset:0  lds
v_mfma_f32_16x16x32_bf16 v[40:43], v[140:143], a[216:219], v[40:43]
ds_read_b64_tr_b16 v[134:135], v169 offset:1024
ds_read_b64_tr_b16 v[136:137], v170 offset:0
v_mfma_f32_16x16x32_bf16 v[44:47], v[140:143], a[220:223], v[44:47]
ds_read_b64_tr_b16 v[138:139], v170 offset:1024
s_waitcnt lgkmcnt(7)
v_mfma_f32_16x16x32_bf16 v[48:51], v[144:147], a[216:219], v[48:51]
ds_read_b128 a[228:231], v196 offset:18432
v_mfma_f32_16x16x32_bf16 v[52:55], v[144:147], a[220:223], v[52:55]
ds_read_b64_tr_b16 v[140:141], v171 offset:0
ds_read_b64_tr_b16 v[142:143], v171 offset:1024
v_mfma_f32_16x16x32_bf16 v[56:59], v[148:151], a[216:219], v[56:59]
buffer_load_dwordx4 v193, s[24:27], s41 offen offset:1024  lds
v_mfma_f32_16x16x32_bf16 v[60:63], v[148:151], a[220:223], v[60:63]
ds_read_b64_tr_b16 v[144:145], v172 offset:0
ds_read_b64_tr_b16 v[146:147], v172 offset:1024
v_mfma_f32_16x16x32_bf16 v[64:67], v[152:155], a[216:219], v[64:67]
ds_read_b64_tr_b16 v[148:149], v173 offset:0
ds_read_b64_tr_b16 v[150:151], v173 offset:1024
v_mfma_f32_16x16x32_bf16 v[68:71], v[152:155], a[220:223], v[68:71]
ds_read_b64_tr_b16 v[152:153], v174 offset:0
v_mfma_f32_16x16x32_bf16 v[72:75], v[156:159], a[216:219], v[72:75]
ds_read_b64_tr_b16 v[154:155], v174 offset:1024
v_mfma_f32_16x16x32_bf16 v[76:79], v[156:159], a[220:223], v[76:79]
ds_read_b64_tr_b16 v[156:157], v175 offset:0
s_waitcnt lgkmcnt(7)
v_mfma_f32_16x16x32_bf16 v[16:19], v[128:131], a[224:227], v[16:19]
ds_read_b128 a[232:235], v197 offset:16384
v_mfma_f32_16x16x32_bf16 v[20:23], v[128:131], a[228:231], v[20:23]
ds_read_b64_tr_b16 v[158:159], v175 offset:1024
ds_read_b64_tr_b16 v[128:129], v168 offset:8192
v_mfma_f32_16x16x32_bf16 v[24:27], v[132:135], a[224:227], v[24:27]
buffer_load_dwordx4 v194, s[24:27], s41 offen offset:2048  lds
v_mfma_f32_16x16x32_bf16 v[28:31], v[132:135], a[228:231], v[28:31]
ds_read_b64_tr_b16 v[130:131], v168 offset:9216
ds_read_b64_tr_b16 v[132:133], v169 offset:8192
v_mfma_f32_16x16x32_bf16 v[32:35], v[136:139], a[224:227], v[32:35]
ds_read_b128 a[236:239], v197 offset:18432
v_mfma_f32_16x16x32_bf16 v[36:39], v[136:139], a[228:231], v[36:39]
ds_read_b64_tr_b16 v[134:135], v169 offset:9216
ds_read_b64_tr_b16 v[136:137], v170 offset:8192
v_mfma_f32_16x16x32_bf16 v[40:43], v[140:143], a[224:227], v[40:43]
ds_read_b64_tr_b16 v[138:139], v170 offset:9216
v_mfma_f32_16x16x32_bf16 v[44:47], v[140:143], a[228:231], v[44:47]
ds_read_b64_tr_b16 v[140:141], v171 offset:8192
s_waitcnt lgkmcnt(8)
v_mfma_f32_16x16x32_bf16 v[48:51], v[144:147], a[224:227], v[48:51]
ds_read_b64_tr_b16 v[142:143], v171 offset:9216
v_mfma_f32_16x16x32_bf16 v[52:55], v[144:147], a[228:231], v[52:55]
buffer_load_dwordx4 v195, s[24:27], s41 offen offset:3072  lds
v_mfma_f32_16x16x32_bf16 v[56:59], v[148:151], a[224:227], v[56:59]
ds_read_b64_tr_b16 v[144:145], v172 offset:8192
ds_read_b64_tr_b16 v[146:147], v172 offset:9216
v_mfma_f32_16x16x32_bf16 v[60:63], v[148:151], a[228:231], v[60:63]
ds_read_b64_tr_b16 v[148:149], v173 offset:8192
v_mfma_f32_16x16x32_bf16 v[64:67], v[152:155], a[224:227], v[64:67]
ds_read_b64_tr_b16 v[150:151], v173 offset:9216
v_mfma_f32_16x16x32_bf16 v[68:71], v[152:155], a[228:231], v[68:71]
ds_read_b64_tr_b16 v[152:153], v174 offset:8192
v_mfma_f32_16x16x32_bf16 v[72:75], v[156:159], a[224:227], v[72:75]
ds_read_b64_tr_b16 v[154:155], v174 offset:9216
s_add_u32 s40, s3, 128
v_mfma_f32_16x16x32_bf16 v[76:79], v[156:159], a[228:231], v[76:79]
ds_read_b64_tr_b16 v[156:157], v175 offset:8192
s_waitcnt lgkmcnt(7)
v_mfma_f32_16x16x32_bf16 v[16:19], v[128:131], a[232:235], v[16:19]
s_and_b32 s40, s40, 2047
ds_read_b64_tr_b16 v[158:159], v175 offset:9216
v_mfma_f32_16x16x32_bf16 v[20:23], v[128:131], a[236:239], v[20:23]
s_waitcnt vmcnt(8)
s_barrier
v_mfma_f32_16x16x32_bf16 v[24:27], v[132:135], a[232:235], v[24:27]
ds_read_b64_tr_b16 v[128:129], v160 offset:0
ds_read_b64_tr_b16 v[130:131], v160 offset:1024
v_mfma_f32_16x16x32_bf16 v[28:31], v[132:135], a[236:239], v[28:31]
ds_read_b64_tr_b16 v[132:133], v161 offset:0
s_add_u32 m0, s44, 49152
v_mfma_f32_16x16x32_bf16 v[32:35], v[136:139], a[232:235], v[32:35]
ds_read_b128 a[240:243], v196 offset:0
v_mfma_f32_16x16x32_bf16 v[36:39], v[136:139], a[236:239], v[36:39]
s_mul_i32 s41, s40, 3584
buffer_load_dwordx4 v192, s[24:27], s41 offen offset:0  lds
v_mfma_f32_16x16x32_bf16 v[40:43], v[140:143], a[232:235], v[40:43]
ds_read_b64_tr_b16 v[134:135], v161 offset:1024
ds_read_b64_tr_b16 v[136:137], v162 offset:0
v_mfma_f32_16x16x32_bf16 v[44:47], v[140:143], a[236:239], v[44:47]
ds_read_b64_tr_b16 v[138:139], v162 offset:1024
s_waitcnt lgkmcnt(7)
v_mfma_f32_16x16x32_bf16 v[48:51], v[144:147], a[232:235], v[48:51]
ds_read_b128 a[244:247], v196 offset:2048
v_mfma_f32_16x16x32_bf16 v[52:55], v[144:147], a[236:239], v[52:55]
ds_read_b64_tr_b16 v[140:141], v163 offset:0
ds_read_b64_tr_b16 v[142:143], v163 offset:1024
v_mfma_f32_16x16x32_bf16 v[56:59], v[148:151], a[232:235], v[56:59]
buffer_load_dwordx4 v193, s[24:27], s41 offen offset:1024  lds
v_mfma_f32_16x16x32_bf16 v[60:63], v[148:151], a[236:239], v[60:63]
ds_read_b64_tr_b16 v[144:145], v164 offset:0
ds_read_b64_tr_b16 v[146:147], v164 offset:1024
v_mfma_f32_16x16x32_bf16 v[64:67], v[152:155], a[232:235], v[64:67]
ds_read_b64_tr_b16 v[148:149], v165 offset:0
ds_read_b64_tr_b16 v[150:151], v165 offset:1024
v_mfma_f32_16x16x32_bf16 v[68:71], v[152:155], a[236:239], v[68:71]
ds_read_b64_tr_b16 v[152:153], v166 offset:0
v_mfma_f32_16x16x32_bf16 v[72:75], v[156:159], a[232:235], v[72:75]
ds_read_b64_tr_b16 v[154:155], v166 offset:1024
v_mfma_f32_16x16x32_bf16 v[76:79], v[156:159], a[236:239], v[76:79]
ds_read_b64_tr_b16 v[156:157], v167 offset:0
s_waitcnt lgkmcnt(7)
v_mfma_f32_16x16x32_bf16 v[16:19], v[128:131], a[240:243], v[16:19]
ds_read_b128 a[248:251], v197 offset:0
v_mfma_f32_16x16x32_bf16 v[20:23], v[128:131], a[244:247], v[20:23]
ds_read_b64_tr_b16 v[158:159], v167 offset:1024
ds_read_b64_tr_b16 v[128:129], v160 offset:8192
v_mfma_f32_16x16x32_bf16 v[24:27], v[132:135], a[240:243], v[24:27]
buffer_load_dwordx4 v194, s[24:27], s41 offen offset:2048  lds
v_mfma_f32_16x16x32_bf16 v[28:31], v[132:135], a[244:247], v[28:31]
ds_read_b64_tr_b16 v[130:131], v160 offset:9216
ds_read_b64_tr_b16 v[132:133], v161 offset:8192
v_mfma_f32_16x16x32_bf16 v[32:35], v[136:139], a[240:243], v[32:35]
ds_read_b128 a[252:255], v197 offset:2048
v_mfma_f32_16x16x32_bf16 v[36:39], v[136:139], a[244:247], v[36:39]
ds_read_b64_tr_b16 v[134:135], v161 offset:9216
ds_read_b64_tr_b16 v[136:137], v162 offset:8192
v_mfma_f32_16x16x32_bf16 v[40:43], v[140:143], a[240:243], v[40:43]
ds_read_b64_tr_b16 v[138:139], v162 offset:9216
v_mfma_f32_16x16x32_bf16 v[44:47], v[140:143], a[244:247], v[44:47]
ds_read_b64_tr_b16 v[140:141], v163 offset:8192
s_waitcnt lgkmcnt(8)
v_mfma_f32_16x16x32_bf16 v[48:51], v[144:147], a[240:243], v[48:51]
ds_read_b64_tr_b16 v[142:143], v163 offset:9216
v_mfma_f32_16x16x32_bf16 v[52:55], v[144:147], a[244:247], v[52:55]
buffer_load_dwordx4 v195, s[24:27], s41 offen offset:3072  lds
v_mfma_f32_16x16x32_bf16 v[56:59], v[148:151], a[240:243], v[56:59]
ds_read_b64_tr_b16 v[144:145], v164 offset:8192
ds_read_b64_tr_b16 v[146:147], v164 offset:9216
v_mfma_f32_16x16x32_bf16 v[60:63], v[148:151], a[244:247], v[60:63]
ds_read_b64_tr_b16 v[148:149], v165 offset:8192
v_mfma_f32_16x16x32_bf16 v[64:67], v[152:155], a[240:243], v[64:67]
ds_read_b64_tr_b16 v[150:151], v165 offset:9216
v_mfma_f32_16x16x32_bf16 v[68:71], v[152:155], a[244:247], v[68:71]
ds_read_b64_tr_b16 v[152:153], v166 offset:8192
v_mfma_f32_16x16x32_bf16 v[72:75], v[156:159], a[240:243], v[72:75]
ds_read_b64_tr_b16 v[154:155], v166 offset:9216
s_add_u32 s3, s40, 128
v_mfma_f32_16x16x32_bf16 v[76:79], v[156:159], a[244:247], v[76:79]
ds_read_b64_tr_b16 v[156:157], v167 offset:8192
s_waitcnt lgkmcnt(7)
v_mfma_f32_16x16x32_bf16 v[16:19], v[128:131], a[248:251], v[16:19]
s_and_b32 s3, s3, 2047
ds_read_b64_tr_b16 v[158:159], v167 offset:9216
v_mfma_f32_16x16x32_bf16 v[20:23], v[128:131], a[252:255], v[20:23]
s_waitcnt vmcnt(8)
s_barrier
v_mfma_f32_16x16x32_bf16 v[24:27], v[132:135], a[248:251], v[24:27]
ds_read_b64_tr_b16 v[128:129], v176 offset:16384
ds_read_b64_tr_b16 v[130:131], v176 offset:17408
v_mfma_f32_16x16x32_bf16 v[28:31], v[132:135], a[252:255], v[28:31]
ds_read_b64_tr_b16 v[132:133], v176 offset:24576
s_add_u32 m0, s44, 65536
v_mfma_f32_16x16x32_bf16 v[32:35], v[136:139], a[248:251], v[32:35]
ds_read_b64_tr_b16 v[134:135], v176 offset:25600
s_mul_i32 s41, s3, 3584
v_mfma_f32_16x16x32_bf16 v[36:39], v[136:139], a[252:255], v[36:39]
buffer_load_dwordx4 v192, s[24:27], s41 offen offset:0  lds
v_mfma_f32_16x16x32_bf16 v[40:43], v[140:143], a[248:251], v[40:43]
ds_read_b64_tr_b16 v[136:137], v177 offset:16384
ds_read_b64_tr_b16 v[138:139], v177 offset:17408
v_mfma_f32_16x16x32_bf16 v[44:47], v[140:143], a[252:255], v[44:47]
ds_read_b64_tr_b16 v[140:141], v177 offset:24576
s_waitcnt lgkmcnt(7)
v_mfma_f32_16x16x32_bf16 v[48:51], v[144:147], a[248:251], v[48:51]
buffer_load_dwordx4 v193, s[24:27], s41 offen offset:1024  lds
v_mfma_f32_16x16x32_bf16 v[52:55], v[144:147], a[252:255], v[52:55]
ds_read_b64_tr_b16 v[142:143], v177 offset:25600
ds_read_b64_tr_b16 v[144:145], v178 offset:16384
v_mfma_f32_16x16x32_bf16 v[56:59], v[148:151], a[248:251], v[56:59]
ds_read_b64_tr_b16 v[146:147], v178 offset:17408
v_mfma_f32_16x16x32_bf16 v[60:63], v[148:151], a[252:255], v[60:63]
ds_read_b64_tr_b16 v[148:149], v178 offset:24576
v_mfma_f32_16x16x32_bf16 v[64:67], v[152:155], a[248:251], v[64:67]
ds_read_b64_tr_b16 v[150:151], v178 offset:25600
v_mfma_f32_16x16x32_bf16 v[68:71], v[152:155], a[252:255], v[68:71]
ds_read_b64_tr_b16 v[152:153], v179 offset:16384
v_mfma_f32_16x16x32_bf16 v[72:75], v[156:159], a[248:251], v[72:75]
buffer_load_dwordx4 v194, s[24:27], s41 offen offset:2048  lds
v_mfma_f32_16x16x32_bf16 v[76:79], v[156:159], a[252:255], v[76:79]
ds_read_b64_tr_b16 v[154:155], v179 offset:17408
s_waitcnt lgkmcnt(6)
v_mfma_f32_16x16x32_bf16 v[80:83], v[128:131], a[0:3], 0
ds_read_b64_tr_b16 v[156:157], v179 offset:24576
ds_read_b64_tr_b16 v[158:159], v179 offset:25600
v_mfma_f32_16x16x32_bf16 v[80:83], v[132:135], a[8:11], v[80:83]
s_nop 3
v_pk_mul_f32 v[200:201], v[16:17], s[56:57] op_sel_hi:[1,0]
v_pk_mul_f32 v[202:203], v[18:19], s[56:57] op_sel_hi:[1,0]
v_pk_mul_f32 v[204:205], v[24:25], s[56:57] op_sel_hi:[1,0]
v_pk_mul_f32 v[206:207], v[26:27], s[56:57] op_sel_hi:[1,0]
v_mfma_f32_16x16x32_bf16 v[84:87], v[128:131], a[4:7], 0
ds_read_b64_tr_b16 v[128:129], v180 offset:16384
v_mfma_f32_16x16x32_bf16 v[84:87], v[132:135], a[12:15], v[84:87]
ds_read_b64_tr_b16 v[130:131], v180 offset:17408
v_mfma_f32_16x16x32_bf16 v[88:91], v[136:139], a[0:3], 0
v_exp_f32 v200, v200
v_exp_f32 v201, v201
v_exp_f32 v202, v202
v_exp_f32 v203, v203
v_exp_f32 v204, v204
v_exp_f32 v205, v205
v_exp_f32 v206, v206
v_exp_f32 v207, v207
v_pk_add_f32 v[200:201], v[200:201], 1.0 op_sel_hi:[1,0]
v_pk_add_f32 v[202:203], v[202:203], 1.0 op_sel_hi:[1,0]
v_pk_add_f32 v[204:205], v[204:205], 1.0 op_sel_hi:[1,0]
v_pk_add_f32 v[206:207], v[206:207], 1.0 op_sel_hi:[1,0]
v_rcp_f32 v200, v200
v_rcp_f32 v201, v201
v_rcp_f32 v202, v202
v_rcp_f32 v203, v203
v_rcp_f32 v204, v204
v_rcp_f32 v205, v205
v_rcp_f32 v206, v206
v_rcp_f32 v207, v207
v_pk_mul_f32 v[200:201], v[200:201], v[16:17]
v_pk_mul_f32 v[202:203], v[202:203], v[18:19]
v_pk_mul_f32 v[204:205], v[204:205], v[24:25]
v_pk_mul_f32 v[206:207], v[206:207], v[26:27]
v_pk_mul_f32 v[4:5], v[20:21], s[56:57] op_sel_hi:[1,0]
v_pk_mul_f32 v[6:7], v[22:23], s[56:57] op_sel_hi:[1,0]
v_pk_mul_f32 v[8:9], v[28:29], s[56:57] op_sel_hi:[1,0]
v_pk_mul_f32 v[10:11], v[30:31], s[56:57] op_sel_hi:[1,0]
v_cvt_pk_bf16_f32 v160, v200, v201
v_cvt_pk_bf16_f32 v161, v202, v203
v_cvt_pk_bf16_f32 v162, v204, v205
v_cvt_pk_bf16_f32 v163, v206, v207
v_mfma_f32_16x16x32_bf16 v[88:91], v[140:143], a[8:11], v[88:91]
L_pg2:
s_cbranch_execz L_pg_ret
ds_read_b64_tr_b16 v[132:133], v180 offset:24576
v_mfma_f32_16x16x32_bf16 v[92:95], v[136:139], a[4:7], 0
buffer_load_dwordx4 v195, s[24:27], s41 offen offset:3072  lds
v_mfma_f32_16x16x32_bf16 v[92:95], v[140:143], a[12:15], v[92:95]
ds_read_b64_tr_b16 v[134:135], v180 offset:25600
s_waitcnt lgkmcnt(4)
v_mfma_f32_16x16x32_bf16 v[96:99], v[144:147], a[0:3], 0
ds_read_b64_tr_b16 v[136:137], v181 offset:16384
ds_read_b64_tr_b16 v[138:139], v181 offset:17408
v_mfma_f32_16x16x32_bf16 v[96:99], v[148:151], a[8:11], v[96:99]
ds_read_b64_tr_b16 v[140:141], v181 offset:24576
ds_read_b64_tr_b16 v[142:143], v181 offset:25600
s_add_u32 s40, s3, 128
s_and_b32 s40, s40, 2047
v_mfma_f32_16x16x32_bf16 v[100:103], v[144:147], a[4:7], 0
s_waitcnt vmcnt(8)
s_barrier
v_mfma_f32_16x16x32_bf16 v[100:103], v[148:151], a[12:15], v[100:103]
ds_read_b64_tr_b16 v[144:145], v176 offset:32768
ds_read_b64_tr_b16 v[146:147], v176 offset:33792
v_mfma_f32_16x16x32_bf16 v[104:107], v[152:155], a[0:3], 0
ds_read_b64_tr_b16 v[148:149], v176 offset:40960
s_add_u32 m0, s44, 0
v_mfma_f32_16x16x32_bf16 v[104:107], v[156:159], a[8:11], v[104:107]
ds_read_b64_tr_b16 v[150:151], v176 offset:41984
s_mul_i32 s41, s40, 3584
v_mfma_f32_16x16x32_bf16 v[108:111], v[152:155], a[4:7], 0
buffer_load_dwordx4 v192, s[24:27], s41 offen offset:0  lds
v_mfma_f32_16x16x32_bf16 v[108:111], v[156:159], a[12:15], v[108:111]
ds_read_b64_tr_b16 v[152:153], v177 offset:32768
s_waitcnt lgkmcnt(5)
v_mfma_f32_16x16x32_bf16 v[112:115], v[128:131], a[0:3], 0
buffer_load_dwordx4 v193, s[24:27], s41 offen offset:1024  lds
v_mfma_f32_16x16x32_bf16 v[112:115], v[132:135], a[8:11], v[112:115]
ds_read_b64_tr_b16 v[154:155], v177 offset:33792
ds_read_b64_tr_b16 v[156:157], v177 offset:40960
ds_read_b64_tr_b16 v[158:159], v177 offset:41984
v_mfma_f32_16x16x32_bf16 v[116:119], v[128:131], a[4:7], 0
buffer_load_dwordx4 v194, s[24:27], s41 offen offset:2048  lds
v_mfma_f32_16x16x32_bf16 v[116:119], v[132:135], a[12:15], v[116:119]
ds_read_b64_tr_b16 v[128:129], v178 offset:32768
ds_read_b64_tr_b16 v[130:131], v178 offset:33792
v_mfma_f32_16x16x32_bf16 v[120:123], v[136:139], a[0:3], 0
ds_read_b64_tr_b16 v[132:133], v178 offset:40960
v_mfma_f32_16x16x32_bf16 v[120:123], v[140:143], a[8:11], v[120:123]
ds_read_b64_tr_b16 v[134:135], v178 offset:41984
v_mfma_f32_16x16x32_bf16 v[124:127], v[136:139], a[4:7], 0
buffer_load_dwordx4 v195, s[24:27], s41 offen offset:3072  lds
v_mfma_f32_16x16x32_bf16 v[124:127], v[140:143], a[12:15], v[124:127]
buffer_store_dwordx4 v[160:163], v198, s[32:35], s58 offen sc1
v_exp_f32 v4, v4
v_exp_f32 v5, v5
v_exp_f32 v6, v6
v_exp_f32 v7, v7
v_exp_f32 v8, v8
v_exp_f32 v9, v9
v_exp_f32 v10, v10
v_exp_f32 v11, v11
v_pk_add_f32 v[4:5], v[4:5], 1.0 op_sel_hi:[1,0]
v_pk_add_f32 v[6:7], v[6:7], 1.0 op_sel_hi:[1,0]
v_pk_add_f32 v[8:9], v[8:9], 1.0 op_sel_hi:[1,0]
v_pk_add_f32 v[10:11], v[10:11], 1.0 op_sel_hi:[1,0]
v_rcp_f32 v4, v4
v_rcp_f32 v5, v5
v_rcp_f32 v6, v6
v_rcp_f32 v7, v7
v_rcp_f32 v8, v8
v_rcp_f32 v9, v9
v_rcp_f32 v10, v10
v_rcp_f32 v11, v11
v_pk_mul_f32 v[4:5], v[4:5], v[20:21]
v_pk_mul_f32 v[6:7], v[6:7], v[22:23]
v_pk_mul_f32 v[8:9], v[8:9], v[28:29]
v_pk_mul_f32 v[10:11], v[10:11], v[30:31]
v_pk_mul_f32 v[200:201], v[32:33], s[56:57] op_sel_hi:[1,0]
v_pk_mul_f32 v[202:203], v[34:35], s[56:57] op_sel_hi:[1,0]
v_pk_mul_f32 v[204:205], v[40:41], s[56:57] op_sel_hi:[1,0]
v_pk_mul_f32 v[206:207], v[42:43], s[56:57] op_sel_hi:[1,0]
v_cvt_pk_bf16_f32 v164, v4, v5
v_cvt_pk_bf16_f32 v165, v6, v7
v_cvt_pk_bf16_f32 v166, v8, v9
v_cvt_pk_bf16_f32 v167, v10, v11
s_waitcnt lgkmcnt(4)
v_mfma_f32_16x16x32_bf16 v[80:83], v[144:147], a[16:19], v[80:83]
ds_read_b64_tr_b16 v[136:137], v179 offset:32768
ds_read_b64_tr_b16 v[138:139], v179 offset:33792
v_mfma_f32_16x16x32_bf16 v[80:83], v[148:151], a[24:27], v[80:83]
ds_read_b64_tr_b16 v[140:141], v179 offset:40960
ds_read_b64_tr_b16 v[142:143], v179 offset:41984
v_mfma_f32_16x16x32_bf16 v[84:87], v[148:151], a[28:31], v[84:87]
ds_read_b64_tr_b16 v[148:149], v180 offset:32768
s_add_u32 s3, s40, 128
v_mfma_f32_16x16x32_bf16 v[84:87], v[144:147], a[20:23], v[84:87]
s_and_b32 s3, s3, 2047
s_add_u32 m0, s62, 81920
s_lshl_b32 s63, s64, 4
v_mfma_f32_16x16x32_bf16 v[88:91], v[152:155], a[16:19], v[88:91]
buffer_load_dwordx4 v236, s[92:95], s63 offen offset:0  lds
v_mfma_f32_16x16x32_bf16 v[88:91], v[156:159], a[24:27], v[88:91]
ds_read_b64_tr_b16 v[150:151], v180 offset:33792
ds_read_b64_tr_b16 v[144:145], v180 offset:40960
v_mfma_f32_16x16x32_bf16 v[92:95], v[156:159], a[28:31], v[92:95]
buffer_load_dwordx4 v237, s[92:95], s63 offen offset:1024  lds
v_mfma_f32_16x16x32_bf16 v[92:95], v[152:155], a[20:23], v[92:95]
ds_read_b64_tr_b16 v[146:147], v180 offset:41984
s_waitcnt lgkmcnt(4)
v_mfma_f32_16x16x32_bf16 v[96:99], v[128:131], a[16:19], v[96:99]
ds_read_b64_tr_b16 v[156:157], v181 offset:32768
ds_read_b64_tr_b16 v[158:159], v181 offset:33792
v_mfma_f32_16x16x32_bf16 v[96:99], v[132:135], a[24:27], v[96:99]
ds_read_b64_tr_b16 v[152:153], v181 offset:40960
ds_read_b64_tr_b16 v[154:155], v181 offset:41984
v_mfma_f32_16x16x32_bf16 v[100:103], v[132:135], a[28:31], v[100:103]
s_waitcnt vmcnt(11)
s_barrier
v_mfma_f32_16x16x32_bf16 v[100:103], v[128:131], a[20:23], v[100:103]
ds_read_b64_tr_b16 a[0:1], v176 offset:49152
ds_read_b64_tr_b16 a[2:3], v176 offset:50176
v_mfma_f32_16x16x32_bf16 v[104:107], v[136:139], a[16:19], v[104:107]
ds_read_b64_tr_b16 a[4:5], v176 offset:57344
s_add_u32 m0, s44, 16384
v_mfma_f32_16x16x32_bf16 v[104:107], v[140:143], a[24:27], v[104:107]
ds_read_b64_tr_b16 a[6:7], v176 offset:58368
s_mul_i32 s41, s3, 3584
v_mfma_f32_16x16x32_bf16 v[108:111], v[140:143], a[28:31], v[108:111]
buffer_load_dwordx4 v192, s[24:27], s41 offen offset:0  lds
v_mfma_f32_16x16x32_bf16 v[108:111], v[136:139], a[20:23], v[108:111]
ds_read_b64_tr_b16 a[8:9], v177 offset:49152
s_waitcnt lgkmcnt(5)
v_mfma_f32_16x16x32_bf16 v[112:115], v[148:151], a[16:19], v[112:115]
buffer_load_dwordx4 v193, s[24:27], s41 offen offset:1024  lds
v_mfma_f32_16x16x32_bf16 v[112:115], v[144:147], a[24:27], v[112:115]
ds_read_b64_tr_b16 a[10:11], v177 offset:50176
ds_read_b64_tr_b16 a[12:13], v177 offset:57344
ds_read_b64_tr_b16 a[14:15], v177 offset:58368
v_mfma_f32_16x16x32_bf16 v[116:119], v[144:147], a[28:31], v[116:119]
buffer_store_dwordx4 v[164:167], v239, s[32:35], s58 offen sc1
v_exp_f32 v200, v200
v_exp_f32 v201, v201
v_exp_f32 v202, v202
v_exp_f32 v203, v203
v_exp_f32 v204, v204
v_exp_f32 v205, v205
v_exp_f32 v206, v206
v_exp_f32 v207, v207
v_pk_add_f32 v[200:201], v[200:201], 1.0 op_sel_hi:[1,0]
v_pk_add_f32 v[202:203], v[202:203], 1.0 op_sel_hi:[1,0]
v_pk_add_f32 v[204:205], v[204:205], 1.0 op_sel_hi:[1,0]
v_pk_add_f32 v[206:207], v[206:207], 1.0 op_sel_hi:[1,0]
v_rcp_f32 v200, v200
v_rcp_f32 v201, v201
v_rcp_f32 v202, v202
v_rcp_f32 v203, v203
v_rcp_f32 v204, v204
v_rcp_f32 v205, v205
v_rcp_f32 v206, v206
v_rcp_f32 v207, v207
v_pk_mul_f32 v[200:201], v[200:201], v[32:33]
v_pk_mul_f32 v[202:203], v[202:203], v[34:35]
v_pk_mul_f32 v[204:205], v[204:205], v[40:41]
v_pk_mul_f32 v[206:207], v[206:207], v[42:43]
v_pk_mul_f32 v[4:5], v[36:37], s[56:57] op_sel_hi:[1,0]
v_pk_mul_f32 v[6:7], v[38:39], s[56:57] op_sel_hi:[1,0]
v_pk_mul_f32 v[8:9], v[44:45], s[56:57] op_sel_hi:[1,0]
v_pk_mul_f32 v[10:11], v[46:47], s[56:57] op_sel_hi:[1,0]
v_cvt_pk_bf16_f32 v168, v200, v201
v_cvt_pk_bf16_f32 v169, v202, v203
v_cvt_pk_bf16_f32 v170, v204, v205
v_cvt_pk_bf16_f32 v171, v206, v207
v_mfma_f32_16x16x32_bf16 v[116:119], v[148:151], a[20:23], v[116:119]
buffer_load_dwordx4 v194, s[24:27], s41 offen offset:2048  lds
v_mfma_f32_16x16x32_bf16 v[120:123], v[156:159], a[16:19], v[120:123]
ds_read_b64_tr_b16 v[132:133], v178 offset:49152
ds_read_b64_tr_b16 v[134:135], v178 offset:50176
v_mfma_f32_16x16x32_bf16 v[120:123], v[152:155], a[24:27], v[120:123]
buffer_load_dwordx4 v195, s[24:27], s41 offen offset:3072  lds
v_mfma_f32_16x16x32_bf16 v[124:127], v[152:155], a[28:31], v[124:127]
ds_read_b64_tr_b16 v[128:129], v178 offset:57344
ds_read_b64_tr_b16 v[130:131], v178 offset:58368
v_mfma_f32_16x16x32_bf16 v[124:127], v[156:159], a[20:23], v[124:127]
ds_read_b64_tr_b16 v[140:141], v179 offset:49152
s_waitcnt lgkmcnt(5)
v_mfma_f32_16x16x32_bf16 v[80:83], a[0:3], a[32:35], v[80:83]
ds_read_b64_tr_b16 v[142:143], v179 offset:50176
ds_read_b64_tr_b16 v[136:137], v179 offset:57344
v_mfma_f32_16x16x32_bf16 v[80:83], a[4:7], a[40:43], v[80:83]
ds_read_b64_tr_b16 v[138:139], v179 offset:58368
s_add_u32 s40, s3, 128
v_mfma_f32_16x16x32_bf16 v[84:87], a[4:7], a[44:47], v[84:87]
s_and_b32 s40, s40, 2047
s_add_u32 m0, s62, 90112
s_lshl_b32 s63, s65, 4
v_mfma_f32_16x16x32_bf16 v[84:87], a[0:3], a[36:39], v[84:87]
buffer_load_dwordx4 v236, s[92:95], s63 offen offset:0  lds
v_mfma_f32_16x16x32_bf16 v[88:91], a[8:11], a[32:35], v[88:91]
ds_read_b64_tr_b16 v[144:145], v180 offset:49152
ds_read_b64_tr_b16 v[146:147], v180 offset:50176
v_mfma_f32_16x16x32_bf16 v[88:91], a[12:15], a[40:43], v[88:91]
buffer_load_dwordx4 v237, s[92:95], s63 offen offset:1024  lds
v_mfma_f32_16x16x32_bf16 v[92:95], a[12:15], a[44:47], v[92:95]
ds_read_b64_tr_b16 v[148:149], v180 offset:57344
ds_read_b64_tr_b16 v[150:151], v180 offset:58368
v_mfma_f32_16x16x32_bf16 v[92:95], a[8:11], a[36:39], v[92:95]
ds_read_b64_tr_b16 v[152:153], v181 offset:49152
s_waitcnt lgkmcnt(5)
v_mfma_f32_16x16x32_bf16 v[96:99], v[132:135], a[32:35], v[96:99]
s_waitcnt vmcnt(14)
s_barrier
v_mfma_f32_16x16x32_bf16 v[96:99], v[128:131], a[40:43], v[96:99]
ds_read_b64_tr_b16 v[154:155], v181 offset:50176
ds_read_b64_tr_b16 v[156:157], v181 offset:57344
ds_read_b64_tr_b16 v[158:159], v181 offset:58368
v_mfma_f32_16x16x32_bf16 v[100:103], v[128:131], a[44:47], v[100:103]
ds_read_b64_tr_b16 a[4:5], v182 offset:0
s_add_u32 m0, s44, 32768
v_mfma_f32_16x16x32_bf16 v[100:103], v[132:135], a[36:39], v[100:103]
ds_read_b64_tr_b16 a[6:7], v182 offset:1024
s_mul_i32 s41, s40, 3584
v_mfma_f32_16x16x32_bf16 v[104:107], v[140:143], a[32:35], v[104:107]
buffer_load_dwordx4 v192, s[24:27], s41 offen offset:0  lds
v_mfma_f32_16x16x32_bf16 v[104:107], v[136:139], a[40:43], v[104:107]
ds_read_b64_tr_b16 a[0:1], v182 offset:8192
ds_read_b64_tr_b16 a[2:3], v182 offset:9216
v_mfma_f32_16x16x32_bf16 v[108:111], v[136:139], a[44:47], v[108:111]
buffer_store_dwordx4 v[168:171], v248, s[32:35], s58 offen sc1
v_exp_f32 v4, v4
v_exp_f32 v5, v5
v_exp_f32 v6, v6
v_exp_f32 v7, v7
v_exp_f32 v8, v8
v_exp_f32 v9, v9
v_exp_f32 v10, v10
v_exp_f32 v11, v11
v_pk_add_f32 v[4:5], v[4:5], 1.0 op_sel_hi:[1,0]
v_pk_add_f32 v[6:7], v[6:7], 1.0 op_sel_hi:[1,0]
v_pk_add_f32 v[8:9], v[8:9], 1.0 op_sel_hi:[1,0]
v_pk_add_f32 v[10:11], v[10:11], 1.0 op_sel_hi:[1,0]
v_rcp_f32 v4, v4
v_rcp_f32 v5, v5
v_rcp_f32 v6, v6
v_rcp_f32 v7, v7
v_rcp_f32 v8, v8
v_rcp_f32 v9, v9
v_rcp_f32 v10, v10
v_rcp_f32 v11, v11
v_pk_mul_f32 v[4:5], v[4:5], v[36:37]
v_pk_mul_f32 v[6:7], v[6:7], v[38:39]
v_pk_mul_f32 v[8:9], v[8:9], v[44:45]
v_pk_mul_f32 v[10:11], v[10:11], v[46:47]
v_pk_mul_f32 v[200:201], v[48:49], s[56:57] op_sel_hi:[1,0]
v_pk_mul_f32 v[202:203], v[50:51], s[56:57] op_sel_hi:[1,0]
v_pk_mul_f32 v[204:205], v[56:57], s[56:57] op_sel_hi:[1,0]
v_pk_mul_f32 v[206:207], v[58:59], s[56:57] op_sel_hi:[1,0]
v_cvt_pk_bf16_f32 v172, v4, v5
v_cvt_pk_bf16_f32 v173, v6, v7
v_cvt_pk_bf16_f32 v174, v8, v9
v_cvt_pk_bf16_f32 v175, v10, v11
v_mfma_f32_16x16x32_bf16 v[108:111], v[140:143], a[36:39], v[108:111]
buffer_load_dwordx4 v193, s[24:27], s41 offen offset:1024  lds
s_waitcnt lgkmcnt(4)
v_mfma_f32_16x16x32_bf16 v[112:115], v[144:147], a[32:35], v[112:115]
ds_read_b64_tr_b16 a[12:13], v183 offset:0
ds_read_b64_tr_b16 a[14:15], v183 offset:1024
v_mfma_f32_16x16x32_bf16 v[112:115], v[148:151], a[40:43], v[112:115]
ds_read_b64_tr_b16 a[8:9], v183 offset:8192
ds_read_b64_tr_b16 a[10:11], v183 offset:9216
v_mfma_f32_16x16x32_bf16 v[116:119], v[148:151], a[44:47], v[116:119]
buffer_load_dwordx4 v194, s[24:27], s41 offen offset:2048  lds
v_mfma_f32_16x16x32_bf16 v[116:119], v[144:147], a[36:39], v[116:119]
ds_read_b64_tr_b16 v[128:129], v184 offset:0
ds_read_b64_tr_b16 v[130:131], v184 offset:1024
v_mfma_f32_16x16x32_bf16 v[120:123], v[152:155], a[32:35], v[120:123]
buffer_load_dwordx4 v195, s[24:27], s41 offen offset:3072  lds
v_mfma_f32_16x16x32_bf16 v[120:123], v[156:159], a[40:43], v[120:123]
ds_read_b64_tr_b16 v[132:133], v184 offset:8192
ds_read_b64_tr_b16 v[134:135], v184 offset:9216
v_mfma_f32_16x16x32_bf16 v[124:127], v[156:159], a[44:47], v[124:127]
ds_read_b64_tr_b16 v[136:137], v185 offset:0
s_add_u32 s3, s40, 128
v_mfma_f32_16x16x32_bf16 v[124:127], v[152:155], a[36:39], v[124:127]
ds_read_b64_tr_b16 v[138:139], v185 offset:1024
s_waitcnt lgkmcnt(6)
v_mfma_f32_16x16x32_bf16 v[80:83], a[4:7], a[48:51], v[80:83]
ds_read_b64_tr_b16 v[140:141], v185 offset:8192
s_and_b32 s3, s3, 2047
v_mfma_f32_16x16x32_bf16 v[80:83], a[0:3], a[56:59], v[80:83]
ds_read_b64_tr_b16 v[142:143], v185 offset:9216
s_add_u32 m0, s62, 98304
s_lshl_b32 s63, s66, 4
v_mfma_f32_16x16x32_bf16 v[84:87], a[0:3], a[60:63], v[84:87]
buffer_load_dwordx4 v236, s[92:95], s63 offen offset:0  lds
v_mfma_f32_16x16x32_bf16 v[84:87], a[4:7], a[52:55], v[84:87]
ds_read_b64_tr_b16 v[148:149], v186 offset:0
ds_read_b64_tr_b16 v[150:151], v186 offset:1024
v_mfma_f32_16x16x32_bf16 v[88:91], a[12:15], a[48:51], v[88:91]
buffer_load_dwordx4 v237, s[92:95], s63 offen offset:1024  lds
v_mfma_f32_16x16x32_bf16 v[88:91], a[8:11], a[56:59], v[88:91]
ds_read_b64_tr_b16 v[144:145], v186 offset:8192
ds_read_b64_tr_b16 v[146:147], v186 offset:9216
v_mfma_f32_16x16x32_bf16 v[92:95], a[8:11], a[60:63], v[92:95]
ds_read_b64_tr_b16 v[156:157], v187 offset:0
v_mfma_f32_16x16x32_bf16 v[92:95], a[12:15], a[52:55], v[92:95]
ds_read_b64_tr_b16 v[158:159], v187 offset:1024
s_waitcnt lgkmcnt(6)
v_mfma_f32_16x16x32_bf16 v[96:99], v[128:131], a[48:51], v[96:99]
s_waitcnt vmcnt(17)
s_barrier
v_mfma_f32_16x16x32_bf16 v[96:99], v[132:135], a[56:59], v[96:99]
ds_read_b64_tr_b16 v[152:153], v187 offset:8192
ds_read_b64_tr_b16 v[154:155], v187 offset:9216
buffer_store_dwordx4 v[172:175], v249, s[32:35], s58 offen sc1
v_exp_f32 v200, v200
v_exp_f32 v201, v201
v_exp_f32 v202, v202
v_exp_f32 v203, v203
v_exp_f32 v204, v204
v_exp_f32 v205, v205
v_exp_f32 v206, v206
v_exp_f32 v207, v207
v_pk_add_f32 v[200:201], v[200:201], 1.0 op_sel_hi:[1,0]
v_pk_add_f32 v[202:203], v[202:203], 1.0 op_sel_hi:[1,0]
v_pk_add_f32 v[204:205], v[204:205], 1.0 op_sel_hi:[1,0]
v_pk_add_f32 v[206:207], v[206:207], 1.0 op_sel_hi:[1,0]
v_rcp_f32 v200, v200
v_rcp_f32 v201, v201
v_rcp_f32 v202, v202
v_rcp_f32 v203, v203
v_rcp_f32 v204, v204
v_rcp_f32 v205, v205
v_rcp_f32 v206, v206
v_rcp_f32 v207, v207
v_pk_mul_f32 v[200:201], v[200:201], v[48:49]
v_pk_mul_f32 v[202:203], v[202:203], v[50:51]
v_pk_mul_f32 v[204:205], v[204:205], v[56:57]
v_pk_mul_f32 v[206:207], v[206:207], v[58:59]
v_pk_mul_f32 v[4:5], v[52:53], s[56:57] op_sel_hi:[1,0]
v_pk_mul_f32 v[6:7], v[54:55], s[56:57] op_sel_hi:[1,0]
v_pk_mul_f32 v[8:9], v[60:61], s[56:57] op_sel_hi:[1,0]
v_pk_mul_f32 v[10:11], v[62:63], s[56:57] op_sel_hi:[1,0]
v_cvt_pk_bf16_f32 v208, v200, v201
v_cvt_pk_bf16_f32 v209, v202, v203
v_cvt_pk_bf16_f32 v210, v204, v205
v_cvt_pk_bf16_f32 v211, v206, v207
v_mfma_f32_16x16x32_bf16 v[100:103], v[132:135], a[60:63], v[100:103]
ds_read_b64_tr_b16 a[0:1], v176 offset:0
s_add_u32 m0, s44, 49152
v_mfma_f32_16x16x32_bf16 v[100:103], v[128:131], a[52:55], v[100:103]
ds_read_b64_tr_b16 a[2:3], v176 offset:1024
s_mul_i32 s41, s3, 3584
v_mfma_f32_16x16x32_bf16 v[104:107], v[136:139], a[48:51], v[104:107]
buffer_load_dwordx4 v192, s[24:27], s41 offen offset:0  lds
v_mfma_f32_16x16x32_bf16 v[104:107], v[140:143], a[56:59], v[104:107]
ds_read_b64_tr_b16 a[4:5], v176 offset:8192
ds_read_b64_tr_b16 a[6:7], v176 offset:9216
v_mfma_f32_16x16x32_bf16 v[108:111], v[140:143], a[60:63], v[108:111]
buffer_load_dwordx2 v[240:241], v246, s[4:7], 0 offen sc1
v_mfma_f32_16x16x32_bf16 v[108:111], v[136:139], a[52:55], v[108:111]
buffer_load_dwordx4 v193, s[24:27], s41 offen offset:1024  lds
s_waitcnt lgkmcnt(4)
v_mfma_f32_16x16x32_bf16 v[112:115], v[148:151], a[48:51], v[112:115]
ds_read_b64_tr_b16 a[8:9], v177 offset:0
ds_read_b64_tr_b16 a[10:11], v177 offset:1024
v_mfma_f32_16x16x32_bf16 v[112:115], v[144:147], a[56:59], v[112:115]
ds_read_b64_tr_b16 a[12:13], v177 offset:8192
ds_read_b64_tr_b16 a[14:15], v177 offset:9216
v_mfma_f32_16x16x32_bf16 v[116:119], v[144:147], a[60:63], v[116:119]
buffer_load_dwordx4 v194, s[24:27], s41 offen offset:2048  lds
v_mfma_f32_16x16x32_bf16 v[116:119], v[148:151], a[52:55], v[116:119]
ds_read_b64_tr_b16 v[132:133], v178 offset:0
ds_read_b64_tr_b16 v[134:135], v178 offset:1024
v_mfma_f32_16x16x32_bf16 v[120:123], v[156:159], a[48:51], v[120:123]
buffer_load_dwordx4 v195, s[24:27], s41 offen offset:3072  lds
v_mfma_f32_16x16x32_bf16 v[120:123], v[152:155], a[56:59], v[120:123]
ds_read_b64_tr_b16 v[128:129], v178 offset:8192
ds_read_b64_tr_b16 v[130:131], v178 offset:9216
v_mfma_f32_16x16x32_bf16 v[124:127], v[152:155], a[60:63], v[124:127]
ds_read_b64_tr_b16 v[140:141], v179 offset:0
s_add_u32 s40, s3, 128
v_mfma_f32_16x16x32_bf16 v[124:127], v[156:159], a[52:55], v[124:127]
ds_read_b64_tr_b16 v[142:143], v179 offset:1024
s_waitcnt lgkmcnt(6)
v_mfma_f32_16x16x32_bf16 v[80:83], a[0:3], a[64:67], v[80:83]
ds_read_b64_tr_b16 v[136:137], v179 offset:8192
s_and_b32 s40, s40, 2047
v_mfma_f32_16x16x32_bf16 v[80:83], a[4:7], a[72:75], v[80:83]
ds_read_b64_tr_b16 v[138:139], v179 offset:9216
s_add_u32 m0, s62, 106496
s_lshl_b32 s63, s64, 4
v_mfma_f32_16x16x32_bf16 v[84:87], a[4:7], a[76:79], v[84:87]
buffer_load_dwordx4 v236, s[96:99], s63 offen offset:0  lds
v_mfma_f32_16x16x32_bf16 v[84:87], a[0:3], a[68:71], v[84:87]
ds_read_b64_tr_b16 v[144:145], v180 offset:0
ds_read_b64_tr_b16 v[146:147], v180 offset:1024
v_mfma_f32_16x16x32_bf16 v[88:91], a[8:11], a[64:67], v[88:91]
buffer_load_dwordx4 v237, s[96:99], s63 offen offset:1024  lds
v_mfma_f32_16x16x32_bf16 v[88:91], a[12:15], a[72:75], v[88:91]
buffer_store_dwordx4 v[208:211], v198, s[32:35], s59 offen sc1
v_exp_f32 v4, v4
v_exp_f32 v5, v5
v_exp_f32 v6, v6
v_exp_f32 v7, v7
v_exp_f32 v8, v8
v_exp_f32 v9, v9
v_exp_f32 v10, v10
v_exp_f32 v11, v11
v_pk_add_f32 v[4:5], v[4:5], 1.0 op_sel_hi:[1,0]
v_pk_add_f32 v[6:7], v[6:7], 1.0 op_sel_hi:[1,0]
v_pk_add_f32 v[8:9], v[8:9], 1.0 op_sel_hi:[1,0]
v_pk_add_f32 v[10:11], v[10:11], 1.0 op_sel_hi:[1,0]
v_rcp_f32 v4, v4
v_rcp_f32 v5, v5
v_rcp_f32 v6, v6
v_rcp_f32 v7, v7
v_rcp_f32 v8, v8
v_rcp_f32 v9, v9
v_rcp_f32 v10, v10
v_rcp_f32 v11, v11
v_pk_mul_f32 v[4:5], v[4:5], v[52:53]
v_pk_mul_f32 v[6:7], v[6:7], v[54:55]
v_pk_mul_f32 v[8:9], v[8:9], v[60:61]
v_pk_mul_f32 v[10:11], v[10:11], v[62:63]
v_pk_mul_f32 v[200:201], v[64:65], s[56:57] op_sel_hi:[1,0]
v_pk_mul_f32 v[202:203], v[66:67], s[56:57] op_sel_hi:[1,0]
v_pk_mul_f32 v[204:205], v[72:73], s[56:57] op_sel_hi:[1,0]
v_pk_mul_f32 v[206:207], v[74:75], s[56:57] op_sel_hi:[1,0]
v_cvt_pk_bf16_f32 v212, v4, v5
v_cvt_pk_bf16_f32 v213, v6, v7
v_cvt_pk_bf16_f32 v214, v8, v9
v_cvt_pk_bf16_f32 v215, v10, v11
v_mfma_f32_16x16x32_bf16 v[92:95], a[12:15], a[76:79], v[92:95]
ds_read_b64_tr_b16 v[148:149], v180 offset:8192
ds_read_b64_tr_b16 v[150:151], v180 offset:9216
v_mfma_f32_16x16x32_bf16 v[92:95], a[8:11], a[68:71], v[92:95]
ds_read_b64_tr_b16 v[152:153], v181 offset:0
s_waitcnt lgkmcnt(5)
v_mfma_f32_16x16x32_bf16 v[96:99], v[132:135], a[64:67], v[96:99]
s_waitcnt vmcnt(18)
s_barrier
v_mfma_f32_16x16x32_bf16 v[96:99], v[128:131], a[72:75], v[96:99]
ds_read_b64_tr_b16 v[154:155], v181 offset:1024
ds_read_b64_tr_b16 v[156:157], v181 offset:8192
ds_read_b64_tr_b16 v[158:159], v181 offset:9216
v_mfma_f32_16x16x32_bf16 v[100:103], v[128:131], a[76:79], v[100:103]
ds_read_b64_tr_b16 a[4:5], v176 offset:16384
s_add_u32 m0, s44, 65536
v_mfma_f32_16x16x32_bf16 v[100:103], v[132:135], a[68:71], v[100:103]
ds_read_b64_tr_b16 a[6:7], v176 offset:17408
s_mul_i32 s41, s40, 3584
v_mfma_f32_16x16x32_bf16 v[104:107], v[140:143], a[64:67], v[104:107]
buffer_load_dwordx4 v192, s[24:27], s41 offen offset:0  lds
v_mfma_f32_16x16x32_bf16 v[104:107], v[136:139], a[72:75], v[104:107]
ds_read_b64_tr_b16 a[0:1], v176 offset:24576
ds_read_b64_tr_b16 a[2:3], v176 offset:25600
v_mfma_f32_16x16x32_bf16 v[108:111], v[136:139], a[76:79], v[108:111]
buffer_load_dwordx4 v193, s[24:27], s41 offen offset:1024  lds
v_mfma_f32_16x16x32_bf16 v[108:111], v[140:143], a[68:71], v[108:111]
ds_read_b64_tr_b16 a[12:13], v177 offset:16384
s_waitcnt lgkmcnt(5)
v_mfma_f32_16x16x32_bf16 v[112:115], v[144:147], a[64:67], v[112:115]
buffer_load_dwordx4 v194, s[24:27], s41 offen offset:2048  lds
v_mfma_f32_16x16x32_bf16 v[112:115], v[148:151], a[72:75], v[112:115]
ds_read_b64_tr_b16 a[14:15], v177 offset:17408
ds_read_b64_tr_b16 a[8:9], v177 offset:24576
ds_read_b64_tr_b16 a[10:11], v177 offset:25600
v_mfma_f32_16x16x32_bf16 v[116:119], v[148:151], a[76:79], v[116:119]
ds_read_b64_tr_b16 v[128:129], v178 offset:16384
v_mfma_f32_16x16x32_bf16 v[116:119], v[144:147], a[68:71], v[116:119]
ds_read_b64_tr_b16 v[130:131], v178 offset:17408
v_mfma_f32_16x16x32_bf16 v[120:123], v[152:155], a[64:67], v[120:123]
buffer_load_dwordx4 v195, s[24:27], s41 offen offset:3072  lds
v_mfma_f32_16x16x32_bf16 v[120:123], v[156:159], a[72:75], v[120:123]
ds_read_b64_tr_b16 v[132:133], v178 offset:24576
ds_read_b64_tr_b16 v[134:135], v178 offset:25600
v_mfma_f32_16x16x32_bf16 v[124:127], v[156:159], a[76:79], v[124:127]
ds_read_b64_tr_b16 v[136:137], v179 offset:16384
s_add_u32 s3, s40, 128
v_mfma_f32_16x16x32_bf16 v[124:127], v[152:155], a[68:71], v[124:127]
ds_read_b64_tr_b16 v[138:139], v179 offset:17408
s_waitcnt lgkmcnt(6)
v_mfma_f32_16x16x32_bf16 v[80:83], a[4:7], a[80:83], v[80:83]
buffer_store_dwordx4 v[212:215], v239, s[32:35], s59 offen sc1
v_exp_f32 v200, v200
v_exp_f32 v201, v201
v_exp_f32 v202, v202
v_exp_f32 v203, v203
v_exp_f32 v204, v204
v_exp_f32 v205, v205
v_exp_f32 v206, v206
v_exp_f32 v207, v207
v_pk_add_f32 v[200:201], v[200:201], 1.0 op_sel_hi:[1,0]
v_pk_add_f32 v[202:203], v[202:203], 1.0 op_sel_hi:[1,0]
v_pk_add_f32 v[204:205], v[204:205], 1.0 op_sel_hi:[1,0]
v_pk_add_f32 v[206:207], v[206:207], 1.0 op_sel_hi:[1,0]
v_rcp_f32 v200, v200
v_rcp_f32 v201, v201
v_rcp_f32 v202, v202
v_rcp_f32 v203, v203
v_rcp_f32 v204, v204
v_rcp_f32 v205, v205
v_rcp_f32 v206, v206
v_rcp_f32 v207, v207
v_pk_mul_f32 v[200:201], v[200:201], v[64:65]
v_pk_mul_f32 v[202:203], v[202:203], v[66:67]
v_pk_mul_f32 v[204:205], v[204:205], v[72:73]
v_pk_mul_f32 v[206:207], v[206:207], v[74:75]
v_pk_mul_f32 v[4:5], v[68:69], s[56:57] op_sel_hi:[1,0]
v_pk_mul_f32 v[6:7], v[70:71], s[56:57] op_sel_hi:[1,0]
v_pk_mul_f32 v[8:9], v[76:77], s[56:57] op_sel_hi:[1,0]
v_pk_mul_f32 v[10:11], v[78:79], s[56:57] op_sel_hi:[1,0]
v_cvt_pk_bf16_f32 v216, v200, v201
v_cvt_pk_bf16_f32 v217, v202, v203
v_cvt_pk_bf16_f32 v218, v204, v205
v_cvt_pk_bf16_f32 v219, v206, v207
v_mfma_f32_16x16x32_bf16 v[80:83], a[0:3], a[88:91], v[80:83]
ds_read_b64_tr_b16 v[140:141], v179 offset:24576
ds_read_b64_tr_b16 v[142:143], v179 offset:25600
s_and_b32 s3, s3, 2047
s_add_u32 m0, s62, 114688
s_lshl_b32 s63, s65, 4
v_mfma_f32_16x16x32_bf16 v[84:87], a[0:3], a[92:95], v[84:87]
buffer_load_dwordx4 v236, s[96:99], s63 offen offset:0  lds
v_mfma_f32_16x16x32_bf16 v[84:87], a[4:7], a[84:87], v[84:87]
ds_read_b64_tr_b16 v[148:149], v180 offset:16384
ds_read_b64_tr_b16 v[150:151], v180 offset:17408
v_mfma_f32_16x16x32_bf16 v[88:91], a[12:15], a[80:83], v[88:91]
buffer_load_dwordx4 v237, s[96:99], s63 offen offset:1024  lds
v_mfma_f32_16x16x32_bf16 v[88:91], a[8:11], a[88:91], v[88:91]
ds_read_b64_tr_b16 v[144:145], v180 offset:24576
ds_read_b64_tr_b16 v[146:147], v180 offset:25600
v_mfma_f32_16x16x32_bf16 v[92:95], a[8:11], a[92:95], v[92:95]
ds_read_b64_tr_b16 v[156:157], v181 offset:16384
v_mfma_f32_16x16x32_bf16 v[92:95], a[12:15], a[84:87], v[92:95]
ds_read_b64_tr_b16 v[158:159], v181 offset:17408
s_waitcnt lgkmcnt(6)
v_mfma_f32_16x16x32_bf16 v[96:99], v[128:131], a[80:83], v[96:99]
s_waitcnt vmcnt(18)
s_barrier
v_mfma_f32_16x16x32_bf16 v[96:99], v[132:135], a[88:91], v[96:99]
ds_read_b64_tr_b16 v[152:153], v181 offset:24576
ds_read_b64_tr_b16 v[154:155], v181 offset:25600
v_mfma_f32_16x16x32_bf16 v[100:103], v[132:135], a[92:95], v[100:103]
ds_read_b64_tr_b16 a[0:1], v176 offset:32768
s_add_u32 m0, s44, 0
v_mfma_f32_16x16x32_bf16 v[100:103], v[128:131], a[84:87], v[100:103]
ds_read_b64_tr_b16 a[2:3], v176 offset:33792
s_mul_i32 s41, s3, 3584
v_mfma_f32_16x16x32_bf16 v[104:107], v[136:139], a[80:83], v[104:107]
buffer_load_dwordx4 v192, s[24:27], s41 offen offset:0  lds
v_mfma_f32_16x16x32_bf16 v[104:107], v[140:143], a[88:91], v[104:107]
ds_read_b64_tr_b16 a[4:5], v176 offset:40960
ds_read_b64_tr_b16 a[6:7], v176 offset:41984
v_mfma_f32_16x16x32_bf16 v[108:111], v[140:143], a[92:95], v[108:111]
buffer_load_dwordx4 v193, s[24:27], s41 offen offset:1024  lds
v_mfma_f32_16x16x32_bf16 v[108:111], v[136:139], a[84:87], v[108:111]
ds_read_b64_tr_b16 a[8:9], v177 offset:32768
s_waitcnt lgkmcnt(5)
v_mfma_f32_16x16x32_bf16 v[112:115], v[148:151], a[80:83], v[112:115]
buffer_load_dwordx4 v194, s[24:27], s41 offen offset:2048  lds
v_mfma_f32_16x16x32_bf16 v[112:115], v[144:147], a[88:91], v[112:115]
ds_read_b64_tr_b16 a[10:11], v177 offset:33792
ds_read_b64_tr_b16 a[12:13], v177 offset:40960
ds_read_b64_tr_b16 a[14:15], v177 offset:41984
v_mfma_f32_16x16x32_bf16 v[116:119], v[144:147], a[92:95], v[116:119]
ds_read_b64_tr_b16 v[132:133], v178 offset:32768
v_mfma_f32_16x16x32_bf16 v[116:119], v[148:151], a[84:87], v[116:119]
ds_read_b64_tr_b16 v[134:135], v178 offset:33792
v_mfma_f32_16x16x32_bf16 v[120:123], v[156:159], a[80:83], v[120:123]
L_pg3:
s_cbranch_execz L_pg4
buffer_store_dwordx4 v[216:219], v248, s[32:35], s59 offen sc1
v_exp_f32 v4, v4
v_exp_f32 v5, v5
v_exp_f32 v6, v6
v_exp_f32 v7, v7
v_exp_f32 v8, v8
v_exp_f32 v9, v9
v_exp_f32 v10, v10
v_exp_f32 v11, v11
v_pk_add_f32 v[4:5], v[4:5], 1.0 op_sel_hi:[1,0]
v_pk_add_f32 v[6:7], v[6:7], 1.0 op_sel_hi:[1,0]
v_pk_add_f32 v[8:9], v[8:9], 1.0 op_sel_hi:[1,0]
v_pk_add_f32 v[10:11], v[10:11], 1.0 op_sel_hi:[1,0]
v_rcp_f32 v4, v4
v_rcp_f32 v5, v5
v_rcp_f32 v6, v6
v_rcp_f32 v7, v7
v_rcp_f32 v8, v8
v_rcp_f32 v9, v9
v_rcp_f32 v10, v10
v_rcp_f32 v11, v11
v_pk_mul_f32 v[4:5], v[4:5], v[68:69]
v_pk_mul_f32 v[6:7], v[6:7], v[70:71]
v_pk_mul_f32 v[8:9], v[8:9], v[76:77]
v_pk_mul_f32 v[10:11], v[10:11], v[78:79]
v_cvt_pk_bf16_f32 v220, v4, v5
v_cvt_pk_bf16_f32 v221, v6, v7
v_cvt_pk_bf16_f32 v222, v8, v9
v_cvt_pk_bf16_f32 v223, v10, v11
v_mfma_f32_16x16x32_bf16 v[120:123], v[152:155], a[88:91], v[120:123]
buffer_store_dwordx4 v[220:223], v249, s[32:35], s59 offen sc1
v_mfma_f32_16x16x32_bf16 v[124:127], v[152:155], a[92:95], v[124:127]
buffer_load_dwordx4 v195, s[24:27], s41 offen offset:3072  lds
v_mfma_f32_16x16x32_bf16 v[124:127], v[156:159], a[84:87], v[124:127]
ds_read_b64_tr_b16 v[128:129], v178 offset:40960
s_waitcnt lgkmcnt(3)
v_mfma_f32_16x16x32_bf16 v[80:83], a[0:3], a[96:99], v[80:83]
ds_read_b64_tr_b16 v[130:131], v178 offset:41984
ds_read_b64_tr_b16 v[140:141], v179 offset:32768
v_mfma_f32_16x16x32_bf16 v[80:83], a[4:7], a[104:107], v[80:83]
ds_read_b64_tr_b16 v[142:143], v179 offset:33792
ds_read_b64_tr_b16 v[136:137], v179 offset:40960
ds_read_b64_tr_b16 v[138:139], v179 offset:41984
s_add_u32 s40, s3, 128
s_and_b32 s40, s40, 2047
s_add_u32 m0, s62, 122880
s_lshl_b32 s63, s66, 4
v_mfma_f32_16x16x32_bf16 v[84:87], a[4:7], a[108:111], v[84:87]
buffer_load_dwordx4 v236, s[96:99], s63 offen offset:0  lds
v_mfma_f32_16x16x32_bf16 v[84:87], a[0:3], a[100:103], v[84:87]
ds_read_b64_tr_b16 v[144:145], v180 offset:32768
ds_read_b64_tr_b16 v[146:147], v180 offset:33792
v_mfma_f32_16x16x32_bf16 v[88:91], a[8:11], a[96:99], v[88:91]
buffer_load_dwordx4 v237, s[96:99], s63 offen offset:1024  lds
v_mfma_f32_16x16x32_bf16 v[88:91], a[12:15], a[104:107], v[88:91]
ds_read_b64_tr_b16 v[148:149], v180 offset:40960
ds_read_b64_tr_b16 v[150:151], v180 offset:41984
v_mfma_f32_16x16x32_bf16 v[92:95], a[12:15], a[108:111], v[92:95]
ds_read_b64_tr_b16 v[152:153], v181 offset:32768
v_mfma_f32_16x16x32_bf16 v[92:95], a[8:11], a[100:103], v[92:95]
ds_read_b64_tr_b16 v[154:155], v181 offset:33792
s_waitcnt lgkmcnt(6)
v_mfma_f32_16x16x32_bf16 v[96:99], v[132:135], a[96:99], v[96:99]
s_waitcnt vmcnt(18)
s_barrier
v_mfma_f32_16x16x32_bf16 v[96:99], v[128:131], a[104:107], v[96:99]
ds_read_b64_tr_b16 v[156:157], v181 offset:40960
ds_read_b64_tr_b16 v[158:159], v181 offset:41984
s_waitcnt vmcnt(21)
v_readfirstlane_b32 s100, v240
s_nop 0
s_cmp_eq_u32 s100, 0
s_cbranch_scc1 L_n_slow
L_n_ok:
v_readfirstlane_b32 s101, v241
s_cmp_eq_u32 s36, 0
s_nop 0
s_cselect_b64 s[54:55], s[100:101], 0
v_mfma_f32_16x16x32_bf16 v[100:103], v[128:131], a[108:111], v[100:103]
ds_read_b64_tr_b16 a[4:5], v176 offset:49152
s_add_u32 m0, s44, 16384
v_mfma_f32_16x16x32_bf16 v[100:103], v[132:135], a[100:103], v[100:103]
ds_read_b64_tr_b16 a[6:7], v176 offset:50176
s_mul_i32 s41, s40, 3584
v_mfma_f32_16x16x32_bf16 v[104:107], v[140:143], a[96:99], v[104:107]
buffer_load_dwordx4 v192, s[24:27], s41 offen offset:0  lds
v_mfma_f32_16x16x32_bf16 v[104:107], v[136:139], a[104:107], v[104:107]
ds_read_b64_tr_b16 a[0:1], v176 offset:57344
ds_read_b64_tr_b16 a[2:3], v176 offset:58368
v_mfma_f32_16x16x32_bf16 v[108:111], v[136:139], a[108:111], v[108:111]
buffer_load_dwordx4 v193, s[24:27], s41 offen offset:1024  lds
v_mfma_f32_16x16x32_bf16 v[108:111], v[140:143], a[100:103], v[108:111]
ds_read_b64_tr_b16 a[12:13], v177 offset:49152
s_waitcnt lgkmcnt(5)
v_mfma_f32_16x16x32_bf16 v[112:115], v[144:147], a[96:99], v[112:115]
buffer_load_dwordx4 v194, s[24:27], s41 offen offset:2048  lds
v_mfma_f32_16x16x32_bf16 v[112:115], v[148:151], a[104:107], v[112:115]
ds_read_b64_tr_b16 a[14:15], v177 offset:50176
ds_read_b64_tr_b16 a[8:9], v177 offset:57344
ds_read_b64_tr_b16 a[10:11], v177 offset:58368
v_mfma_f32_16x16x32_bf16 v[116:119], v[148:151], a[108:111], v[116:119]
ds_read_b64_tr_b16 v[128:129], v178 offset:49152
v_mfma_f32_16x16x32_bf16 v[116:119], v[144:147], a[100:103], v[116:119]
ds_read_b64_tr_b16 v[130:131], v178 offset:50176
v_mfma_f32_16x16x32_bf16 v[120:123], v[152:155], a[96:99], v[120:123]
buffer_load_dwordx4 v195, s[24:27], s41 offen offset:3072  lds
v_mfma_f32_16x16x32_bf16 v[120:123], v[156:159], a[104:107], v[120:123]
ds_read_b64_tr_b16 v[132:133], v178 offset:57344
ds_read_b64_tr_b16 v[134:135], v178 offset:58368
v_mfma_f32_16x16x32_bf16 v[124:127], v[156:159], a[108:111], v[124:127]
ds_read_b64_tr_b16 v[136:137], v179 offset:49152
s_add_u32 s3, s40, 128
v_mfma_f32_16x16x32_bf16 v[124:127], v[152:155], a[100:103], v[124:127]
ds_read_b64_tr_b16 v[138:139], v179 offset:50176
s_waitcnt lgkmcnt(6)
v_mfma_f32_16x16x32_bf16 v[80:83], a[4:7], a[112:115], v[80:83]
ds_read_b64_tr_b16 v[140:141], v179 offset:57344
s_and_b32 s3, s3, 2047
v_mfma_f32_16x16x32_bf16 v[80:83], a[0:3], a[120:123], v[80:83]
ds_read_b64_tr_b16 v[142:143], v179 offset:58368
s_add_u32 m0, s62, 131072
s_lshl_b32 s63, s67, 4
v_mfma_f32_16x16x32_bf16 v[84:87], a[0:3], a[124:127], v[84:87]
buffer_load_dwordx4 v236, s[92:95], s63 offen offset:0  lds
v_mfma_f32_16x16x32_bf16 v[84:87], a[4:7], a[116:119], v[84:87]
ds_read_b64_tr_b16 v[148:149], v180 offset:49152
ds_read_b64_tr_b16 v[150:151], v180 offset:50176
v_mfma_f32_16x16x32_bf16 v[88:91], a[12:15], a[112:115], v[88:91]
buffer_load_dwordx4 v237, s[92:95], s63 offen offset:1024  lds
v_mfma_f32_16x16x32_bf16 v[88:91], a[8:11], a[120:123], v[88:91]
ds_read_b64_tr_b16 v[144:145], v180 offset:57344
ds_read_b64_tr_b16 v[146:147], v180 offset:58368
v_mfma_f32_16x16x32_bf16 v[92:95], a[8:11], a[124:127], v[92:95]
ds_read_b64_tr_b16 v[156:157], v181 offset:49152
v_mfma_f32_16x16x32_bf16 v[92:95], a[12:15], a[116:119], v[92:95]
ds_read_b64_tr_b16 v[158:159], v181 offset:50176
s_waitcnt lgkmcnt(6)
v_mfma_f32_16x16x32_bf16 v[96:99], v[128:131], a[112:115], v[96:99]
s_waitcnt vmcnt(17)
s_barrier
v_mfma_f32_16x16x32_bf16 v[96:99], v[132:135], a[120:123], v[96:99]
ds_read_b64_tr_b16 v[152:153], v181 offset:57344
ds_read_b64_tr_b16 v[154:155], v181 offset:58368
v_mfma_f32_16x16x32_bf16 v[100:103], v[132:135], a[124:127], v[100:103]
ds_read_b64_tr_b16 a[0:1], v182 offset:0
s_add_u32 m0, s44, 32768
v_mfma_f32_16x16x32_bf16 v[100:103], v[128:131], a[116:119], v[100:103]
ds_read_b64_tr_b16 a[2:3], v182 offset:1024
s_mul_i32 s41, s3, 3584
v_mfma_f32_16x16x32_bf16 v[104:107], v[136:139], a[112:115], v[104:107]
buffer_load_dwordx4 v192, s[24:27], s41 offen offset:0  lds
v_mfma_f32_16x16x32_bf16 v[104:107], v[140:143], a[120:123], v[104:107]
ds_read_b64_tr_b16 a[4:5], v182 offset:8192
ds_read_b64_tr_b16 a[6:7], v182 offset:9216
v_mfma_f32_16x16x32_bf16 v[108:111], v[140:143], a[124:127], v[108:111]
buffer_load_dwordx4 v193, s[24:27], s41 offen offset:1024  lds
v_mfma_f32_16x16x32_bf16 v[108:111], v[136:139], a[116:119], v[108:111]
ds_read_b64_tr_b16 a[8:9], v183 offset:0
s_waitcnt lgkmcnt(5)
v_mfma_f32_16x16x32_bf16 v[112:115], v[148:151], a[112:115], v[112:115]
buffer_load_dwordx4 v194, s[24:27], s41 offen offset:2048  lds
v_mfma_f32_16x16x32_bf16 v[112:115], v[144:147], a[120:123], v[112:115]
ds_read_b64_tr_b16 a[10:11], v183 offset:1024
ds_read_b64_tr_b16 a[12:13], v183 offset:8192
ds_read_b64_tr_b16 a[14:15], v183 offset:9216
v_mfma_f32_16x16x32_bf16 v[116:119], v[144:147], a[124:127], v[116:119]
ds_read_b64_tr_b16 v[132:133], v184 offset:0
v_mfma_f32_16x16x32_bf16 v[116:119], v[148:151], a[116:119], v[116:119]
ds_read_b64_tr_b16 v[134:135], v184 offset:1024
v_mfma_f32_16x16x32_bf16 v[120:123], v[156:159], a[112:115], v[120:123]
buffer_load_dwordx4 v195, s[24:27], s41 offen offset:3072  lds
v_mfma_f32_16x16x32_bf16 v[120:123], v[152:155], a[120:123], v[120:123]
ds_read_b64_tr_b16 v[128:129], v184 offset:8192
ds_read_b64_tr_b16 v[130:131], v184 offset:9216
v_mfma_f32_16x16x32_bf16 v[124:127], v[152:155], a[124:127], v[124:127]
ds_read_b64_tr_b16 v[140:141], v185 offset:0
s_add_u32 s40, s3, 128
v_mfma_f32_16x16x32_bf16 v[124:127], v[156:159], a[116:119], v[124:127]
ds_read_b64_tr_b16 v[142:143], v185 offset:1024
s_waitcnt lgkmcnt(6)
v_mfma_f32_16x16x32_bf16 v[80:83], a[0:3], a[128:131], v[80:83]
ds_read_b64_tr_b16 v[136:137], v185 offset:8192
s_and_b32 s40, s40, 2047
v_mfma_f32_16x16x32_bf16 v[80:83], a[4:7], a[136:139], v[80:83]
ds_read_b64_tr_b16 v[138:139], v185 offset:9216
s_add_u32 m0, s62, 139264
s_lshl_b32 s63, s68, 4
v_mfma_f32_16x16x32_bf16 v[84:87], a[4:7], a[140:143], v[84:87]
buffer_load_dwordx4 v236, s[92:95], s63 offen offset:0  lds
v_mfma_f32_16x16x32_bf16 v[84:87], a[0:3], a[132:135], v[84:87]
ds_read_b64_tr_b16 v[144:145], v186 offset:0
ds_read_b64_tr_b16 v[146:147], v186 offset:1024
v_mfma_f32_16x16x32_bf16 v[88:91], a[8:11], a[128:131], v[88:91]
buffer_load_dwordx4 v237, s[92:95], s63 offen offset:1024  lds
v_mfma_f32_16x16x32_bf16 v[88:91], a[12:15], a[136:139], v[88:91]
ds_read_b64_tr_b16 v[148:149], v186 offset:8192
ds_read_b64_tr_b16 v[150:151], v186 offset:9216
v_mfma_f32_16x16x32_bf16 v[92:95], a[12:15], a[140:143], v[92:95]
ds_read_b64_tr_b16 v[152:153], v187 offset:0
v_mfma_f32_16x16x32_bf16 v[92:95], a[8:11], a[132:135], v[92:95]
ds_read_b64_tr_b16 v[154:155], v187 offset:1024
s_waitcnt lgkmcnt(6)
v_mfma_f32_16x16x32_bf16 v[96:99], v[132:135], a[128:131], v[96:99]
s_waitcnt vmcnt(14)
s_barrier
v_mfma_f32_16x16x32_bf16 v[96:99], v[128:131], a[136:139], v[96:99]
ds_read_b64_tr_b16 v[156:157], v187 offset:8192
ds_read_b64_tr_b16 v[158:159], v187 offset:9216
v_mfma_f32_16x16x32_bf16 v[100:103], v[128:131], a[140:143], v[100:103]
ds_read_b64_tr_b16 a[4:5], v176 offset:0
s_add_u32 m0, s44, 49152
v_mfma_f32_16x16x32_bf16 v[100:103], v[132:135], a[132:135], v[100:103]
ds_read_b64_tr_b16 a[6:7], v176 offset:1024
s_mul_i32 s41, s40, 3584
v_mfma_f32_16x16x32_bf16 v[104:107], v[140:143], a[128:131], v[104:107]
buffer_load_dwordx4 v192, s[24:27], s41 offen offset:0  lds
v_mfma_f32_16x16x32_bf16 v[104:107], v[136:139], a[136:139], v[104:107]
ds_read_b64_tr_b16 a[0:1], v176 offset:8192
ds_read_b64_tr_b16 a[2:3], v176 offset:9216
v_mfma_f32_16x16x32_bf16 v[108:111], v[136:139], a[140:143], v[108:111]
buffer_store_dwordx2 v[240:241], v1, s[32:35], s8 offen sc1
v_mfma_f32_16x16x32_bf16 v[108:111], v[140:143], a[132:135], v[108:111]
buffer_load_dwordx4 v193, s[24:27], s41 offen offset:1024  lds
s_waitcnt lgkmcnt(4)
v_mfma_f32_16x16x32_bf16 v[112:115], v[144:147], a[128:131], v[112:115]
ds_read_b64_tr_b16 a[12:13], v177 offset:0
ds_read_b64_tr_b16 a[14:15], v177 offset:1024
v_mfma_f32_16x16x32_bf16 v[112:115], v[148:151], a[136:139], v[112:115]
ds_read_b64_tr_b16 a[8:9], v177 offset:8192
ds_read_b64_tr_b16 a[10:11], v177 offset:9216
v_mfma_f32_16x16x32_bf16 v[116:119], v[148:151], a[140:143], v[116:119]
buffer_load_dwordx4 v194, s[24:27], s41 offen offset:2048  lds
v_mfma_f32_16x16x32_bf16 v[116:119], v[144:147], a[132:135], v[116:119]
ds_read_b64_tr_b16 v[128:129], v178 offset:0
ds_read_b64_tr_b16 v[130:131], v178 offset:1024
v_mfma_f32_16x16x32_bf16 v[120:123], v[152:155], a[128:131], v[120:123]
buffer_load_dwordx4 v195, s[24:27], s41 offen offset:3072  lds
v_mfma_f32_16x16x32_bf16 v[120:123], v[156:159], a[136:139], v[120:123]
ds_read_b64_tr_b16 v[132:133], v178 offset:8192
ds_read_b64_tr_b16 v[134:135], v178 offset:9216
v_mfma_f32_16x16x32_bf16 v[124:127], v[156:159], a[140:143], v[124:127]
ds_read_b64_tr_b16 v[136:137], v179 offset:0
s_add_u32 s3, s40, 128
v_mfma_f32_16x16x32_bf16 v[124:127], v[152:155], a[132:135], v[124:127]
ds_read_b64_tr_b16 v[138:139], v179 offset:1024
s_waitcnt lgkmcnt(6)
v_mfma_f32_16x16x32_bf16 v[80:83], a[4:7], a[144:147], v[80:83]
ds_read_b64_tr_b16 v[140:141], v179 offset:8192
s_and_b32 s3, s3, 2047
v_mfma_f32_16x16x32_bf16 v[80:83], a[0:3], a[152:155], v[80:83]
ds_read_b64_tr_b16 v[142:143], v179 offset:9216
s_add_u32 m0, s62, 147456
s_lshl_b32 s63, s69, 4
v_mfma_f32_16x16x32_bf16 v[84:87], a[0:3], a[156:159], v[84:87]
buffer_load_dwordx4 v236, s[92:95], s63 offen offset:0  lds
v_mfma_f32_16x16x32_bf16 v[84:87], a[4:7], a[148:151], v[84:87]
ds_read_b64_tr_b16 v[148:149], v180 offset:0
ds_read_b64_tr_b16 v[150:151], v180 offset:1024
v_mfma_f32_16x16x32_bf16 v[88:91], a[12:15], a[144:147], v[88:91]
buffer_load_dwordx4 v237, s[92:95], s63 offen offset:1024  lds
v_mfma_f32_16x16x32_bf16 v[88:91], a[8:11], a[152:155], v[88:91]
ds_read_b64_tr_b16 v[144:145], v180 offset:8192
ds_read_b64_tr_b16 v[146:147], v180 offset:9216
v_mfma_f32_16x16x32_bf16 v[92:95], a[8:11], a[156:159], v[92:95]
buffer_load_dword v2, v244, s[92:95], 0 offen
v_mfma_f32_16x16x32_bf16 v[92:95], a[12:15], a[148:151], v[92:95]
ds_read_b64_tr_b16 v[156:157], v181 offset:0
s_waitcnt lgkmcnt(5)
v_mfma_f32_16x16x32_bf16 v[96:99], v[128:131], a[144:147], v[96:99]
s_waitcnt vmcnt(16)
s_barrier
v_mfma_f32_16x16x32_bf16 v[96:99], v[132:135], a[152:155], v[96:99]
ds_read_b64_tr_b16 v[158:159], v181 offset:1024
ds_read_b64_tr_b16 v[152:153], v181 offset:8192
ds_read_b64_tr_b16 v[154:155], v181 offset:9216
v_mfma_f32_16x16x32_bf16 v[100:103], v[132:135], a[156:159], v[100:103]
ds_read_b64_tr_b16 a[0:1], v176 offset:16384
s_add_u32 m0, s44, 65536
v_mfma_f32_16x16x32_bf16 v[100:103], v[128:131], a[148:151], v[100:103]
ds_read_b64_tr_b16 a[2:3], v176 offset:17408
s_mul_i32 s41, s3, 3584
v_mfma_f32_16x16x32_bf16 v[104:107], v[136:139], a[144:147], v[104:107]
buffer_load_dwordx4 v192, s[24:27], s41 offen offset:0  lds
v_mfma_f32_16x16x32_bf16 v[104:107], v[140:143], a[152:155], v[104:107]
ds_read_b64_tr_b16 a[4:5], v176 offset:24576
ds_read_b64_tr_b16 a[6:7], v176 offset:25600
v_mfma_f32_16x16x32_bf16 v[108:111], v[140:143], a[156:159], v[108:111]
buffer_load_dwordx4 v193, s[24:27], s41 offen offset:1024  lds
v_mfma_f32_16x16x32_bf16 v[108:111], v[136:139], a[148:151], v[108:111]
ds_read_b64_tr_b16 a[8:9], v177 offset:16384
s_waitcnt lgkmcnt(5)
v_mfma_f32_16x16x32_bf16 v[112:115], v[148:151], a[144:147], v[112:115]
buffer_load_dwordx4 v194, s[24:27], s41 offen offset:2048  lds
v_mfma_f32_16x16x32_bf16 v[112:115], v[144:147], a[152:155], v[112:115]
ds_read_b64_tr_b16 a[10:11], v177 offset:17408
ds_read_b64_tr_b16 a[12:13], v177 offset:24576
ds_read_b64_tr_b16 a[14:15], v177 offset:25600
v_mfma_f32_16x16x32_bf16 v[116:119], v[144:147], a[156:159], v[116:119]
ds_read_b64_tr_b16 v[132:133], v178 offset:16384
v_mfma_f32_16x16x32_bf16 v[116:119], v[148:151], a[148:151], v[116:119]
ds_read_b64_tr_b16 v[134:135], v178 offset:17408
v_mfma_f32_16x16x32_bf16 v[120:123], v[156:159], a[144:147], v[120:123]
buffer_load_dwordx4 v195, s[24:27], s41 offen offset:3072  lds
v_mfma_f32_16x16x32_bf16 v[120:123], v[152:155], a[152:155], v[120:123]
ds_read_b64_tr_b16 v[128:129], v178 offset:24576
ds_read_b64_tr_b16 v[130:131], v178 offset:25600
v_mfma_f32_16x16x32_bf16 v[124:127], v[152:155], a[156:159], v[124:127]
ds_read_b64_tr_b16 v[140:141], v179 offset:16384
s_add_u32 s40, s3, 128
v_mfma_f32_16x16x32_bf16 v[124:127], v[156:159], a[148:151], v[124:127]
ds_read_b64_tr_b16 v[142:143], v179 offset:17408
s_waitcnt lgkmcnt(6)
v_mfma_f32_16x16x32_bf16 v[80:83], a[0:3], a[160:163], v[80:83]
ds_read_b64_tr_b16 v[136:137], v179 offset:24576
s_and_b32 s40, s40, 2047
v_mfma_f32_16x16x32_bf16 v[80:83], a[4:7], a[168:171], v[80:83]
ds_read_b64_tr_b16 v[138:139], v179 offset:25600
s_add_u32 m0, s62, 155648
s_lshl_b32 s63, s67, 4
v_mfma_f32_16x16x32_bf16 v[84:87], a[4:7], a[172:175], v[84:87]
buffer_load_dwordx4 v236, s[96:99], s63 offen offset:0  lds
v_mfma_f32_16x16x32_bf16 v[84:87], a[0:3], a[164:167], v[84:87]
ds_read_b64_tr_b16 v[144:145], v180 offset:16384
ds_read_b64_tr_b16 v[146:147], v180 offset:17408
v_mfma_f32_16x16x32_bf16 v[88:91], a[8:11], a[160:163], v[88:91]
buffer_load_dwordx4 v237, s[96:99], s63 offen offset:1024  lds
v_mfma_f32_16x16x32_bf16 v[88:91], a[12:15], a[168:171], v[88:91]
ds_read_b64_tr_b16 v[148:149], v180 offset:24576
ds_read_b64_tr_b16 v[150:151], v180 offset:25600
v_mfma_f32_16x16x32_bf16 v[92:95], a[12:15], a[172:175], v[92:95]
ds_read_b64_tr_b16 v[152:153], v181 offset:16384
v_mfma_f32_16x16x32_bf16 v[92:95], a[8:11], a[164:167], v[92:95]
ds_read_b64_tr_b16 v[154:155], v181 offset:17408
s_waitcnt lgkmcnt(6)
v_mfma_f32_16x16x32_bf16 v[96:99], v[132:135], a[160:163], v[96:99]
s_waitcnt vmcnt(16)
s_barrier
v_mfma_f32_16x16x32_bf16 v[96:99], v[128:131], a[168:171], v[96:99]
ds_read_b64_tr_b16 v[156:157], v181 offset:24576
ds_read_b64_tr_b16 v[158:159], v181 offset:25600
v_mfma_f32_16x16x32_bf16 v[100:103], v[128:131], a[172:175], v[100:103]
ds_read_b64_tr_b16 a[4:5], v176 offset:32768
s_add_u32 m0, s44, 0
v_mfma_f32_16x16x32_bf16 v[100:103], v[132:135], a[164:167], v[100:103]
ds_read_b64_tr_b16 a[6:7], v176 offset:33792
s_mul_i32 s41, s40, 3584
v_mfma_f32_16x16x32_bf16 v[104:107], v[140:143], a[160:163], v[104:107]
buffer_load_dwordx4 v192, s[24:27], s41 offen offset:0  lds
v_mfma_f32_16x16x32_bf16 v[104:107], v[136:139], a[168:171], v[104:107]
ds_read_b64_tr_b16 a[0:1], v176 offset:40960
ds_read_b64_tr_b16 a[2:3], v176 offset:41984
v_mfma_f32_16x16x32_bf16 v[108:111], v[136:139], a[172:175], v[108:111]
buffer_load_dwordx4 v193, s[24:27], s41 offen offset:1024  lds
v_mfma_f32_16x16x32_bf16 v[108:111], v[140:143], a[164:167], v[108:111]
ds_read_b64_tr_b16 a[12:13], v177 offset:32768
s_waitcnt lgkmcnt(5)
v_mfma_f32_16x16x32_bf16 v[112:115], v[144:147], a[160:163], v[112:115]
ds_read_b64_tr_b16 a[14:15], v177 offset:33792
ds_read_b64_tr_b16 a[8:9], v177 offset:40960
v_mfma_f32_16x16x32_bf16 v[112:115], v[148:151], a[168:171], v[112:115]
ds_read_b64_tr_b16 a[10:11], v177 offset:41984
v_mfma_f32_16x16x32_bf16 v[116:119], v[148:151], a[172:175], v[116:119]
ds_read_b64_tr_b16 v[128:129], v178 offset:32768
v_mfma_f32_16x16x32_bf16 v[116:119], v[144:147], a[164:167], v[116:119]
ds_read_b64_tr_b16 v[130:131], v178 offset:33792
v_mfma_f32_16x16x32_bf16 v[120:123], v[152:155], a[160:163], v[120:123]
buffer_load_dwordx4 v194, s[24:27], s41 offen offset:2048  lds
v_mfma_f32_16x16x32_bf16 v[120:123], v[156:159], a[168:171], v[120:123]
ds_read_b64_tr_b16 v[132:133], v178 offset:40960
ds_read_b64_tr_b16 v[134:135], v178 offset:41984
v_mfma_f32_16x16x32_bf16 v[124:127], v[156:159], a[172:175], v[124:127]
ds_read_b64_tr_b16 v[136:137], v179 offset:32768
v_mfma_f32_16x16x32_bf16 v[124:127], v[152:155], a[164:167], v[124:127]
ds_read_b64_tr_b16 v[138:139], v179 offset:33792
s_waitcnt lgkmcnt(6)
v_mfma_f32_16x16x32_bf16 v[80:83], a[4:7], a[176:179], v[80:83]
ds_read_b64_tr_b16 v[140:141], v179 offset:40960
v_mfma_f32_16x16x32_bf16 v[80:83], a[0:3], a[184:187], v[80:83]
ds_read_b64_tr_b16 v[142:143], v179 offset:41984
v_mfma_f32_16x16x32_bf16 v[84:87], a[0:3], a[188:191], v[84:87]
buffer_load_dwordx4 v195, s[24:27], s41 offen offset:3072  lds
v_mfma_f32_16x16x32_bf16 v[84:87], a[4:7], a[180:183], v[84:87]
ds_read_b64_tr_b16 v[148:149], v180 offset:32768
ds_read_b64_tr_b16 v[150:151], v180 offset:33792
v_mfma_f32_16x16x32_bf16 v[88:91], a[12:15], a[176:179], v[88:91]
ds_read_b64_tr_b16 v[144:145], v180 offset:40960
v_mfma_f32_16x16x32_bf16 v[88:91], a[8:11], a[184:187], v[88:91]
ds_read_b64_tr_b16 v[146:147], v180 offset:41984
s_add_u32 s3, s40, 128
v_mfma_f32_16x16x32_bf16 v[92:95], a[8:11], a[188:191], v[92:95]
ds_read_b64_tr_b16 v[156:157], v181 offset:32768
s_and_b32 s3, s3, 2047
v_mfma_f32_16x16x32_bf16 v[92:95], a[12:15], a[180:183], v[92:95]
ds_read_b64_tr_b16 v[158:159], v181 offset:33792
s_waitcnt lgkmcnt(6)
v_mfma_f32_16x16x32_bf16 v[96:99], v[128:131], a[176:179], v[96:99]
s_waitcnt vmcnt(13)
s_barrier
v_mfma_f32_16x16x32_bf16 v[96:99], v[132:135], a[184:187], v[96:99]
ds_read_b64_tr_b16 v[152:153], v181 offset:40960
ds_read_b64_tr_b16 v[154:155], v181 offset:41984
v_mfma_f32_16x16x32_bf16 v[100:103], v[132:135], a[188:191], v[100:103]
ds_read_b64_tr_b16 a[0:1], v176 offset:49152
s_add_u32 m0, s44, 16384
v_mfma_f32_16x16x32_bf16 v[100:103], v[128:131], a[180:183], v[100:103]
ds_read_b64_tr_b16 a[2:3], v176 offset:50176
s_mul_i32 s41, s3, 3584
v_mfma_f32_16x16x32_bf16 v[104:107], v[136:139], a[176:179], v[104:107]
buffer_load_dwordx4 v192, s[24:27], s41 offen offset:0  lds
v_mfma_f32_16x16x32_bf16 v[104:107], v[140:143], a[184:187], v[104:107]
ds_read_b64_tr_b16 a[4:5], v176 offset:57344
ds_read_b64_tr_b16 a[6:7], v176 offset:58368
v_mfma_f32_16x16x32_bf16 v[108:111], v[140:143], a[188:191], v[108:111]
buffer_load_dwordx4 v193, s[24:27], s41 offen offset:1024  lds
v_mfma_f32_16x16x32_bf16 v[108:111], v[136:139], a[180:183], v[108:111]
ds_read_b64_tr_b16 a[8:9], v177 offset:49152
s_waitcnt lgkmcnt(5)
v_mfma_f32_16x16x32_bf16 v[112:115], v[148:151], a[176:179], v[112:115]
ds_read_b64_tr_b16 a[10:11], v177 offset:50176
ds_read_b64_tr_b16 a[12:13], v177 offset:57344
v_mfma_f32_16x16x32_bf16 v[112:115], v[144:147], a[184:187], v[112:115]
ds_read_b64_tr_b16 a[14:15], v177 offset:58368
v_mfma_f32_16x16x32_bf16 v[116:119], v[144:147], a[188:191], v[116:119]
ds_read_b64_tr_b16 v[132:133], v178 offset:49152
v_mfma_f32_16x16x32_bf16 v[116:119], v[148:151], a[180:183], v[116:119]
ds_read_b64_tr_b16 v[134:135], v178 offset:50176
v_mfma_f32_16x16x32_bf16 v[120:123], v[156:159], a[176:179], v[120:123]
buffer_load_dwordx4 v194, s[24:27], s41 offen offset:2048  lds
v_mfma_f32_16x16x32_bf16 v[120:123], v[152:155], a[184:187], v[120:123]
ds_read_b64_tr_b16 v[128:129], v178 offset:57344
ds_read_b64_tr_b16 v[130:131], v178 offset:58368
v_mfma_f32_16x16x32_bf16 v[124:127], v[152:155], a[188:191], v[124:127]
ds_read_b64_tr_b16 v[140:141], v179 offset:49152
v_mfma_f32_16x16x32_bf16 v[124:127], v[156:159], a[180:183], v[124:127]
ds_read_b64_tr_b16 v[142:143], v179 offset:50176
s_waitcnt lgkmcnt(6)
v_mfma_f32_16x16x32_bf16 v[80:83], a[0:3], a[192:195], v[80:83]
ds_read_b64_tr_b16 v[136:137], v179 offset:57344
v_mfma_f32_16x16x32_bf16 v[80:83], a[4:7], a[200:203], v[80:83]
ds_read_b64_tr_b16 v[138:139], v179 offset:58368
v_mfma_f32_16x16x32_bf16 v[84:87], a[4:7], a[204:207], v[84:87]
buffer_load_dwordx4 v195, s[24:27], s41 offen offset:3072  lds
v_mfma_f32_16x16x32_bf16 v[84:87], a[0:3], a[196:199], v[84:87]
ds_read_b64_tr_b16 v[144:145], v180 offset:49152
ds_read_b64_tr_b16 v[146:147], v180 offset:50176
v_mfma_f32_16x16x32_bf16 v[88:91], a[8:11], a[192:195], v[88:91]
ds_read_b64_tr_b16 v[148:149], v180 offset:57344
v_mfma_f32_16x16x32_bf16 v[88:91], a[12:15], a[200:203], v[88:91]
ds_read_b64_tr_b16 v[150:151], v180 offset:58368
s_add_u32 s40, s3, 128
v_mfma_f32_16x16x32_bf16 v[92:95], a[12:15], a[204:207], v[92:95]
ds_read_b64_tr_b16 v[152:153], v181 offset:49152
s_and_b32 s40, s40, 2047
v_mfma_f32_16x16x32_bf16 v[92:95], a[8:11], a[196:199], v[92:95]
ds_read_b64_tr_b16 v[154:155], v181 offset:50176
s_waitcnt lgkmcnt(6)
v_mfma_f32_16x16x32_bf16 v[96:99], v[132:135], a[192:195], v[96:99]
s_waitcnt vmcnt(10)
s_barrier
v_mfma_f32_16x16x32_bf16 v[96:99], v[128:131], a[200:203], v[96:99]
ds_read_b64_tr_b16 v[156:157], v181 offset:57344
ds_read_b64_tr_b16 v[158:159], v181 offset:58368
v_mfma_f32_16x16x32_bf16 v[100:103], v[128:131], a[204:207], v[100:103]
ds_read_b64_tr_b16 a[4:5], v182 offset:0
s_add_u32 m0, s62, 32768
v_mfma_f32_16x16x32_bf16 v[100:103], v[132:135], a[196:199], v[100:103]
ds_read_b64_tr_b16 a[6:7], v182 offset:1024
s_lshl_b32 s63, s68, 4
v_mfma_f32_16x16x32_bf16 v[104:107], v[140:143], a[192:195], v[104:107]
buffer_load_dwordx4 v236, s[96:99], s63 offen offset:0  lds
v_mfma_f32_16x16x32_bf16 v[104:107], v[136:139], a[200:203], v[104:107]
ds_read_b64_tr_b16 a[0:1], v182 offset:8192
ds_read_b64_tr_b16 a[2:3], v182 offset:9216
v_mfma_f32_16x16x32_bf16 v[108:111], v[136:139], a[204:207], v[108:111]
buffer_load_dwordx2 v[242:243], v199, s[32:35], s8 offen sc1
v_mfma_f32_16x16x32_bf16 v[108:111], v[140:143], a[196:199], v[108:111]
ds_read_b64_tr_b16 a[12:13], v183 offset:0
s_waitcnt lgkmcnt(5)
v_mfma_f32_16x16x32_bf16 v[112:115], v[144:147], a[192:195], v[112:115]
buffer_load_dwordx4 v237, s[96:99], s63 offen offset:1024  lds
v_mfma_f32_16x16x32_bf16 v[112:115], v[148:151], a[200:203], v[112:115]
ds_read_b64_tr_b16 a[14:15], v183 offset:1024
ds_read_b64_tr_b16 a[8:9], v183 offset:8192
ds_read_b64_tr_b16 a[10:11], v183 offset:9216
v_mfma_f32_16x16x32_bf16 v[116:119], v[148:151], a[204:207], v[116:119]
ds_read_b64_tr_b16 v[128:129], v184 offset:0
s_add_u32 m0, s62, 40960
v_mfma_f32_16x16x32_bf16 v[116:119], v[144:147], a[196:199], v[116:119]
ds_read_b64_tr_b16 v[130:131], v184 offset:1024
s_lshl_b32 s63, s69, 4
v_mfma_f32_16x16x32_bf16 v[120:123], v[152:155], a[192:195], v[120:123]
buffer_load_dwordx4 v236, s[96:99], s63 offen offset:0  lds
v_mfma_f32_16x16x32_bf16 v[120:123], v[156:159], a[200:203], v[120:123]
ds_read_b64_tr_b16 v[132:133], v184 offset:8192
ds_read_b64_tr_b16 v[134:135], v184 offset:9216
v_mfma_f32_16x16x32_bf16 v[124:127], v[156:159], a[204:207], v[124:127]
ds_read_b64_tr_b16 v[136:137], v185 offset:0
v_mfma_f32_16x16x32_bf16 v[124:127], v[152:155], a[196:199], v[124:127]
ds_read_b64_tr_b16 v[138:139], v185 offset:1024
s_waitcnt lgkmcnt(6)
v_mfma_f32_16x16x32_bf16 v[80:83], a[4:7], a[208:211], v[80:83]
ds_read_b64_tr_b16 v[140:141], v185 offset:8192
v_mfma_f32_16x16x32_bf16 v[80:83], a[0:3], a[216:219], v[80:83]
ds_read_b64_tr_b16 v[142:143], v185 offset:9216
v_mfma_f32_16x16x32_bf16 v[84:87], a[0:3], a[220:223], v[84:87]
buffer_load_dwordx4 v237, s[96:99], s63 offen offset:1024  lds
v_mfma_f32_16x16x32_bf16 v[84:87], a[4:7], a[212:215], v[84:87]
ds_read_b64_tr_b16 v[148:149], v186 offset:0
ds_read_b64_tr_b16 v[150:151], v186 offset:1024
v_mfma_f32_16x16x32_bf16 v[88:91], a[12:15], a[208:211], v[88:91]
ds_read_b64_tr_b16 v[144:145], v186 offset:8192
v_mfma_f32_16x16x32_bf16 v[88:91], a[8:11], a[216:219], v[88:91]
ds_read_b64_tr_b16 v[146:147], v186 offset:9216
v_mfma_f32_16x16x32_bf16 v[92:95], a[8:11], a[220:223], v[92:95]
ds_read_b64_tr_b16 v[156:157], v187 offset:0
v_mfma_f32_16x16x32_bf16 v[92:95], a[12:15], a[212:215], v[92:95]
ds_read_b64_tr_b16 v[158:159], v187 offset:1024
s_waitcnt lgkmcnt(6)
v_mfma_f32_16x16x32_bf16 v[96:99], v[128:131], a[208:211], v[96:99]
s_waitcnt vmcnt(9)
s_barrier
v_mfma_f32_16x16x32_bf16 v[96:99], v[132:135], a[216:219], v[96:99]
ds_read_b64_tr_b16 v[152:153], v187 offset:8192
ds_read_b64_tr_b16 v[154:155], v187 offset:9216
v_mfma_f32_16x16x32_bf16 v[100:103], v[132:135], a[220:223], v[100:103]
ds_read_b64_tr_b16 a[0:1], v176 offset:0
s_add_u32 m0, s62, 49152
v_mfma_f32_16x16x32_bf16 v[100:103], v[128:131], a[212:215], v[100:103]
ds_read_b64_tr_b16 a[2:3], v176 offset:1024
s_lshl_b32 s63, s70, 4
v_mfma_f32_16x16x32_bf16 v[104:107], v[136:139], a[208:211], v[104:107]
buffer_load_dwordx4 v236, s[92:95], s63 offen offset:0  lds
v_mfma_f32_16x16x32_bf16 v[104:107], v[140:143], a[216:219], v[104:107]
ds_read_b64_tr_b16 a[4:5], v176 offset:8192
ds_read_b64_tr_b16 a[6:7], v176 offset:9216
v_mfma_f32_16x16x32_bf16 v[108:111], v[140:143], a[220:223], v[108:111]
buffer_load_dwordx4 v237, s[92:95], s63 offen offset:1024  lds
v_mfma_f32_16x16x32_bf16 v[108:111], v[136:139], a[212:215], v[108:111]
ds_read_b64_tr_b16 a[8:9], v177 offset:0
s_waitcnt lgkmcnt(5)
v_mfma_f32_16x16x32_bf16 v[112:115], v[148:151], a[208:211], v[112:115]
ds_read_b64_tr_b16 a[10:11], v177 offset:1024
ds_read_b64_tr_b16 a[12:13], v177 offset:8192
v_mfma_f32_16x16x32_bf16 v[112:115], v[144:147], a[216:219], v[112:115]
ds_read_b64_tr_b16 a[14:15], v177 offset:9216
v_mfma_f32_16x16x32_bf16 v[116:119], v[144:147], a[220:223], v[116:119]
ds_read_b64_tr_b16 v[132:133], v178 offset:0
s_add_u32 m0, s62, 57344
v_mfma_f32_16x16x32_bf16 v[116:119], v[148:151], a[212:215], v[116:119]
L_pg4:
s_cbranch_execz L_pg5
ds_read_b64_tr_b16 v[134:135], v178 offset:1024
v_mfma_f32_16x16x32_bf16 v[120:123], v[156:159], a[208:211], v[120:123]
ds_read_b64_tr_b16 v[128:129], v178 offset:8192
s_lshl_b32 s63, s71, 4
v_mfma_f32_16x16x32_bf16 v[120:123], v[152:155], a[216:219], v[120:123]
buffer_load_dwordx4 v236, s[92:95], s63 offen offset:0  lds
v_mfma_f32_16x16x32_bf16 v[124:127], v[152:155], a[220:223], v[124:127]
ds_read_b64_tr_b16 v[130:131], v178 offset:9216
ds_read_b64_tr_b16 v[140:141], v179 offset:0
v_mfma_f32_16x16x32_bf16 v[124:127], v[156:159], a[212:215], v[124:127]
ds_read_b64_tr_b16 v[142:143], v179 offset:1024
s_waitcnt lgkmcnt(6)
v_mfma_f32_16x16x32_bf16 v[80:83], a[0:3], a[224:227], v[80:83]
ds_read_b64_tr_b16 v[136:137], v179 offset:8192
v_mfma_f32_16x16x32_bf16 v[80:83], a[4:7], a[232:235], v[80:83]
ds_read_b64_tr_b16 v[138:139], v179 offset:9216
v_mfma_f32_16x16x32_bf16 v[84:87], a[4:7], a[236:239], v[84:87]
buffer_load_dwordx4 v237, s[92:95], s63 offen offset:1024  lds
v_mfma_f32_16x16x32_bf16 v[84:87], a[0:3], a[228:231], v[84:87]
ds_read_b64_tr_b16 v[144:145], v180 offset:0
ds_read_b64_tr_b16 v[146:147], v180 offset:1024
v_mfma_f32_16x16x32_bf16 v[88:91], a[8:11], a[224:227], v[88:91]
ds_read_b64_tr_b16 v[148:149], v180 offset:8192
v_mfma_f32_16x16x32_bf16 v[88:91], a[12:15], a[232:235], v[88:91]
ds_read_b64_tr_b16 v[150:151], v180 offset:9216
v_mfma_f32_16x16x32_bf16 v[92:95], a[12:15], a[236:239], v[92:95]
ds_read_b64_tr_b16 v[152:153], v181 offset:0
v_mfma_f32_16x16x32_bf16 v[92:95], a[8:11], a[228:231], v[92:95]
ds_read_b64_tr_b16 v[154:155], v181 offset:1024
s_waitcnt lgkmcnt(6)
v_mfma_f32_16x16x32_bf16 v[96:99], v[132:135], a[224:227], v[96:99]
s_waitcnt vmcnt(7)
v_cmp_ne_u64 vcc, s[54:55], v[242:243]
s_nop 1
s_cbranch_vccnz L_f1_slow
L_f1_ok:
s_waitcnt vmcnt(9)
s_barrier
v_mfma_f32_16x16x32_bf16 v[96:99], v[128:131], a[232:235], v[96:99]
ds_read_b64_tr_b16 v[156:157], v181 offset:8192
ds_read_b64_tr_b16 v[158:159], v181 offset:9216
v_mfma_f32_16x16x32_bf16 v[100:103], v[128:131], a[236:239], v[100:103]
buffer_load_dwordx4 a[32:35], v198, s[32:35], s66 offen sc1
v_mfma_f32_16x16x32_bf16 v[100:103], v[132:135], a[228:231], v[100:103]
ds_read_b64_tr_b16 a[4:5], v176 offset:16384
ds_read_b64_tr_b16 a[6:7], v176 offset:17408
v_mfma_f32_16x16x32_bf16 v[104:107], v[140:143], a[224:227], v[104:107]
buffer_load_dwordx4 a[36:39], v239, s[32:35], s66 offen sc1
v_mfma_f32_16x16x32_bf16 v[104:107], v[136:139], a[232:235], v[104:107]
ds_read_b64_tr_b16 a[0:1], v176 offset:24576
ds_read_b64_tr_b16 a[2:3], v176 offset:25600
v_mfma_f32_16x16x32_bf16 v[108:111], v[136:139], a[236:239], v[108:111]
buffer_load_dwordx4 a[40:43], v248, s[32:35], s66 offen sc1
v_mfma_f32_16x16x32_bf16 v[108:111], v[140:143], a[228:231], v[108:111]
ds_read_b64_tr_b16 a[12:13], v177 offset:16384
s_waitcnt lgkmcnt(5)
v_mfma_f32_16x16x32_bf16 v[112:115], v[144:147], a[224:227], v[112:115]
ds_read_b64_tr_b16 a[14:15], v177 offset:17408
ds_read_b64_tr_b16 a[8:9], v177 offset:24576
v_mfma_f32_16x16x32_bf16 v[112:115], v[148:151], a[232:235], v[112:115]
ds_read_b64_tr_b16 a[10:11], v177 offset:25600
v_mfma_f32_16x16x32_bf16 v[116:119], v[148:151], a[236:239], v[116:119]
buffer_load_dwordx4 a[44:47], v249, s[32:35], s66 offen sc1
v_mfma_f32_16x16x32_bf16 v[116:119], v[144:147], a[228:231], v[116:119]
ds_read_b64_tr_b16 v[128:129], v178 offset:16384
ds_read_b64_tr_b16 v[130:131], v178 offset:17408
v_mfma_f32_16x16x32_bf16 v[120:123], v[152:155], a[224:227], v[120:123]
buffer_load_dwordx4 a[48:51], v198, s[32:35], s67 offen sc1
v_mfma_f32_16x16x32_bf16 v[120:123], v[156:159], a[232:235], v[120:123]
ds_read_b64_tr_b16 v[132:133], v178 offset:24576
ds_read_b64_tr_b16 v[134:135], v178 offset:25600
v_mfma_f32_16x16x32_bf16 v[124:127], v[156:159], a[236:239], v[124:127]
ds_read_b64_tr_b16 v[136:137], v179 offset:16384
v_mfma_f32_16x16x32_bf16 v[124:127], v[152:155], a[228:231], v[124:127]
ds_read_b64_tr_b16 v[138:139], v179 offset:17408
s_waitcnt lgkmcnt(6)
v_mfma_f32_16x16x32_bf16 v[80:83], a[4:7], a[240:243], v[80:83]
buffer_load_dwordx4 a[52:55], v239, s[32:35], s67 offen sc1
v_mfma_f32_16x16x32_bf16 v[80:83], a[0:3], a[248:251], v[80:83]
ds_read_b64_tr_b16 v[140:141], v179 offset:24576
ds_read_b64_tr_b16 v[142:143], v179 offset:25600
v_mfma_f32_16x16x32_bf16 v[84:87], a[0:3], a[252:255], v[84:87]
buffer_load_dwordx4 a[56:59], v248, s[32:35], s67 offen sc1
v_mfma_f32_16x16x32_bf16 v[84:87], a[4:7], a[244:247], v[84:87]
ds_read_b64_tr_b16 v[148:149], v180 offset:16384
ds_read_b64_tr_b16 v[150:151], v180 offset:17408
v_mfma_f32_16x16x32_bf16 v[88:91], a[12:15], a[240:243], v[88:91]
ds_read_b64_tr_b16 v[144:145], v180 offset:24576
v_mfma_f32_16x16x32_bf16 v[88:91], a[8:11], a[248:251], v[88:91]
buffer_load_dwordx4 a[60:63], v249, s[32:35], s67 offen sc1
v_mfma_f32_16x16x32_bf16 v[92:95], a[8:11], a[252:255], v[92:95]
ds_read_b64_tr_b16 v[146:147], v180 offset:25600
ds_read_b64_tr_b16 v[156:157], v181 offset:16384
v_mfma_f32_16x16x32_bf16 v[92:95], a[12:15], a[244:247], v[92:95]
ds_read_b64_tr_b16 v[158:159], v181 offset:17408
s_waitcnt lgkmcnt(6)
v_mfma_f32_16x16x32_bf16 v[96:99], v[128:131], a[240:243], v[96:99]
s_waitcnt vmcnt(63)
s_barrier
v_mfma_f32_16x16x32_bf16 v[96:99], v[132:135], a[248:251], v[96:99]
ds_read_b64_tr_b16 v[152:153], v181 offset:24576
ds_read_b64_tr_b16 v[154:155], v181 offset:25600
v_mfma_f32_16x16x32_bf16 v[100:103], v[132:135], a[252:255], v[100:103]
buffer_load_dwordx4 a[64:67], v198, s[32:35], s68 offen sc1
v_mfma_f32_16x16x32_bf16 v[100:103], v[128:131], a[244:247], v[100:103]
ds_read_b64_tr_b16 a[0:1], v228 offset:16384
ds_read_b64_tr_b16 a[2:3], v228 offset:18432
v_mfma_f32_16x16x32_bf16 v[104:107], v[136:139], a[240:243], v[104:107]
buffer_load_dwordx4 a[68:71], v239, s[32:35], s68 offen sc1
v_mfma_f32_16x16x32_bf16 v[104:107], v[140:143], a[248:251], v[104:107]
ds_read_b64_tr_b16 a[4:5], v228 offset:20480
ds_read_b64_tr_b16 a[6:7], v228 offset:22528
v_mfma_f32_16x16x32_bf16 v[108:111], v[140:143], a[252:255], v[108:111]
ds_read_b64_tr_b16 a[8:9], v229 offset:16384
v_mfma_f32_16x16x32_bf16 v[108:111], v[136:139], a[244:247], v[108:111]
ds_read_b64_tr_b16 a[10:11], v229 offset:18432
s_waitcnt lgkmcnt(6)
v_mfma_f32_16x16x32_bf16 v[112:115], v[148:151], a[240:243], v[112:115]
buffer_load_dwordx4 a[72:75], v248, s[32:35], s68 offen sc1
v_mfma_f32_16x16x32_bf16 v[112:115], v[144:147], a[248:251], v[112:115]
ds_read_b64_tr_b16 a[12:13], v229 offset:20480
ds_read_b64_tr_b16 a[14:15], v229 offset:22528
v_mfma_f32_16x16x32_bf16 v[116:119], v[144:147], a[252:255], v[116:119]
ds_read_b64_tr_b16 v[132:133], v230 offset:16384
v_mfma_f32_16x16x32_bf16 v[116:119], v[148:151], a[244:247], v[116:119]
ds_read_b64_tr_b16 v[134:135], v230 offset:18432
v_mfma_f32_16x16x32_bf16 v[120:123], v[156:159], a[240:243], v[120:123]
buffer_load_dwordx4 a[76:79], v249, s[32:35], s68 offen sc1
v_mfma_f32_16x16x32_bf16 v[120:123], v[152:155], a[248:251], v[120:123]
ds_read_b64_tr_b16 v[128:129], v230 offset:20480
ds_read_b64_tr_b16 v[130:131], v230 offset:22528
v_mfma_f32_16x16x32_bf16 v[124:127], v[152:155], a[252:255], v[124:127]
ds_read_b64_tr_b16 v[140:141], v231 offset:16384
v_mfma_f32_16x16x32_bf16 v[124:127], v[156:159], a[244:247], v[124:127]
ds_read_b64_tr_b16 v[142:143], v231 offset:18432
s_waitcnt lgkmcnt(6)
v_mfma_f32_16x16x32_bf16 v[16:19], a[0:3], v[160:163], 0
buffer_load_dwordx4 a[80:83], v198, s[32:35], s69 offen sc1
v_mfma_f32_16x16x32_bf16 v[16:19], a[4:7], v[168:171], v[16:19]
ds_read_b64_tr_b16 v[136:137], v231 offset:20480
ds_read_b64_tr_b16 v[138:139], v231 offset:22528
v_mfma_f32_16x16x32_bf16 v[20:23], a[0:3], v[164:167], 0
ds_read_b64_tr_b16 v[144:145], v228 offset:40960
v_mfma_f32_16x16x32_bf16 v[20:23], a[4:7], v[172:175], v[20:23]
ds_read_b64_tr_b16 v[146:147], v228 offset:43008
v_mfma_f32_16x16x32_bf16 v[24:27], a[8:11], v[160:163], 0
buffer_load_dwordx4 a[84:87], v239, s[32:35], s69 offen sc1
v_mfma_f32_16x16x32_bf16 v[24:27], a[12:15], v[168:171], v[24:27]
s_nop 3
v_pk_mul_f32 v[200:201], v[80:81], s[56:57] op_sel_hi:[1,0]
v_pk_mul_f32 v[202:203], v[82:83], s[56:57] op_sel_hi:[1,0]
v_pk_mul_f32 v[204:205], v[88:89], s[56:57] op_sel_hi:[1,0]
v_pk_mul_f32 v[206:207], v[90:91], s[56:57] op_sel_hi:[1,0]
v_mfma_f32_16x16x32_bf16 v[28:31], a[8:11], v[164:167], 0
ds_read_b64_tr_b16 v[148:149], v228 offset:45056
ds_read_b64_tr_b16 v[150:151], v228 offset:47104
v_mfma_f32_16x16x32_bf16 v[28:31], a[12:15], v[172:175], v[28:31]
ds_read_b64_tr_b16 v[152:153], v229 offset:40960
s_waitcnt lgkmcnt(5)
v_mfma_f32_16x16x32_bf16 v[32:35], v[132:135], v[160:163], 0
v_exp_f32 v200, v200
v_exp_f32 v201, v201
v_exp_f32 v202, v202
v_exp_f32 v203, v203
v_exp_f32 v204, v204
v_exp_f32 v205, v205
v_exp_f32 v206, v206
v_exp_f32 v207, v207
v_pk_add_f32 v[200:201], v[200:201], 1.0 op_sel_hi:[1,0]
v_pk_add_f32 v[202:203], v[202:203], 1.0 op_sel_hi:[1,0]
v_pk_add_f32 v[204:205], v[204:205], 1.0 op_sel_hi:[1,0]
v_pk_add_f32 v[206:207], v[206:207], 1.0 op_sel_hi:[1,0]
v_rcp_f32 v200, v200
v_rcp_f32 v201, v201
v_rcp_f32 v202, v202
v_rcp_f32 v203, v203
v_rcp_f32 v204, v204
v_rcp_f32 v205, v205
v_rcp_f32 v206, v206
v_rcp_f32 v207, v207
v_pk_mul_f32 v[200:201], v[200:201], v[80:81]
v_pk_mul_f32 v[202:203], v[202:203], v[82:83]
v_pk_mul_f32 v[204:205], v[204:205], v[88:89]
v_pk_mul_f32 v[206:207], v[206:207], v[90:91]
v_pk_mul_f32 v[4:5], v[84:85], s[56:57] op_sel_hi:[1,0]
v_pk_mul_f32 v[6:7], v[86:87], s[56:57] op_sel_hi:[1,0]
v_pk_mul_f32 v[8:9], v[92:93], s[56:57] op_sel_hi:[1,0]
v_pk_mul_f32 v[10:11], v[94:95], s[56:57] op_sel_hi:[1,0]
v_cvt_pk_bf16_f32 v176, v200, v201
v_cvt_pk_bf16_f32 v177, v202, v203
v_cvt_pk_bf16_f32 v178, v204, v205
v_cvt_pk_bf16_f32 v179, v206, v207
v_mfma_f32_16x16x32_bf16 v[32:35], v[128:131], v[168:171], v[32:35]
ds_read_b64_tr_b16 v[154:155], v229 offset:43008
ds_read_b64_tr_b16 v[156:157], v229 offset:45056
ds_read_b64_tr_b16 v[158:159], v229 offset:47104
v_mfma_f32_16x16x32_bf16 v[36:39], v[132:135], v[164:167], 0
buffer_load_dwordx4 a[88:91], v248, s[32:35], s69 offen sc1
v_mfma_f32_16x16x32_bf16 v[36:39], v[128:131], v[172:175], v[36:39]
ds_read_b64_tr_b16 a[0:1], v230 offset:40960
ds_read_b64_tr_b16 a[2:3], v230 offset:43008
v_mfma_f32_16x16x32_bf16 v[40:43], v[140:143], v[160:163], 0
buffer_load_dwordx4 a[92:95], v249, s[32:35], s69 offen sc1
v_mfma_f32_16x16x32_bf16 v[40:43], v[136:139], v[168:171], v[40:43]
ds_read_b64_tr_b16 a[4:5], v230 offset:45056
ds_read_b64_tr_b16 a[6:7], v230 offset:47104
v_mfma_f32_16x16x32_bf16 v[44:47], v[140:143], v[164:167], 0
ds_read_b64_tr_b16 a[8:9], v231 offset:40960
v_mfma_f32_16x16x32_bf16 v[44:47], v[136:139], v[172:175], v[44:47]
ds_read_b64_tr_b16 a[10:11], v231 offset:43008
s_waitcnt lgkmcnt(6)
v_mfma_f32_16x16x32_bf16 v[48:51], v[144:147], v[160:163], 0
s_waitcnt vmcnt(63)
s_barrier
v_mfma_f32_16x16x32_bf16 v[48:51], v[148:151], v[168:171], v[48:51]
ds_read_b64_tr_b16 a[12:13], v231 offset:45056
ds_read_b64_tr_b16 a[14:15], v231 offset:47104
v_mfma_f32_16x16x32_bf16 v[52:55], v[144:147], v[164:167], 0
ds_read_b64_tr_b16 v[132:133], v228 offset:24576
s_add_u32 m0, s62, 65536
v_mfma_f32_16x16x32_bf16 v[52:55], v[148:151], v[172:175], v[52:55]
ds_read_b64_tr_b16 v[134:135], v228 offset:26624
s_lshl_b32 s63, s72, 4
v_mfma_f32_16x16x32_bf16 v[56:59], v[152:155], v[160:163], 0
buffer_load_dwordx4 v236, s[92:95], s63 offen offset:0  lds
v_mfma_f32_16x16x32_bf16 v[56:59], v[156:159], v[168:171], v[56:59]
ds_read_b64_tr_b16 v[128:129], v228 offset:28672
ds_read_b64_tr_b16 v[130:131], v228 offset:30720
v_mfma_f32_16x16x32_bf16 v[60:63], v[152:155], v[164:167], 0
buffer_load_dwordx4 v237, s[92:95], s63 offen offset:1024  lds
v_mfma_f32_16x16x32_bf16 v[60:63], v[156:159], v[172:175], v[60:63]
ds_read_b64_tr_b16 v[140:141], v229 offset:24576
s_waitcnt lgkmcnt(5)
v_mfma_f32_16x16x32_bf16 v[64:67], a[0:3], v[160:163], 0
buffer_load_dwordx4 a[96:99], v198, s[32:35], s70 offen sc1
v_mfma_f32_16x16x32_bf16 v[64:67], a[4:7], v[168:171], v[64:67]
ds_read_b64_tr_b16 v[142:143], v229 offset:26624
ds_read_b64_tr_b16 v[136:137], v229 offset:28672
ds_read_b64_tr_b16 v[138:139], v229 offset:30720
v_mfma_f32_16x16x32_bf16 v[68:71], a[0:3], v[164:167], 0
ds_read_b64_tr_b16 v[144:145], v230 offset:24576
v_mfma_f32_16x16x32_bf16 v[68:71], a[4:7], v[172:175], v[68:71]
ds_read_b64_tr_b16 v[146:147], v230 offset:26624
v_mfma_f32_16x16x32_bf16 v[72:75], a[8:11], v[160:163], 0
buffer_load_dwordx4 a[100:103], v239, s[32:35], s70 offen sc1
v_mfma_f32_16x16x32_bf16 v[72:75], a[12:15], v[168:171], v[72:75]
ds_read_b64_tr_b16 v[148:149], v230 offset:28672
ds_read_b64_tr_b16 v[150:151], v230 offset:30720
v_mfma_f32_16x16x32_bf16 v[76:79], a[8:11], v[164:167], 0
ds_read_b64_tr_b16 v[152:153], v231 offset:24576
v_mfma_f32_16x16x32_bf16 v[76:79], a[12:15], v[172:175], v[76:79]
buffer_store_dwordx4 v[176:179], v198, s[32:35], s60 offen sc1
v_exp_f32 v4, v4
v_exp_f32 v5, v5
v_exp_f32 v6, v6
v_exp_f32 v7, v7
v_exp_f32 v8, v8
v_exp_f32 v9, v9
v_exp_f32 v10, v10
v_exp_f32 v11, v11
v_pk_add_f32 v[4:5], v[4:5], 1.0 op_sel_hi:[1,0]
v_pk_add_f32 v[6:7], v[6:7], 1.0 op_sel_hi:[1,0]
v_pk_add_f32 v[8:9], v[8:9], 1.0 op_sel_hi:[1,0]
v_pk_add_f32 v[10:11], v[10:11], 1.0 op_sel_hi:[1,0]
v_rcp_f32 v4, v4
v_rcp_f32 v5, v5
v_rcp_f32 v6, v6
v_rcp_f32 v7, v7
v_rcp_f32 v8, v8
v_rcp_f32 v9, v9
v_rcp_f32 v10, v10
v_rcp_f32 v11, v11
v_pk_mul_f32 v[4:5], v[4:5], v[84:85]
v_pk_mul_f32 v[6:7], v[6:7], v[86:87]
v_pk_mul_f32 v[8:9], v[8:9], v[92:93]
v_pk_mul_f32 v[10:11], v[10:11], v[94:95]
v_pk_mul_f32 v[200:201], v[96:97], s[56:57] op_sel_hi:[1,0]
v_pk_mul_f32 v[202:203], v[98:99], s[56:57] op_sel_hi:[1,0]
v_pk_mul_f32 v[204:205], v[104:105], s[56:57] op_sel_hi:[1,0]
v_pk_mul_f32 v[206:207], v[106:107], s[56:57] op_sel_hi:[1,0]
v_cvt_pk_bf16_f32 v180, v4, v5
v_cvt_pk_bf16_f32 v181, v6, v7
v_cvt_pk_bf16_f32 v182, v8, v9
v_cvt_pk_bf16_f32 v183, v10, v11
s_waitcnt lgkmcnt(5)
v_mfma_f32_16x16x32_bf16 v[16:19], v[132:135], v[208:211], v[16:19]
buffer_load_dwordx4 a[104:107], v248, s[32:35], s70 offen sc1
v_mfma_f32_16x16x32_bf16 v[16:19], v[128:131], v[216:219], v[16:19]
ds_read_b64_tr_b16 v[154:155], v231 offset:26624
ds_read_b64_tr_b16 v[156:157], v231 offset:28672
ds_read_b64_tr_b16 v[158:159], v231 offset:30720
v_mfma_f32_16x16x32_bf16 v[20:23], v[128:131], v[220:223], v[20:23]
ds_read_b64_tr_b16 a[0:1], v228 offset:49152
v_mfma_f32_16x16x32_bf16 v[20:23], v[132:135], v[212:215], v[20:23]
ds_read_b64_tr_b16 a[2:3], v228 offset:51200
v_mfma_f32_16x16x32_bf16 v[24:27], v[140:143], v[208:211], v[24:27]
buffer_load_dwordx4 a[108:111], v249, s[32:35], s70 offen sc1
v_mfma_f32_16x16x32_bf16 v[24:27], v[136:139], v[216:219], v[24:27]
ds_read_b64_tr_b16 a[4:5], v228 offset:53248
ds_read_b64_tr_b16 a[6:7], v228 offset:55296
v_mfma_f32_16x16x32_bf16 v[28:31], v[136:139], v[220:223], v[28:31]
ds_read_b64_tr_b16 a[8:9], v229 offset:49152
s_add_u32 m0, s62, 73728
v_mfma_f32_16x16x32_bf16 v[28:31], v[140:143], v[212:215], v[28:31]
ds_read_b64_tr_b16 a[10:11], v229 offset:51200
s_waitcnt lgkmcnt(6)
v_mfma_f32_16x16x32_bf16 v[32:35], v[144:147], v[208:211], v[32:35]
ds_read_b64_tr_b16 a[12:13], v229 offset:53248
s_lshl_b32 s63, s70, 4
v_mfma_f32_16x16x32_bf16 v[32:35], v[148:151], v[216:219], v[32:35]
ds_read_b64_tr_b16 a[14:15], v229 offset:55296
v_mfma_f32_16x16x32_bf16 v[36:39], v[148:151], v[220:223], v[36:39]
buffer_load_dwordx4 v236, s[96:99], s63 offen offset:0  lds
v_mfma_f32_16x16x32_bf16 v[36:39], v[144:147], v[212:215], v[36:39]
ds_read_b64_tr_b16 v[128:129], v230 offset:49152
ds_read_b64_tr_b16 v[130:131], v230 offset:51200
v_mfma_f32_16x16x32_bf16 v[40:43], v[152:155], v[208:211], v[40:43]
buffer_load_dwordx4 v237, s[96:99], s63 offen offset:1024  lds
v_mfma_f32_16x16x32_bf16 v[40:43], v[156:159], v[216:219], v[40:43]
ds_read_b64_tr_b16 v[132:133], v230 offset:53248
ds_read_b64_tr_b16 v[134:135], v230 offset:55296
v_mfma_f32_16x16x32_bf16 v[44:47], v[156:159], v[220:223], v[44:47]
ds_read_b64_tr_b16 v[136:137], v231 offset:49152
v_mfma_f32_16x16x32_bf16 v[44:47], v[152:155], v[212:215], v[44:47]
ds_read_b64_tr_b16 v[138:139], v231 offset:51200
s_waitcnt lgkmcnt(6)
v_mfma_f32_16x16x32_bf16 v[48:51], a[0:3], v[208:211], v[48:51]
s_waitcnt vmcnt(21)
s_barrier
v_mfma_f32_16x16x32_bf16 v[48:51], a[4:7], v[216:219], v[48:51]
ds_read_b64_tr_b16 v[140:141], v231 offset:53248
ds_read_b64_tr_b16 v[142:143], v231 offset:55296
v_mfma_f32_16x16x32_bf16 v[52:55], a[4:7], v[220:223], v[52:55]
ds_read_b64_tr_b16 v[148:149], v228 offset:32768
s_add_u32 m0, s62, 0
v_mfma_f32_16x16x32_bf16 v[52:55], a[0:3], v[212:215], v[52:55]
ds_read_b64_tr_b16 v[150:151], v228 offset:34816
s_lshl_b32 s63, s71, 4
v_mfma_f32_16x16x32_bf16 v[56:59], a[8:11], v[208:211], v[56:59]
buffer_load_dwordx4 v236, s[96:99], s63 offen offset:0  lds
v_mfma_f32_16x16x32_bf16 v[56:59], a[12:15], v[216:219], v[56:59]
ds_read_b64_tr_b16 v[144:145], v228 offset:36864
ds_read_b64_tr_b16 v[146:147], v228 offset:38912
v_mfma_f32_16x16x32_bf16 v[60:63], a[12:15], v[220:223], v[60:63]
buffer_store_dwordx4 v[180:183], v239, s[32:35], s60 offen sc1
v_exp_f32 v200, v200
v_exp_f32 v201, v201
v_exp_f32 v202, v202
v_exp_f32 v203, v203
v_exp_f32 v204, v204
v_exp_f32 v205, v205
v_exp_f32 v206, v206
v_exp_f32 v207, v207
v_pk_add_f32 v[200:201], v[200:201], 1.0 op_sel_hi:[1,0]
v_pk_add_f32 v[202:203], v[202:203], 1.0 op_sel_hi:[1,0]
v_pk_add_f32 v[204:205], v[204:205], 1.0 op_sel_hi:[1,0]
v_pk_add_f32 v[206:207], v[206:207], 1.0 op_sel_hi:[1,0]
v_rcp_f32 v200, v200
v_rcp_f32 v201, v201
v_rcp_f32 v202, v202
v_rcp_f32 v203, v203
v_rcp_f32 v204, v204
v_rcp_f32 v205, v205
v_rcp_f32 v206, v206
v_rcp_f32 v207, v207
v_pk_mul_f32 v[200:201], v[200:201], v[96:97]
v_pk_mul_f32 v[202:203], v[202:203], v[98:99]
v_pk_mul_f32 v[204:205], v[204:205], v[104:105]
v_pk_mul_f32 v[206:207], v[206:207], v[106:107]
v_pk_mul_f32 v[4:5], v[100:101], s[56:57] op_sel_hi:[1,0]
v_pk_mul_f32 v[6:7], v[102:103], s[56:57] op_sel_hi:[1,0]
v_pk_mul_f32 v[8:9], v[108:109], s[56:57] op_sel_hi:[1,0]
v_pk_mul_f32 v[10:11], v[110:111], s[56:57] op_sel_hi:[1,0]
v_cvt_pk_bf16_f32 v184, v200, v201
v_cvt_pk_bf16_f32 v185, v202, v203
v_cvt_pk_bf16_f32 v186, v204, v205
v_cvt_pk_bf16_f32 v187, v206, v207
v_mfma_f32_16x16x32_bf16 v[60:63], a[8:11], v[212:215], v[60:63]
buffer_load_dwordx4 v237, s[96:99], s63 offen offset:1024  lds
s_waitcnt lgkmcnt(4)
v_mfma_f32_16x16x32_bf16 v[64:67], v[128:131], v[208:211], v[64:67]
ds_read_b64_tr_b16 v[156:157], v229 offset:32768
ds_read_b64_tr_b16 v[158:159], v229 offset:34816
v_mfma_f32_16x16x32_bf16 v[64:67], v[132:135], v[216:219], v[64:67]
ds_read_b64_tr_b16 v[152:153], v229 offset:36864
ds_read_b64_tr_b16 v[154:155], v229 offset:38912
s_add_u32 m0, s62, 8192
s_lshl_b32 s63, s72, 4
v_mfma_f32_16x16x32_bf16 v[68:71], v[132:135], v[220:223], v[68:71]
buffer_load_dwordx4 v236, s[96:99], s63 offen offset:0  lds
v_mfma_f32_16x16x32_bf16 v[68:71], v[128:131], v[212:215], v[68:71]
ds_read_b64_tr_b16 a[4:5], v230 offset:32768
ds_read_b64_tr_b16 a[6:7], v230 offset:34816
v_mfma_f32_16x16x32_bf16 v[72:75], v[136:139], v[208:211], v[72:75]
buffer_load_dwordx4 v237, s[96:99], s63 offen offset:1024  lds
v_mfma_f32_16x16x32_bf16 v[72:75], v[140:143], v[216:219], v[72:75]
ds_read_b64_tr_b16 a[0:1], v230 offset:36864
ds_read_b64_tr_b16 a[2:3], v230 offset:38912
v_mfma_f32_16x16x32_bf16 v[76:79], v[140:143], v[220:223], v[76:79]
ds_read_b64_tr_b16 a[12:13], v231 offset:32768
v_mfma_f32_16x16x32_bf16 v[76:79], v[136:139], v[212:215], v[76:79]
ds_read_b64_tr_b16 a[14:15], v231 offset:34816
s_waitcnt lgkmcnt(6)
v_mfma_f32_16x16x32_bf16 v[16:19], v[148:151], a[32:35], v[16:19]
buffer_load_dwordx4 a[112:115], v198, s[32:35], s71 offen sc1
v_mfma_f32_16x16x32_bf16 v[16:19], v[144:147], a[40:43], v[16:19]
ds_read_b64_tr_b16 a[8:9], v231 offset:36864
ds_read_b64_tr_b16 a[10:11], v231 offset:38912
v_mfma_f32_16x16x32_bf16 v[20:23], v[144:147], a[44:47], v[20:23]
ds_read_b64_tr_b16 v[132:133], v228 offset:57344
v_mfma_f32_16x16x32_bf16 v[20:23], v[148:151], a[36:39], v[20:23]
ds_read_b64_tr_b16 v[134:135], v228 offset:59392
v_mfma_f32_16x16x32_bf16 v[24:27], v[156:159], a[32:35], v[24:27]
buffer_load_dwordx4 a[116:119], v239, s[32:35], s71 offen sc1
v_mfma_f32_16x16x32_bf16 v[24:27], v[152:155], a[40:43], v[24:27]
ds_read_b64_tr_b16 v[128:129], v228 offset:61440
ds_read_b64_tr_b16 v[130:131], v228 offset:63488
v_mfma_f32_16x16x32_bf16 v[28:31], v[152:155], a[44:47], v[28:31]
ds_read_b64_tr_b16 v[140:141], v229 offset:57344
v_mfma_f32_16x16x32_bf16 v[28:31], v[156:159], a[36:39], v[28:31]
ds_read_b64_tr_b16 v[142:143], v229 offset:59392
s_waitcnt lgkmcnt(6)
v_mfma_f32_16x16x32_bf16 v[32:35], a[4:7], a[32:35], v[32:35]
buffer_load_dwordx4 a[120:123], v248, s[32:35], s71 offen sc1
v_mfma_f32_16x16x32_bf16 v[32:35], a[0:3], a[40:43], v[32:35]
ds_read_b64_tr_b16 v[136:137], v229 offset:61440
ds_read_b64_tr_b16 v[138:139], v229 offset:63488
v_mfma_f32_16x16x32_bf16 v[36:39], a[0:3], a[44:47], v[36:39]
ds_read_b64_tr_b16 v[144:145], v230 offset:57344
v_mfma_f32_16x16x32_bf16 v[36:39], a[4:7], a[36:39], v[36:39]
ds_read_b64_tr_b16 v[146:147], v230 offset:59392
v_mfma_f32_16x16x32_bf16 v[40:43], a[12:15], a[32:35], v[40:43]
buffer_load_dwordx4 a[124:127], v249, s[32:35], s71 offen sc1
v_mfma_f32_16x16x32_bf16 v[40:43], a[8:11], a[40:43], v[40:43]
buffer_store_dwordx4 v[184:187], v248, s[32:35], s60 offen sc1
v_exp_f32 v4, v4
v_exp_f32 v5, v5
v_exp_f32 v6, v6
v_exp_f32 v7, v7
v_exp_f32 v8, v8
v_exp_f32 v9, v9
v_exp_f32 v10, v10
v_exp_f32 v11, v11
v_pk_add_f32 v[4:5], v[4:5], 1.0 op_sel_hi:[1,0]
v_pk_add_f32 v[6:7], v[6:7], 1.0 op_sel_hi:[1,0]
v_pk_add_f32 v[8:9], v[8:9], 1.0 op_sel_hi:[1,0]
v_pk_add_f32 v[10:11], v[10:11], 1.0 op_sel_hi:[1,0]
v_rcp_f32 v4, v4
v_rcp_f32 v5, v5
v_rcp_f32 v6, v6
v_rcp_f32 v7, v7
v_rcp_f32 v8, v8
v_rcp_f32 v9, v9
v_rcp_f32 v10, v10
v_rcp_f32 v11, v11
v_pk_mul_f32 v[4:5], v[4:5], v[100:101]
v_pk_mul_f32 v[6:7], v[6:7], v[102:103]
v_pk_mul_f32 v[8:9], v[8:9], v[108:109]
v_pk_mul_f32 v[10:11], v[10:11], v[110:111]
v_pk_mul_f32 v[200:201], v[112:113], s[56:57] op_sel_hi:[1,0]
v_pk_mul_f32 v[202:203], v[114:115], s[56:57] op_sel_hi:[1,0]
v_pk_mul_f32 v[204:205], v[120:121], s[56:57] op_sel_hi:[1,0]
v_pk_mul_f32 v[206:207], v[122:123], s[56:57] op_sel_hi:[1,0]
v_cvt_pk_bf16_f32 v188, v4, v5
v_cvt_pk_bf16_f32 v189, v6, v7
v_cvt_pk_bf16_f32 v190, v8, v9
v_cvt_pk_bf16_f32 v191, v10, v11
v_mfma_f32_16x16x32_bf16 v[44:47], a[8:11], a[44:47], v[44:47]
ds_read_b64_tr_b16 v[148:149], v230 offset:61440
ds_read_b64_tr_b16 v[150:151], v230 offset:63488
v_mfma_f32_16x16x32_bf16 v[44:47], a[12:15], a[36:39], v[44:47]
ds_read_b64_tr_b16 v[152:153], v231 offset:57344
s_waitcnt lgkmcnt(5)
v_mfma_f32_16x16x32_bf16 v[48:51], v[132:135], a[32:35], v[48:51]
s_waitcnt vmcnt(27)
s_barrier
v_mfma_f32_16x16x32_bf16 v[48:51], v[128:131], a[40:43], v[48:51]
ds_read_b64_tr_b16 v[154:155], v231 offset:59392
ds_read_b64_tr_b16 v[156:157], v231 offset:61440
ds_read_b64_tr_b16 v[158:159], v231 offset:63488
v_mfma_f32_16x16x32_bf16 v[52:55], v[128:131], a[44:47], v[52:55]
buffer_load_dwordx4 a[128:131], v198, s[32:35], s72 offen sc1
v_mfma_f32_16x16x32_bf16 v[52:55], v[132:135], a[36:39], v[52:55]
ds_read_b64_tr_b16 a[0:1], v232 offset:0
ds_read_b64_tr_b16 a[2:3], v232 offset:2048
v_mfma_f32_16x16x32_bf16 v[56:59], v[140:143], a[32:35], v[56:59]
buffer_load_dwordx4 a[132:135], v239, s[32:35], s72 offen sc1
v_mfma_f32_16x16x32_bf16 v[56:59], v[136:139], a[40:43], v[56:59]
ds_read_b64_tr_b16 a[4:5], v232 offset:4096
ds_read_b64_tr_b16 a[6:7], v232 offset:6144
v_mfma_f32_16x16x32_bf16 v[60:63], v[136:139], a[44:47], v[60:63]
ds_read_b64_tr_b16 a[8:9], v233 offset:0
v_mfma_f32_16x16x32_bf16 v[60:63], v[140:143], a[36:39], v[60:63]
ds_read_b64_tr_b16 a[10:11], v233 offset:2048
s_waitcnt lgkmcnt(6)
v_mfma_f32_16x16x32_bf16 v[64:67], v[144:147], a[32:35], v[64:67]
buffer_load_dwordx4 a[136:139], v248, s[32:35], s72 offen sc1
v_mfma_f32_16x16x32_bf16 v[64:67], v[148:151], a[40:43], v[64:67]
ds_read_b64_tr_b16 a[12:13], v233 offset:4096
ds_read_b64_tr_b16 a[14:15], v233 offset:6144
v_mfma_f32_16x16x32_bf16 v[68:71], v[148:151], a[44:47], v[68:71]
ds_read_b64_tr_b16 v[128:129], v234 offset:0
v_mfma_f32_16x16x32_bf16 v[68:71], v[144:147], a[36:39], v[68:71]
ds_read_b64_tr_b16 v[130:131], v234 offset:2048
v_mfma_f32_16x16x32_bf16 v[72:75], v[152:155], a[32:35], v[72:75]
buffer_load_dwordx4 a[140:143], v249, s[32:35], s72 offen sc1
v_mfma_f32_16x16x32_bf16 v[72:75], v[156:159], a[40:43], v[72:75]
ds_read_b64_tr_b16 v[132:133], v234 offset:4096
ds_read_b64_tr_b16 v[134:135], v234 offset:6144
v_mfma_f32_16x16x32_bf16 v[76:79], v[156:159], a[44:47], v[76:79]
ds_read_b64_tr_b16 v[136:137], v235 offset:0
s_add_u32 m0, s62, 16384
v_mfma_f32_16x16x32_bf16 v[76:79], v[152:155], a[36:39], v[76:79]
ds_read_b64_tr_b16 v[138:139], v235 offset:2048
s_waitcnt lgkmcnt(6)
v_mfma_f32_16x16x32_bf16 v[16:19], a[0:3], a[48:51], v[16:19]
ds_read_b64_tr_b16 v[140:141], v235 offset:4096
s_lshl_b32 s63, s73, 4
v_mfma_f32_16x16x32_bf16 v[16:19], a[4:7], a[56:59], v[16:19]
ds_read_b64_tr_b16 v[142:143], v235 offset:6144
v_mfma_f32_16x16x32_bf16 v[20:23], a[4:7], a[60:63], v[20:23]
buffer_load_dwordx4 v236, s[92:95], s63 offen offset:0  lds
v_mfma_f32_16x16x32_bf16 v[20:23], a[0:3], a[52:55], v[20:23]
ds_read_b64_tr_b16 v[148:149], v232 offset:24576
ds_read_b64_tr_b16 v[150:151], v232 offset:26624
v_mfma_f32_16x16x32_bf16 v[24:27], a[8:11], a[48:51], v[24:27]
buffer_store_dwordx4 v[188:191], v249, s[32:35], s60 offen sc1
v_exp_f32 v200, v200
v_exp_f32 v201, v201
v_exp_f32 v202, v202
v_exp_f32 v203, v203
v_exp_f32 v204, v204
v_exp_f32 v205, v205
v_exp_f32 v206, v206
v_exp_f32 v207, v207
v_pk_add_f32 v[200:201], v[200:201], 1.0 op_sel_hi:[1,0]
v_pk_add_f32 v[202:203], v[202:203], 1.0 op_sel_hi:[1,0]
v_pk_add_f32 v[204:205], v[204:205], 1.0 op_sel_hi:[1,0]
v_pk_add_f32 v[206:207], v[206:207], 1.0 op_sel_hi:[1,0]
v_rcp_f32 v200, v200
v_rcp_f32 v201, v201
v_rcp_f32 v202, v202
v_rcp_f32 v203, v203
v_rcp_f32 v204, v204
v_rcp_f32 v205, v205
v_rcp_f32 v206, v206
v_rcp_f32 v207, v207
v_pk_mul_f32 v[200:201], v[200:201], v[112:113]
v_pk_mul_f32 v[202:203], v[202:203], v[114:115]
v_pk_mul_f32 v[204:205], v[204:205], v[120:121]
v_pk_mul_f32 v[206:207], v[206:207], v[122:123]
v_pk_mul_f32 v[4:5], v[116:117], s[56:57] op_sel_hi:[1,0]
v_pk_mul_f32 v[6:7], v[118:119], s[56:57] op_sel_hi:[1,0]
v_pk_mul_f32 v[8:9], v[124:125], s[56:57] op_sel_hi:[1,0]
v_pk_mul_f32 v[10:11], v[126:127], s[56:57] op_sel_hi:[1,0]
v_cvt_pk_bf16_f32 v192, v200, v201
v_cvt_pk_bf16_f32 v193, v202, v203
v_cvt_pk_bf16_f32 v194, v204, v205
v_cvt_pk_bf16_f32 v195, v206, v207
v_mfma_f32_16x16x32_bf16 v[24:27], a[12:15], a[56:59], v[24:27]
buffer_load_dwordx4 v237, s[92:95], s63 offen offset:1024  lds
v_mfma_f32_16x16x32_bf16 v[28:31], a[12:15], a[60:63], v[28:31]
ds_read_b64_tr_b16 v[144:145], v232 offset:28672
ds_read_b64_tr_b16 v[146:147], v232 offset:30720
v_mfma_f32_16x16x32_bf16 v[28:31], a[8:11], a[52:55], v[28:31]
ds_read_b64_tr_b16 v[156:157], v233 offset:24576
s_waitcnt lgkmcnt(5)
v_mfma_f32_16x16x32_bf16 v[32:35], v[128:131], a[48:51], v[32:35]
ds_read_b64_tr_b16 v[158:159], v233 offset:26624
ds_read_b64_tr_b16 v[152:153], v233 offset:28672
v_mfma_f32_16x16x32_bf16 v[32:35], v[132:135], a[56:59], v[32:35]
ds_read_b64_tr_b16 v[154:155], v233 offset:30720
s_add_u32 m0, s62, 24576
s_lshl_b32 s63, s74, 4
v_mfma_f32_16x16x32_bf16 v[36:39], v[132:135], a[60:63], v[36:39]
L_pg5:
s_cbranch_execz L_pg_ret
ds_read_b64_tr_b16 a[4:5], v234 offset:24576
v_mfma_f32_16x16x32_bf16 v[36:39], v[128:131], a[52:55], v[36:39]
buffer_load_dwordx4 v236, s[92:95], s63 offen offset:0  lds
v_mfma_f32_16x16x32_bf16 v[40:43], v[136:139], a[48:51], v[40:43]
ds_read_b64_tr_b16 a[6:7], v234 offset:26624
ds_read_b64_tr_b16 a[0:1], v234 offset:28672
v_mfma_f32_16x16x32_bf16 v[40:43], v[140:143], a[56:59], v[40:43]
buffer_load_dwordx4 v237, s[92:95], s63 offen offset:1024  lds
v_mfma_f32_16x16x32_bf16 v[44:47], v[140:143], a[60:63], v[44:47]
ds_read_b64_tr_b16 a[2:3], v234 offset:30720
ds_read_b64_tr_b16 a[12:13], v235 offset:24576
v_mfma_f32_16x16x32_bf16 v[44:47], v[136:139], a[52:55], v[44:47]
ds_read_b64_tr_b16 a[14:15], v235 offset:26624
s_waitcnt lgkmcnt(6)
v_mfma_f32_16x16x32_bf16 v[48:51], v[148:151], a[48:51], v[48:51]
s_waitcnt vmcnt(32)
s_barrier
v_mfma_f32_16x16x32_bf16 v[48:51], v[144:147], a[56:59], v[48:51]
ds_read_b64_tr_b16 a[8:9], v235 offset:28672
ds_read_b64_tr_b16 a[10:11], v235 offset:30720
v_mfma_f32_16x16x32_bf16 v[52:55], v[144:147], a[60:63], v[52:55]
ds_read_b64_tr_b16 v[132:133], v232 offset:8192
s_add_u32 m0, s62, 81920
v_mfma_f32_16x16x32_bf16 v[52:55], v[148:151], a[52:55], v[52:55]
ds_read_b64_tr_b16 v[134:135], v232 offset:10240
s_lshl_b32 s63, s75, 4
v_mfma_f32_16x16x32_bf16 v[56:59], v[156:159], a[48:51], v[56:59]
buffer_load_dwordx4 v236, s[92:95], s63 offen offset:0  lds
v_mfma_f32_16x16x32_bf16 v[56:59], v[152:155], a[56:59], v[56:59]
ds_read_b64_tr_b16 v[128:129], v232 offset:12288
ds_read_b64_tr_b16 v[130:131], v232 offset:14336
v_mfma_f32_16x16x32_bf16 v[60:63], v[152:155], a[60:63], v[60:63]
buffer_load_dwordx4 v237, s[92:95], s63 offen offset:1024  lds
v_mfma_f32_16x16x32_bf16 v[60:63], v[156:159], a[52:55], v[60:63]
ds_read_b64_tr_b16 v[140:141], v233 offset:8192
s_waitcnt lgkmcnt(5)
v_mfma_f32_16x16x32_bf16 v[64:67], a[4:7], a[48:51], v[64:67]
buffer_load_dwordx4 a[144:147], v198, s[32:35], s73 offen sc1
v_mfma_f32_16x16x32_bf16 v[64:67], a[0:3], a[56:59], v[64:67]
ds_read_b64_tr_b16 v[142:143], v233 offset:10240
ds_read_b64_tr_b16 v[136:137], v233 offset:12288
ds_read_b64_tr_b16 v[138:139], v233 offset:14336
v_mfma_f32_16x16x32_bf16 v[68:71], a[0:3], a[60:63], v[68:71]
buffer_load_dwordx4 a[148:151], v239, s[32:35], s73 offen sc1
v_mfma_f32_16x16x32_bf16 v[68:71], a[4:7], a[52:55], v[68:71]
ds_read_b64_tr_b16 v[144:145], v234 offset:8192
ds_read_b64_tr_b16 v[146:147], v234 offset:10240
v_mfma_f32_16x16x32_bf16 v[72:75], a[12:15], a[48:51], v[72:75]
buffer_store_dwordx4 v[192:195], v198, s[32:35], s61 offen sc1
v_exp_f32 v4, v4
v_exp_f32 v5, v5
v_exp_f32 v6, v6
v_exp_f32 v7, v7
v_exp_f32 v8, v8
v_exp_f32 v9, v9
v_exp_f32 v10, v10
v_exp_f32 v11, v11
v_pk_add_f32 v[4:5], v[4:5], 1.0 op_sel_hi:[1,0]
v_pk_add_f32 v[6:7], v[6:7], 1.0 op_sel_hi:[1,0]
v_pk_add_f32 v[8:9], v[8:9], 1.0 op_sel_hi:[1,0]
v_pk_add_f32 v[10:11], v[10:11], 1.0 op_sel_hi:[1,0]
v_rcp_f32 v4, v4
v_rcp_f32 v5, v5
v_rcp_f32 v6, v6
v_rcp_f32 v7, v7
v_rcp_f32 v8, v8
v_rcp_f32 v9, v9
v_rcp_f32 v10, v10
v_rcp_f32 v11, v11
v_pk_mul_f32 v[4:5], v[4:5], v[116:117]
v_pk_mul_f32 v[6:7], v[6:7], v[118:119]
v_pk_mul_f32 v[8:9], v[8:9], v[124:125]
v_pk_mul_f32 v[10:11], v[10:11], v[126:127]
v_cvt_pk_bf16_f32 v12, v4, v5
v_cvt_pk_bf16_f32 v13, v6, v7
v_cvt_pk_bf16_f32 v14, v8, v9
v_cvt_pk_bf16_f32 v15, v10, v11
v_mfma_f32_16x16x32_bf16 v[72:75], a[8:11], a[56:59], v[72:75]
buffer_load_dwordx4 a[152:155], v248, s[32:35], s73 offen sc1
v_mfma_f32_16x16x32_bf16 v[76:79], a[8:11], a[60:63], v[76:79]
buffer_store_dwordx4 v[12:15], v239, s[32:35], s61 offen sc1
v_mfma_f32_16x16x32_bf16 v[76:79], a[12:15], a[52:55], v[76:79]
ds_read_b64_tr_b16 v[148:149], v234 offset:12288
s_waitcnt lgkmcnt(3)
v_mfma_f32_16x16x32_bf16 v[16:19], v[132:135], a[64:67], v[16:19]
ds_read_b64_tr_b16 v[150:151], v234 offset:14336
ds_read_b64_tr_b16 v[152:153], v235 offset:8192
v_mfma_f32_16x16x32_bf16 v[16:19], v[128:131], a[72:75], v[16:19]
ds_read_b64_tr_b16 v[154:155], v235 offset:10240
ds_read_b64_tr_b16 v[156:157], v235 offset:12288
ds_read_b64_tr_b16 v[158:159], v235 offset:14336
v_mfma_f32_16x16x32_bf16 v[20:23], v[128:131], a[76:79], v[20:23]
ds_read_b64_tr_b16 a[0:1], v224 offset:32768
v_mfma_f32_16x16x32_bf16 v[20:23], v[132:135], a[68:71], v[20:23]
ds_read_b64_tr_b16 a[2:3], v224 offset:34816
v_mfma_f32_16x16x32_bf16 v[24:27], v[140:143], a[64:67], v[24:27]
ds_read_b64_tr_b16 a[4:5], v224 offset:36864
v_mfma_f32_16x16x32_bf16 v[24:27], v[136:139], a[72:75], v[24:27]
ds_read_b64_tr_b16 a[6:7], v224 offset:38912
v_mfma_f32_16x16x32_bf16 v[28:31], v[136:139], a[76:79], v[28:31]
ds_read_b64_tr_b16 a[8:9], v225 offset:32768
v_mfma_f32_16x16x32_bf16 v[28:31], v[140:143], a[68:71], v[28:31]
ds_read_b64_tr_b16 a[10:11], v225 offset:34816
s_waitcnt lgkmcnt(6)
v_mfma_f32_16x16x32_bf16 v[32:35], v[144:147], a[64:67], v[32:35]
ds_read_b64_tr_b16 a[12:13], v225 offset:36864
v_mfma_f32_16x16x32_bf16 v[32:35], v[148:151], a[72:75], v[32:35]
ds_read_b64_tr_b16 a[14:15], v225 offset:38912
v_mfma_f32_16x16x32_bf16 v[36:39], v[148:151], a[76:79], v[36:39]
buffer_load_dwordx4 a[156:159], v249, s[32:35], s73 offen sc1
v_mfma_f32_16x16x32_bf16 v[36:39], v[144:147], a[68:71], v[36:39]
ds_read_b64_tr_b16 v[128:129], v226 offset:32768
ds_read_b64_tr_b16 v[130:131], v226 offset:34816
v_mfma_f32_16x16x32_bf16 v[40:43], v[152:155], a[64:67], v[40:43]
s_add_u32 m0, s62, 106496
s_lshl_b32 s63, s75, 4
v_mfma_f32_16x16x32_bf16 v[40:43], v[156:159], a[72:75], v[40:43]
buffer_load_dwordx4 v236, s[96:99], s63 offen offset:0  lds
v_mfma_f32_16x16x32_bf16 v[44:47], v[156:159], a[76:79], v[44:47]
ds_read_b64_tr_b16 v[132:133], v226 offset:36864
ds_read_b64_tr_b16 v[134:135], v226 offset:38912
v_mfma_f32_16x16x32_bf16 v[44:47], v[152:155], a[68:71], v[44:47]
buffer_load_dwordx4 v237, s[96:99], s63 offen offset:1024  lds
s_waitcnt lgkmcnt(4)
v_mfma_f32_16x16x32_bf16 v[48:51], a[0:3], a[64:67], v[48:51]
s_waitcnt vmcnt(38)
s_barrier
v_mfma_f32_16x16x32_bf16 v[48:51], a[4:7], a[72:75], v[48:51]
ds_read_b64_tr_b16 v[136:137], v227 offset:32768
ds_read_b64_tr_b16 v[138:139], v227 offset:34816
ds_read_b64_tr_b16 v[140:141], v227 offset:36864
ds_read_b64_tr_b16 v[142:143], v227 offset:38912
v_mfma_f32_16x16x32_bf16 v[52:55], a[4:7], a[76:79], v[52:55]
ds_read_b64_tr_b16 v[148:149], v232 offset:16384
s_add_u32 m0, s62, 90112
v_mfma_f32_16x16x32_bf16 v[52:55], a[0:3], a[68:71], v[52:55]
ds_read_b64_tr_b16 v[150:151], v232 offset:18432
s_lshl_b32 s63, s73, 4
v_mfma_f32_16x16x32_bf16 v[56:59], a[8:11], a[64:67], v[56:59]
buffer_load_dwordx4 v236, s[96:99], s63 offen offset:0  lds
v_mfma_f32_16x16x32_bf16 v[56:59], a[12:15], a[72:75], v[56:59]
ds_read_b64_tr_b16 v[144:145], v232 offset:20480
ds_read_b64_tr_b16 v[146:147], v232 offset:22528
v_mfma_f32_16x16x32_bf16 v[60:63], a[12:15], a[76:79], v[60:63]
buffer_load_dwordx4 v237, s[96:99], s63 offen offset:1024  lds
v_mfma_f32_16x16x32_bf16 v[60:63], a[8:11], a[68:71], v[60:63]
ds_read_b64_tr_b16 v[156:157], v233 offset:16384
s_waitcnt lgkmcnt(5)
v_mfma_f32_16x16x32_bf16 v[64:67], v[128:131], a[64:67], v[64:67]
ds_read_b64_tr_b16 v[158:159], v233 offset:18432
ds_read_b64_tr_b16 v[152:153], v233 offset:20480
v_mfma_f32_16x16x32_bf16 v[64:67], v[132:135], a[72:75], v[64:67]
ds_read_b64_tr_b16 v[154:155], v233 offset:22528
s_add_u32 m0, s62, 98304
s_lshl_b32 s63, s74, 4
v_mfma_f32_16x16x32_bf16 v[68:71], v[132:135], a[76:79], v[68:71]
buffer_load_dwordx4 v236, s[96:99], s63 offen offset:0  lds
v_mfma_f32_16x16x32_bf16 v[68:71], v[128:131], a[68:71], v[68:71]
ds_read_b64_tr_b16 a[4:5], v234 offset:16384
ds_read_b64_tr_b16 a[6:7], v234 offset:18432
v_mfma_f32_16x16x32_bf16 v[72:75], v[136:139], a[64:67], v[72:75]
buffer_load_dwordx4 v237, s[96:99], s63 offen offset:1024  lds
v_mfma_f32_16x16x32_bf16 v[72:75], v[140:143], a[72:75], v[72:75]
ds_read_b64_tr_b16 a[0:1], v234 offset:20480
ds_read_b64_tr_b16 a[2:3], v234 offset:22528
v_mfma_f32_16x16x32_bf16 v[76:79], v[140:143], a[76:79], v[76:79]
ds_read_b64_tr_b16 a[12:13], v235 offset:16384
v_mfma_f32_16x16x32_bf16 v[76:79], v[136:139], a[68:71], v[76:79]
ds_read_b64_tr_b16 a[14:15], v235 offset:18432
s_waitcnt lgkmcnt(6)
v_mfma_f32_16x16x32_bf16 v[16:19], v[148:151], a[80:83], v[16:19]
buffer_load_dwordx4 a[160:163], v198, s[32:35], s74 offen sc1
v_mfma_f32_16x16x32_bf16 v[16:19], v[144:147], a[88:91], v[16:19]
ds_read_b64_tr_b16 a[8:9], v235 offset:20480
ds_read_b64_tr_b16 a[10:11], v235 offset:22528
v_mfma_f32_16x16x32_bf16 v[20:23], v[144:147], a[92:95], v[20:23]
ds_read_b64_tr_b16 v[132:133], v224 offset:40960
v_mfma_f32_16x16x32_bf16 v[20:23], v[148:151], a[84:87], v[20:23]
ds_read_b64_tr_b16 v[134:135], v224 offset:43008
v_mfma_f32_16x16x32_bf16 v[24:27], v[156:159], a[80:83], v[24:27]
buffer_load_dwordx4 a[164:167], v239, s[32:35], s74 offen sc1
v_mfma_f32_16x16x32_bf16 v[24:27], v[152:155], a[88:91], v[24:27]
ds_read_b64_tr_b16 v[128:129], v224 offset:45056
ds_read_b64_tr_b16 v[130:131], v224 offset:47104
v_mfma_f32_16x16x32_bf16 v[28:31], v[152:155], a[92:95], v[28:31]
ds_read_b64_tr_b16 v[140:141], v225 offset:40960
v_mfma_f32_16x16x32_bf16 v[28:31], v[156:159], a[84:87], v[28:31]
ds_read_b64_tr_b16 v[142:143], v225 offset:43008
s_waitcnt lgkmcnt(6)
v_mfma_f32_16x16x32_bf16 v[32:35], a[4:7], a[80:83], v[32:35]
buffer_load_dwordx4 a[168:171], v248, s[32:35], s74 offen sc1
v_mfma_f32_16x16x32_bf16 v[32:35], a[0:3], a[88:91], v[32:35]
ds_read_b64_tr_b16 v[136:137], v225 offset:45056
ds_read_b64_tr_b16 v[138:139], v225 offset:47104
v_mfma_f32_16x16x32_bf16 v[36:39], a[0:3], a[92:95], v[36:39]
ds_read_b64_tr_b16 v[144:145], v226 offset:40960
v_mfma_f32_16x16x32_bf16 v[36:39], a[4:7], a[84:87], v[36:39]
ds_read_b64_tr_b16 v[146:147], v226 offset:43008
v_mfma_f32_16x16x32_bf16 v[40:43], a[12:15], a[80:83], v[40:43]
buffer_load_dwordx4 a[172:175], v249, s[32:35], s74 offen sc1
v_mfma_f32_16x16x32_bf16 v[40:43], a[8:11], a[88:91], v[40:43]
ds_read_b64_tr_b16 v[148:149], v226 offset:45056
ds_read_b64_tr_b16 v[150:151], v226 offset:47104
v_mfma_f32_16x16x32_bf16 v[44:47], a[8:11], a[92:95], v[44:47]
ds_read_b64_tr_b16 v[152:153], v227 offset:40960
v_mfma_f32_16x16x32_bf16 v[44:47], a[12:15], a[84:87], v[44:47]
ds_read_b64_tr_b16 v[154:155], v227 offset:43008
s_waitcnt lgkmcnt(6)
v_mfma_f32_16x16x32_bf16 v[48:51], v[132:135], a[80:83], v[48:51]
s_waitcnt vmcnt(11)
s_barrier
v_mfma_f32_16x16x32_bf16 v[48:51], v[128:131], a[88:91], v[48:51]
ds_read_b64_tr_b16 v[156:157], v227 offset:45056
ds_read_b64_tr_b16 v[158:159], v227 offset:47104
v_mfma_f32_16x16x32_bf16 v[52:55], v[128:131], a[92:95], v[52:55]
buffer_load_dwordx4 a[176:179], v198, s[32:35], s75 offen sc1
v_mfma_f32_16x16x32_bf16 v[52:55], v[132:135], a[84:87], v[52:55]
ds_read_b64_tr_b16 a[0:1], v224 offset:49152
ds_read_b64_tr_b16 a[2:3], v224 offset:51200
v_mfma_f32_16x16x32_bf16 v[56:59], v[140:143], a[80:83], v[56:59]
buffer_load_dwordx4 a[180:183], v239, s[32:35], s75 offen sc1
v_mfma_f32_16x16x32_bf16 v[56:59], v[136:139], a[88:91], v[56:59]
ds_read_b64_tr_b16 a[4:5], v224 offset:53248
ds_read_b64_tr_b16 a[6:7], v224 offset:55296
v_mfma_f32_16x16x32_bf16 v[60:63], v[136:139], a[92:95], v[60:63]
buffer_store_dwordx2 v[240:241], v1, s[32:35], s9 offen sc1
v_mfma_f32_16x16x32_bf16 v[60:63], v[140:143], a[84:87], v[60:63]
ds_read_b64_tr_b16 a[8:9], v225 offset:49152
s_waitcnt lgkmcnt(5)
v_mfma_f32_16x16x32_bf16 v[64:67], v[144:147], a[80:83], v[64:67]
buffer_load_dwordx4 a[184:187], v248, s[32:35], s75 offen sc1
v_mfma_f32_16x16x32_bf16 v[64:67], v[148:151], a[88:91], v[64:67]
ds_read_b64_tr_b16 a[10:11], v225 offset:51200
ds_read_b64_tr_b16 a[12:13], v225 offset:53248
ds_read_b64_tr_b16 a[14:15], v225 offset:55296
v_mfma_f32_16x16x32_bf16 v[68:71], v[148:151], a[92:95], v[68:71]
ds_read_b64_tr_b16 v[128:129], v226 offset:49152
v_mfma_f32_16x16x32_bf16 v[68:71], v[144:147], a[84:87], v[68:71]
ds_read_b64_tr_b16 v[130:131], v226 offset:51200
v_mfma_f32_16x16x32_bf16 v[72:75], v[152:155], a[80:83], v[72:75]
buffer_load_dwordx4 a[188:191], v249, s[32:35], s75 offen sc1
v_mfma_f32_16x16x32_bf16 v[72:75], v[156:159], a[88:91], v[72:75]
ds_read_b64_tr_b16 v[132:133], v226 offset:53248
ds_read_b64_tr_b16 v[134:135], v226 offset:55296
v_mfma_f32_16x16x32_bf16 v[76:79], v[156:159], a[92:95], v[76:79]
ds_read_b64_tr_b16 v[136:137], v227 offset:49152
s_add_u32 m0, s62, 114688
v_mfma_f32_16x16x32_bf16 v[76:79], v[152:155], a[84:87], v[76:79]
ds_read_b64_tr_b16 v[138:139], v227 offset:51200
s_waitcnt lgkmcnt(6)
v_mfma_f32_16x16x32_bf16 v[16:19], a[0:3], a[96:99], v[16:19]
ds_read_b64_tr_b16 v[140:141], v227 offset:53248
s_lshl_b32 s63, s76, 4
v_mfma_f32_16x16x32_bf16 v[16:19], a[4:7], a[104:107], v[16:19]
ds_read_b64_tr_b16 v[142:143], v227 offset:55296
v_mfma_f32_16x16x32_bf16 v[20:23], a[4:7], a[108:111], v[20:23]
buffer_load_dwordx4 v236, s[92:95], s63 offen offset:0  lds
v_mfma_f32_16x16x32_bf16 v[20:23], a[0:3], a[100:103], v[20:23]
ds_read_b64_tr_b16 v[148:149], v228 offset:8192
ds_read_b64_tr_b16 v[150:151], v228 offset:10240
v_mfma_f32_16x16x32_bf16 v[24:27], a[8:11], a[96:99], v[24:27]
buffer_load_dwordx4 v237, s[92:95], s63 offen offset:1024  lds
v_mfma_f32_16x16x32_bf16 v[24:27], a[12:15], a[104:107], v[24:27]
ds_read_b64_tr_b16 v[144:145], v228 offset:12288
ds_read_b64_tr_b16 v[146:147], v228 offset:14336
v_mfma_f32_16x16x32_bf16 v[28:31], a[12:15], a[108:111], v[28:31]
ds_read_b64_tr_b16 v[156:157], v229 offset:8192
s_add_u32 m0, s62, 122880
v_mfma_f32_16x16x32_bf16 v[28:31], a[8:11], a[100:103], v[28:31]
ds_read_b64_tr_b16 v[158:159], v229 offset:10240
s_waitcnt lgkmcnt(6)
v_mfma_f32_16x16x32_bf16 v[32:35], v[128:131], a[96:99], v[32:35]
ds_read_b64_tr_b16 v[152:153], v229 offset:12288
s_lshl_b32 s63, s77, 4
v_mfma_f32_16x16x32_bf16 v[32:35], v[132:135], a[104:107], v[32:35]
ds_read_b64_tr_b16 v[154:155], v229 offset:14336
v_mfma_f32_16x16x32_bf16 v[36:39], v[132:135], a[108:111], v[36:39]
buffer_load_dwordx4 v236, s[92:95], s63 offen offset:0  lds
v_mfma_f32_16x16x32_bf16 v[36:39], v[128:131], a[100:103], v[36:39]
ds_read_b64_tr_b16 a[4:5], v230 offset:8192
ds_read_b64_tr_b16 a[6:7], v230 offset:10240
v_mfma_f32_16x16x32_bf16 v[40:43], v[136:139], a[96:99], v[40:43]
buffer_load_dwordx4 v237, s[92:95], s63 offen offset:1024  lds
v_mfma_f32_16x16x32_bf16 v[40:43], v[140:143], a[104:107], v[40:43]
ds_read_b64_tr_b16 a[0:1], v230 offset:12288
ds_read_b64_tr_b16 a[2:3], v230 offset:14336
v_mfma_f32_16x16x32_bf16 v[44:47], v[140:143], a[108:111], v[44:47]
ds_read_b64_tr_b16 a[12:13], v231 offset:8192
v_mfma_f32_16x16x32_bf16 v[44:47], v[136:139], a[100:103], v[44:47]
ds_read_b64_tr_b16 a[14:15], v231 offset:10240
s_waitcnt lgkmcnt(6)
v_mfma_f32_16x16x32_bf16 v[48:51], v[148:151], a[96:99], v[48:51]
s_waitcnt vmcnt(37)
s_barrier
v_mfma_f32_16x16x32_bf16 v[48:51], v[144:147], a[104:107], v[48:51]
ds_read_b64_tr_b16 a[8:9], v231 offset:12288
ds_read_b64_tr_b16 a[10:11], v231 offset:14336
v_mfma_f32_16x16x32_bf16 v[52:55], v[144:147], a[108:111], v[52:55]
buffer_load_dwordx4 a[192:195], v198, s[32:35], s76 offen sc1
v_mfma_f32_16x16x32_bf16 v[52:55], v[148:151], a[100:103], v[52:55]
ds_read_b64_tr_b16 v[132:133], v224 offset:57344
ds_read_b64_tr_b16 v[134:135], v224 offset:59392
v_mfma_f32_16x16x32_bf16 v[56:59], v[156:159], a[96:99], v[56:59]
buffer_load_dwordx4 a[196:199], v239, s[32:35], s76 offen sc1
v_mfma_f32_16x16x32_bf16 v[56:59], v[152:155], a[104:107], v[56:59]
ds_read_b64_tr_b16 v[128:129], v224 offset:61440
ds_read_b64_tr_b16 v[130:131], v224 offset:63488
v_mfma_f32_16x16x32_bf16 v[60:63], v[152:155], a[108:111], v[60:63]
ds_read_b64_tr_b16 v[140:141], v225 offset:57344
v_mfma_f32_16x16x32_bf16 v[60:63], v[156:159], a[100:103], v[60:63]
ds_read_b64_tr_b16 v[142:143], v225 offset:59392
s_waitcnt lgkmcnt(6)
v_mfma_f32_16x16x32_bf16 v[64:67], a[4:7], a[96:99], v[64:67]
buffer_load_dwordx4 a[200:203], v248, s[32:35], s76 offen sc1
v_mfma_f32_16x16x32_bf16 v[64:67], a[0:3], a[104:107], v[64:67]
ds_read_b64_tr_b16 v[136:137], v225 offset:61440
ds_read_b64_tr_b16 v[138:139], v225 offset:63488
v_mfma_f32_16x16x32_bf16 v[68:71], a[0:3], a[108:111], v[68:71]
ds_read_b64_tr_b16 v[144:145], v226 offset:57344
v_mfma_f32_16x16x32_bf16 v[68:71], a[4:7], a[100:103], v[68:71]
ds_read_b64_tr_b16 v[146:147], v226 offset:59392
v_mfma_f32_16x16x32_bf16 v[72:75], a[12:15], a[96:99], v[72:75]
buffer_load_dwordx4 a[204:207], v249, s[32:35], s76 offen sc1
v_mfma_f32_16x16x32_bf16 v[72:75], a[8:11], a[104:107], v[72:75]
ds_read_b64_tr_b16 v[148:149], v226 offset:61440
ds_read_b64_tr_b16 v[150:151], v226 offset:63488
v_mfma_f32_16x16x32_bf16 v[76:79], a[8:11], a[108:111], v[76:79]
ds_read_b64_tr_b16 v[152:153], v227 offset:57344
s_add_u32 m0, s62, 131072
v_mfma_f32_16x16x32_bf16 v[76:79], a[12:15], a[100:103], v[76:79]
ds_read_b64_tr_b16 v[154:155], v227 offset:59392
s_waitcnt lgkmcnt(6)
v_mfma_f32_16x16x32_bf16 v[16:19], v[132:135], a[112:115], v[16:19]
ds_read_b64_tr_b16 v[156:157], v227 offset:61440
s_lshl_b32 s63, s76, 4
v_mfma_f32_16x16x32_bf16 v[16:19], v[128:131], a[120:123], v[16:19]
ds_read_b64_tr_b16 v[158:159], v227 offset:63488
v_mfma_f32_16x16x32_bf16 v[20:23], v[128:131], a[124:127], v[20:23]
buffer_load_dwordx4 v236, s[96:99], s63 offen offset:0  lds
v_mfma_f32_16x16x32_bf16 v[20:23], v[132:135], a[116:119], v[20:23]
ds_read_b64_tr_b16 a[0:1], v224 offset:0
ds_read_b64_tr_b16 a[2:3], v224 offset:2048
v_mfma_f32_16x16x32_bf16 v[24:27], v[140:143], a[112:115], v[24:27]
buffer_load_dwordx4 v237, s[96:99], s63 offen offset:1024  lds
v_mfma_f32_16x16x32_bf16 v[24:27], v[136:139], a[120:123], v[24:27]
ds_read_b64_tr_b16 a[4:5], v224 offset:4096
ds_read_b64_tr_b16 a[6:7], v224 offset:6144
v_mfma_f32_16x16x32_bf16 v[28:31], v[136:139], a[124:127], v[28:31]
ds_read_b64_tr_b16 a[8:9], v225 offset:0
s_add_u32 m0, s62, 139264
v_mfma_f32_16x16x32_bf16 v[28:31], v[140:143], a[116:119], v[28:31]
ds_read_b64_tr_b16 a[10:11], v225 offset:2048
s_waitcnt lgkmcnt(6)
v_mfma_f32_16x16x32_bf16 v[32:35], v[144:147], a[112:115], v[32:35]
ds_read_b64_tr_b16 a[12:13], v225 offset:4096
s_lshl_b32 s63, s77, 4
v_mfma_f32_16x16x32_bf16 v[32:35], v[148:151], a[120:123], v[32:35]
ds_read_b64_tr_b16 a[14:15], v225 offset:6144
v_mfma_f32_16x16x32_bf16 v[36:39], v[148:151], a[124:127], v[36:39]
buffer_load_dwordx4 v236, s[96:99], s63 offen offset:0  lds
v_mfma_f32_16x16x32_bf16 v[36:39], v[144:147], a[116:119], v[36:39]
ds_read_b64_tr_b16 v[128:129], v226 offset:0
ds_read_b64_tr_b16 v[130:131], v226 offset:2048
v_mfma_f32_16x16x32_bf16 v[40:43], v[152:155], a[112:115], v[40:43]
buffer_load_dwordx4 v237, s[96:99], s63 offen offset:1024  lds
v_mfma_f32_16x16x32_bf16 v[40:43], v[156:159], a[120:123], v[40:43]
ds_read_b64_tr_b16 v[132:133], v226 offset:4096
ds_read_b64_tr_b16 v[134:135], v226 offset:6144
v_mfma_f32_16x16x32_bf16 v[44:47], v[156:159], a[124:127], v[44:47]
ds_read_b64_tr_b16 v[136:137], v227 offset:0
v_mfma_f32_16x16x32_bf16 v[44:47], v[152:155], a[116:119], v[44:47]
ds_read_b64_tr_b16 v[138:139], v227 offset:2048
s_waitcnt lgkmcnt(6)
v_mfma_f32_16x16x32_bf16 v[48:51], a[0:3], a[112:115], v[48:51]
s_waitcnt vmcnt(40)
s_barrier
v_mfma_f32_16x16x32_bf16 v[48:51], a[4:7], a[120:123], v[48:51]
ds_read_b64_tr_b16 v[140:141], v227 offset:4096
ds_read_b64_tr_b16 v[142:143], v227 offset:6144
v_mfma_f32_16x16x32_bf16 v[52:55], a[4:7], a[124:127], v[52:55]
buffer_load_dwordx4 a[208:211], v198, s[32:35], s77 offen sc1
v_mfma_f32_16x16x32_bf16 v[52:55], a[0:3], a[116:119], v[52:55]
ds_read_b64_tr_b16 v[148:149], v228 offset:0
ds_read_b64_tr_b16 v[150:151], v228 offset:2048
v_mfma_f32_16x16x32_bf16 v[56:59], a[8:11], a[112:115], v[56:59]
buffer_load_dwordx4 a[212:215], v239, s[32:35], s77 offen sc1
v_mfma_f32_16x16x32_bf16 v[56:59], a[12:15], a[120:123], v[56:59]
ds_read_b64_tr_b16 v[144:145], v228 offset:4096
ds_read_b64_tr_b16 v[146:147], v228 offset:6144
v_mfma_f32_16x16x32_bf16 v[60:63], a[12:15], a[124:127], v[60:63]
ds_read_b64_tr_b16 v[156:157], v229 offset:0
v_mfma_f32_16x16x32_bf16 v[60:63], a[8:11], a[116:119], v[60:63]
ds_read_b64_tr_b16 v[158:159], v229 offset:2048
s_waitcnt lgkmcnt(6)
v_mfma_f32_16x16x32_bf16 v[64:67], v[128:131], a[112:115], v[64:67]
buffer_load_dwordx4 a[216:219], v248, s[32:35], s77 offen sc1
v_mfma_f32_16x16x32_bf16 v[64:67], v[132:135], a[120:123], v[64:67]
ds_read_b64_tr_b16 v[152:153], v229 offset:4096
ds_read_b64_tr_b16 v[154:155], v229 offset:6144
v_mfma_f32_16x16x32_bf16 v[68:71], v[132:135], a[124:127], v[68:71]
ds_read_b64_tr_b16 a[4:5], v230 offset:0
v_mfma_f32_16x16x32_bf16 v[68:71], v[128:131], a[116:119], v[68:71]
ds_read_b64_tr_b16 a[6:7], v230 offset:2048
v_mfma_f32_16x16x32_bf16 v[72:75], v[136:139], a[112:115], v[72:75]
buffer_load_dwordx4 a[220:223], v249, s[32:35], s77 offen sc1
v_mfma_f32_16x16x32_bf16 v[72:75], v[140:143], a[120:123], v[72:75]
ds_read_b64_tr_b16 a[0:1], v230 offset:4096
ds_read_b64_tr_b16 a[2:3], v230 offset:6144
v_mfma_f32_16x16x32_bf16 v[76:79], v[140:143], a[124:127], v[76:79]
ds_read_b64_tr_b16 a[12:13], v231 offset:0
v_mfma_f32_16x16x32_bf16 v[76:79], v[136:139], a[116:119], v[76:79]
ds_read_b64_tr_b16 a[14:15], v231 offset:2048
s_waitcnt lgkmcnt(6)
v_mfma_f32_16x16x32_bf16 v[16:19], v[148:151], a[128:131], v[16:19]
buffer_load_dwordx4 a[224:227], v198, s[32:35], s78 offen sc1
v_mfma_f32_16x16x32_bf16 v[16:19], v[144:147], a[136:139], v[16:19]
ds_read_b64_tr_b16 a[8:9], v231 offset:4096
ds_read_b64_tr_b16 a[10:11], v231 offset:6144
v_mfma_f32_16x16x32_bf16 v[20:23], v[144:147], a[140:143], v[20:23]
ds_read_b64_tr_b16 v[132:133], v224 offset:8192
v_mfma_f32_16x16x32_bf16 v[20:23], v[148:151], a[132:135], v[20:23]
ds_read_b64_tr_b16 v[134:135], v224 offset:10240
v_mfma_f32_16x16x32_bf16 v[24:27], v[156:159], a[128:131], v[24:27]
buffer_load_dwordx4 a[228:231], v239, s[32:35], s78 offen sc1
v_mfma_f32_16x16x32_bf16 v[24:27], v[152:155], a[136:139], v[24:27]
ds_read_b64_tr_b16 v[128:129], v224 offset:12288
ds_read_b64_tr_b16 v[130:131], v224 offset:14336
v_mfma_f32_16x16x32_bf16 v[28:31], v[152:155], a[140:143], v[28:31]
ds_read_b64_tr_b16 v[140:141], v225 offset:8192
v_mfma_f32_16x16x32_bf16 v[28:31], v[156:159], a[132:135], v[28:31]
ds_read_b64_tr_b16 v[142:143], v225 offset:10240
s_waitcnt lgkmcnt(6)
v_mfma_f32_16x16x32_bf16 v[32:35], a[4:7], a[128:131], v[32:35]
buffer_load_dwordx4 a[232:235], v248, s[32:35], s78 offen sc1
v_mfma_f32_16x16x32_bf16 v[32:35], a[0:3], a[136:139], v[32:35]
ds_read_b64_tr_b16 v[136:137], v225 offset:12288
ds_read_b64_tr_b16 v[138:139], v225 offset:14336
v_mfma_f32_16x16x32_bf16 v[36:39], a[0:3], a[140:143], v[36:39]
ds_read_b64_tr_b16 v[144:145], v226 offset:8192
v_mfma_f32_16x16x32_bf16 v[36:39], a[4:7], a[132:135], v[36:39]
ds_read_b64_tr_b16 v[146:147], v226 offset:10240
v_mfma_f32_16x16x32_bf16 v[40:43], a[12:15], a[128:131], v[40:43]
buffer_load_dwordx4 a[236:239], v249, s[32:35], s78 offen sc1
v_mfma_f32_16x16x32_bf16 v[40:43], a[8:11], a[136:139], v[40:43]
ds_read_b64_tr_b16 v[148:149], v226 offset:12288
ds_read_b64_tr_b16 v[150:151], v226 offset:14336
v_mfma_f32_16x16x32_bf16 v[44:47], a[8:11], a[140:143], v[44:47]
ds_read_b64_tr_b16 v[152:153], v227 offset:8192
v_mfma_f32_16x16x32_bf16 v[44:47], a[12:15], a[132:135], v[44:47]
ds_read_b64_tr_b16 v[154:155], v227 offset:10240
s_waitcnt lgkmcnt(6)
v_mfma_f32_16x16x32_bf16 v[48:51], v[132:135], a[128:131], v[48:51]
s_waitcnt vmcnt(31)
s_barrier
v_mfma_f32_16x16x32_bf16 v[48:51], v[128:131], a[136:139], v[48:51]
ds_read_b64_tr_b16 v[156:157], v227 offset:12288
ds_read_b64_tr_b16 v[158:159], v227 offset:14336
v_mfma_f32_16x16x32_bf16 v[52:55], v[128:131], a[140:143], v[52:55]
buffer_load_dwordx4 a[240:243], v198, s[32:35], s79 offen sc1
v_mfma_f32_16x16x32_bf16 v[52:55], v[132:135], a[132:135], v[52:55]
ds_read_b64_tr_b16 a[0:1], v224 offset:16384
ds_read_b64_tr_b16 a[2:3], v224 offset:18432
v_mfma_f32_16x16x32_bf16 v[56:59], v[140:143], a[128:131], v[56:59]
buffer_load_dwordx4 a[244:247], v239, s[32:35], s79 offen sc1
v_mfma_f32_16x16x32_bf16 v[56:59], v[136:139], a[136:139], v[56:59]
ds_read_b64_tr_b16 a[4:5], v224 offset:20480
ds_read_b64_tr_b16 a[6:7], v224 offset:22528
v_mfma_f32_16x16x32_bf16 v[60:63], v[136:139], a[140:143], v[60:63]
ds_read_b64_tr_b16 a[8:9], v225 offset:16384
v_mfma_f32_16x16x32_bf16 v[60:63], v[140:143], a[132:135], v[60:63]
ds_read_b64_tr_b16 a[10:11], v225 offset:18432
s_waitcnt lgkmcnt(6)
v_mfma_f32_16x16x32_bf16 v[64:67], v[144:147], a[128:131], v[64:67]
buffer_load_dwordx4 a[248:251], v248, s[32:35], s79 offen sc1
v_mfma_f32_16x16x32_bf16 v[64:67], v[148:151], a[136:139], v[64:67]
ds_read_b64_tr_b16 a[12:13], v225 offset:20480
ds_read_b64_tr_b16 a[14:15], v225 offset:22528
v_mfma_f32_16x16x32_bf16 v[68:71], v[148:151], a[140:143], v[68:71]
ds_read_b64_tr_b16 v[128:129], v226 offset:16384
v_mfma_f32_16x16x32_bf16 v[68:71], v[144:147], a[132:135], v[68:71]
ds_read_b64_tr_b16 v[130:131], v226 offset:18432
v_mfma_f32_16x16x32_bf16 v[72:75], v[152:155], a[128:131], v[72:75]
buffer_load_dwordx4 a[252:255], v249, s[32:35], s79 offen sc1
v_mfma_f32_16x16x32_bf16 v[72:75], v[156:159], a[136:139], v[72:75]
ds_read_b64_tr_b16 v[132:133], v226 offset:20480
ds_read_b64_tr_b16 v[134:135], v226 offset:22528
v_mfma_f32_16x16x32_bf16 v[76:79], v[156:159], a[140:143], v[76:79]
ds_read_b64_tr_b16 v[136:137], v227 offset:16384
s_add_u32 m0, s62, 155648
v_mfma_f32_16x16x32_bf16 v[76:79], v[152:155], a[132:135], v[76:79]
ds_read_b64_tr_b16 v[138:139], v227 offset:18432
s_waitcnt lgkmcnt(6)
v_mfma_f32_16x16x32_bf16 v[16:19], a[0:3], a[144:147], v[16:19]
ds_read_b64_tr_b16 v[140:141], v227 offset:20480
s_lshl_b32 s63, s79, 4
v_mfma_f32_16x16x32_bf16 v[16:19], a[4:7], a[152:155], v[16:19]
ds_read_b64_tr_b16 v[142:143], v227 offset:22528
v_mfma_f32_16x16x32_bf16 v[20:23], a[4:7], a[156:159], v[20:23]
buffer_load_dwordx4 v236, s[92:95], s63 offen offset:0  lds
v_mfma_f32_16x16x32_bf16 v[20:23], a[0:3], a[148:151], v[20:23]
ds_read_b64_tr_b16 v[148:149], v228 offset:24576
ds_read_b64_tr_b16 v[150:151], v228 offset:26624
v_mfma_f32_16x16x32_bf16 v[24:27], a[8:11], a[144:147], v[24:27]
buffer_load_dwordx4 v237, s[92:95], s63 offen offset:1024  lds
v_mfma_f32_16x16x32_bf16 v[24:27], a[12:15], a[152:155], v[24:27]
ds_read_b64_tr_b16 v[144:145], v228 offset:28672
ds_read_b64_tr_b16 v[146:147], v228 offset:30720
v_mfma_f32_16x16x32_bf16 v[28:31], a[12:15], a[156:159], v[28:31]
ds_read_b64_tr_b16 v[156:157], v229 offset:24576
s_add_u32 m0, s62, 147456
v_mfma_f32_16x16x32_bf16 v[28:31], a[8:11], a[148:151], v[28:31]
ds_read_b64_tr_b16 v[158:159], v229 offset:26624
s_waitcnt lgkmcnt(6)
v_mfma_f32_16x16x32_bf16 v[32:35], v[128:131], a[144:147], v[32:35]
ds_read_b64_tr_b16 v[152:153], v229 offset:28672
s_lshl_b32 s63, s78, 4
v_mfma_f32_16x16x32_bf16 v[32:35], v[132:135], a[152:155], v[32:35]
ds_read_b64_tr_b16 v[154:155], v229 offset:30720
v_mfma_f32_16x16x32_bf16 v[36:39], v[132:135], a[156:159], v[36:39]
buffer_load_dwordx4 v236, s[92:95], s63 offen offset:0  lds
v_mfma_f32_16x16x32_bf16 v[36:39], v[128:131], a[148:151], v[36:39]
ds_read_b64_tr_b16 a[4:5], v230 offset:24576
ds_read_b64_tr_b16 a[6:7], v230 offset:26624
v_mfma_f32_16x16x32_bf16 v[40:43], v[136:139], a[144:147], v[40:43]
buffer_load_dwordx4 v237, s[92:95], s63 offen offset:1024  lds
v_mfma_f32_16x16x32_bf16 v[40:43], v[140:143], a[152:155], v[40:43]
ds_read_b64_tr_b16 a[0:1], v230 offset:28672
ds_read_b64_tr_b16 a[2:3], v230 offset:30720
v_mfma_f32_16x16x32_bf16 v[44:47], v[140:143], a[156:159], v[44:47]
ds_read_b64_tr_b16 a[12:13], v231 offset:24576
v_mfma_f32_16x16x32_bf16 v[44:47], v[136:139], a[148:151], v[44:47]
ds_read_b64_tr_b16 a[14:15], v231 offset:26624
s_waitcnt lgkmcnt(6)
v_mfma_f32_16x16x32_bf16 v[48:51], v[148:151], a[144:147], v[48:51]
s_waitcnt vmcnt(33)
s_barrier
v_mfma_f32_16x16x32_bf16 v[48:51], v[144:147], a[152:155], v[48:51]
ds_read_b64_tr_b16 a[8:9], v231 offset:28672
ds_read_b64_tr_b16 a[10:11], v231 offset:30720
v_mfma_f32_16x16x32_bf16 v[52:55], v[144:147], a[156:159], v[52:55]
ds_read_b64_tr_b16 v[132:133], v224 offset:24576
s_add_u32 m0, s62, 32768
v_mfma_f32_16x16x32_bf16 v[52:55], v[148:151], a[148:151], v[52:55]
L_pg6:
s_cbranch_execz L_pg7
ds_read_b64_tr_b16 v[134:135], v224 offset:26624
v_mfma_f32_16x16x32_bf16 v[56:59], v[156:159], a[144:147], v[56:59]
s_lshl_b32 s63, s80, 4
buffer_load_dwordx4 v236, s[92:95], s63 offen offset:0  lds
v_mfma_f32_16x16x32_bf16 v[56:59], v[152:155], a[152:155], v[56:59]
ds_read_b64_tr_b16 v[128:129], v224 offset:28672
ds_read_b64_tr_b16 v[130:131], v224 offset:30720
v_mfma_f32_16x16x32_bf16 v[60:63], v[152:155], a[156:159], v[60:63]
buffer_load_dwordx2 v[242:243], v199, s[32:35], s9 offen sc1
v_mfma_f32_16x16x32_bf16 v[60:63], v[156:159], a[148:151], v[60:63]
buffer_load_dwordx4 v237, s[92:95], s63 offen offset:1024  lds
s_waitcnt lgkmcnt(4)
v_mfma_f32_16x16x32_bf16 v[64:67], a[4:7], a[144:147], v[64:67]
ds_read_b64_tr_b16 v[140:141], v225 offset:24576
ds_read_b64_tr_b16 v[142:143], v225 offset:26624
v_mfma_f32_16x16x32_bf16 v[64:67], a[0:3], a[152:155], v[64:67]
ds_read_b64_tr_b16 v[136:137], v225 offset:28672
ds_read_b64_tr_b16 v[138:139], v225 offset:30720
s_add_u32 m0, s62, 40960
s_lshl4_add_u32 s63, s81, s37
v_mfma_f32_16x16x32_bf16 v[68:71], a[0:3], a[156:159], v[68:71]
buffer_load_dwordx4 v236, s[92:95], s63 offen offset:0  lds
v_mfma_f32_16x16x32_bf16 v[68:71], a[4:7], a[148:151], v[68:71]
ds_read_b64_tr_b16 v[144:145], v226 offset:24576
ds_read_b64_tr_b16 v[146:147], v226 offset:26624
v_mfma_f32_16x16x32_bf16 v[72:75], a[12:15], a[144:147], v[72:75]
buffer_load_dwordx4 v237, s[92:95], s63 offen offset:1024  lds
v_mfma_f32_16x16x32_bf16 v[72:75], a[8:11], a[152:155], v[72:75]
ds_read_b64_tr_b16 v[148:149], v226 offset:28672
ds_read_b64_tr_b16 v[150:151], v226 offset:30720
v_mfma_f32_16x16x32_bf16 v[76:79], a[8:11], a[156:159], v[76:79]
ds_read_b64_tr_b16 v[152:153], v227 offset:24576
s_add_u32 m0, s62, 49152
v_mfma_f32_16x16x32_bf16 v[76:79], a[12:15], a[148:151], v[76:79]
ds_read_b64_tr_b16 v[154:155], v227 offset:26624
s_waitcnt lgkmcnt(6)
v_mfma_f32_16x16x32_bf16 v[16:19], v[132:135], a[160:163], v[16:19]
ds_read_b64_tr_b16 v[156:157], v227 offset:28672
s_lshl_b32 s63, s82, 4
v_mfma_f32_16x16x32_bf16 v[16:19], v[128:131], a[168:171], v[16:19]
ds_read_b64_tr_b16 v[158:159], v227 offset:30720
v_mfma_f32_16x16x32_bf16 v[20:23], v[128:131], a[172:175], v[20:23]
buffer_load_dwordx4 v236, s[92:95], s63 offen offset:0  lds
v_mfma_f32_16x16x32_bf16 v[20:23], v[132:135], a[164:167], v[20:23]
ds_read_b64_tr_b16 a[0:1], v228 offset:32768
ds_read_b64_tr_b16 a[2:3], v228 offset:34816
v_mfma_f32_16x16x32_bf16 v[24:27], v[140:143], a[160:163], v[24:27]
buffer_load_dwordx4 v237, s[92:95], s63 offen offset:1024  lds
v_mfma_f32_16x16x32_bf16 v[24:27], v[136:139], a[168:171], v[24:27]
ds_read_b64_tr_b16 a[4:5], v228 offset:36864
ds_read_b64_tr_b16 a[6:7], v228 offset:38912
v_mfma_f32_16x16x32_bf16 v[28:31], v[136:139], a[172:175], v[28:31]
ds_read_b64_tr_b16 a[8:9], v229 offset:32768
s_add_u32 m0, s62, 57344
v_mfma_f32_16x16x32_bf16 v[28:31], v[140:143], a[164:167], v[28:31]
ds_read_b64_tr_b16 a[10:11], v229 offset:34816
s_waitcnt lgkmcnt(6)
v_mfma_f32_16x16x32_bf16 v[32:35], v[144:147], a[160:163], v[32:35]
ds_read_b64_tr_b16 a[12:13], v229 offset:36864
s_lshl_b32 s63, s83, 4
v_mfma_f32_16x16x32_bf16 v[32:35], v[148:151], a[168:171], v[32:35]
ds_read_b64_tr_b16 a[14:15], v229 offset:38912
v_mfma_f32_16x16x32_bf16 v[36:39], v[148:151], a[172:175], v[36:39]
buffer_load_dwordx4 v236, s[92:95], s63 offen offset:0  lds
v_mfma_f32_16x16x32_bf16 v[36:39], v[144:147], a[164:167], v[36:39]
ds_read_b64_tr_b16 v[128:129], v230 offset:32768
ds_read_b64_tr_b16 v[130:131], v230 offset:34816
v_mfma_f32_16x16x32_bf16 v[40:43], v[152:155], a[160:163], v[40:43]
buffer_load_dwordx4 v237, s[92:95], s63 offen offset:1024  lds
v_mfma_f32_16x16x32_bf16 v[40:43], v[156:159], a[168:171], v[40:43]
ds_read_b64_tr_b16 v[132:133], v230 offset:36864
ds_read_b64_tr_b16 v[134:135], v230 offset:38912
v_mfma_f32_16x16x32_bf16 v[44:47], v[156:159], a[172:175], v[44:47]
ds_read_b64_tr_b16 v[136:137], v231 offset:32768
v_mfma_f32_16x16x32_bf16 v[44:47], v[152:155], a[164:167], v[44:47]
ds_read_b64_tr_b16 v[138:139], v231 offset:34816
s_waitcnt lgkmcnt(6)
v_mfma_f32_16x16x32_bf16 v[48:51], a[0:3], a[160:163], v[48:51]
s_waitcnt vmcnt(37)
s_barrier
v_mfma_f32_16x16x32_bf16 v[48:51], a[4:7], a[168:171], v[48:51]
ds_read_b64_tr_b16 v[140:141], v231 offset:36864
ds_read_b64_tr_b16 v[142:143], v231 offset:38912
v_mfma_f32_16x16x32_bf16 v[52:55], a[4:7], a[172:175], v[52:55]
ds_read_b64_tr_b16 v[148:149], v228 offset:16384
s_add_u32 m0, s62, 73728
v_mfma_f32_16x16x32_bf16 v[52:55], a[0:3], a[164:167], v[52:55]
ds_read_b64_tr_b16 v[150:151], v228 offset:18432
s_lshl_b32 s63, s85, 4
v_mfma_f32_16x16x32_bf16 v[56:59], a[8:11], a[160:163], v[56:59]
buffer_load_dwordx4 v236, s[92:95], s63 offen offset:0  lds
v_mfma_f32_16x16x32_bf16 v[56:59], a[12:15], a[168:171], v[56:59]
ds_read_b64_tr_b16 v[144:145], v228 offset:20480
ds_read_b64_tr_b16 v[146:147], v228 offset:22528
v_mfma_f32_16x16x32_bf16 v[60:63], a[12:15], a[172:175], v[60:63]
buffer_load_dwordx4 v237, s[92:95], s63 offen offset:1024  lds
v_mfma_f32_16x16x32_bf16 v[60:63], a[8:11], a[164:167], v[60:63]
ds_read_b64_tr_b16 v[156:157], v229 offset:16384
s_waitcnt lgkmcnt(5)
v_mfma_f32_16x16x32_bf16 v[64:67], v[128:131], a[160:163], v[64:67]
ds_read_b64_tr_b16 v[158:159], v229 offset:18432
ds_read_b64_tr_b16 v[152:153], v229 offset:20480
v_mfma_f32_16x16x32_bf16 v[64:67], v[132:135], a[168:171], v[64:67]
ds_read_b64_tr_b16 v[154:155], v229 offset:22528
s_add_u32 m0, s62, 65536
s_lshl_b32 s63, s84, 4
v_mfma_f32_16x16x32_bf16 v[68:71], v[132:135], a[172:175], v[68:71]
buffer_load_dwordx4 v236, s[92:95], s63 offen offset:0  lds
v_mfma_f32_16x16x32_bf16 v[68:71], v[128:131], a[164:167], v[68:71]
ds_read_b64_tr_b16 a[4:5], v230 offset:16384
ds_read_b64_tr_b16 a[6:7], v230 offset:18432
v_mfma_f32_16x16x32_bf16 v[72:75], v[136:139], a[160:163], v[72:75]
buffer_load_dwordx4 v237, s[92:95], s63 offen offset:1024  lds
v_mfma_f32_16x16x32_bf16 v[72:75], v[140:143], a[168:171], v[72:75]
ds_read_b64_tr_b16 a[0:1], v230 offset:20480
ds_read_b64_tr_b16 a[2:3], v230 offset:22528
v_mfma_f32_16x16x32_bf16 v[76:79], v[140:143], a[172:175], v[76:79]
ds_read_b64_tr_b16 a[12:13], v231 offset:16384
s_add_u32 m0, s62, 0
v_mfma_f32_16x16x32_bf16 v[76:79], v[136:139], a[164:167], v[76:79]
ds_read_b64_tr_b16 a[14:15], v231 offset:18432
s_waitcnt lgkmcnt(6)
v_mfma_f32_16x16x32_bf16 v[16:19], v[148:151], a[176:179], v[16:19]
ds_read_b64_tr_b16 a[8:9], v231 offset:20480
s_lshl_b32 s63, s86, 4
v_mfma_f32_16x16x32_bf16 v[16:19], v[144:147], a[184:187], v[16:19]
ds_read_b64_tr_b16 a[10:11], v231 offset:22528
v_mfma_f32_16x16x32_bf16 v[20:23], v[144:147], a[188:191], v[20:23]
buffer_load_dwordx4 v236, s[92:95], s63 offen offset:0  lds
v_mfma_f32_16x16x32_bf16 v[20:23], v[148:151], a[180:183], v[20:23]
ds_read_b64_tr_b16 v[132:133], v228 offset:40960
ds_read_b64_tr_b16 v[134:135], v228 offset:43008
v_mfma_f32_16x16x32_bf16 v[24:27], v[156:159], a[176:179], v[24:27]
buffer_load_dwordx4 v237, s[92:95], s63 offen offset:1024  lds
v_mfma_f32_16x16x32_bf16 v[24:27], v[152:155], a[184:187], v[24:27]
ds_read_b64_tr_b16 v[128:129], v228 offset:45056
ds_read_b64_tr_b16 v[130:131], v228 offset:47104
v_mfma_f32_16x16x32_bf16 v[28:31], v[152:155], a[188:191], v[28:31]
ds_read_b64_tr_b16 v[140:141], v229 offset:40960
s_add_u32 m0, s62, 8192
v_mfma_f32_16x16x32_bf16 v[28:31], v[156:159], a[180:183], v[28:31]
ds_read_b64_tr_b16 v[142:143], v229 offset:43008
s_waitcnt lgkmcnt(6)
v_mfma_f32_16x16x32_bf16 v[32:35], a[4:7], a[176:179], v[32:35]
ds_read_b64_tr_b16 v[136:137], v229 offset:45056
s_lshl_b32 s63, s87, 4
v_mfma_f32_16x16x32_bf16 v[32:35], a[0:3], a[184:187], v[32:35]
ds_read_b64_tr_b16 v[138:139], v229 offset:47104
v_mfma_f32_16x16x32_bf16 v[36:39], a[0:3], a[188:191], v[36:39]
buffer_load_dwordx4 v236, s[92:95], s63 offen offset:0  lds
v_mfma_f32_16x16x32_bf16 v[36:39], a[4:7], a[180:183], v[36:39]
ds_read_b64_tr_b16 v[144:145], v230 offset:40960
ds_read_b64_tr_b16 v[146:147], v230 offset:43008
v_mfma_f32_16x16x32_bf16 v[40:43], a[12:15], a[176:179], v[40:43]
buffer_load_dwordx4 v237, s[92:95], s63 offen offset:1024  lds
v_mfma_f32_16x16x32_bf16 v[40:43], a[8:11], a[184:187], v[40:43]
ds_read_b64_tr_b16 v[148:149], v230 offset:45056
ds_read_b64_tr_b16 v[150:151], v230 offset:47104
v_mfma_f32_16x16x32_bf16 v[44:47], a[8:11], a[188:191], v[44:47]
ds_read_b64_tr_b16 v[152:153], v231 offset:40960
v_mfma_f32_16x16x32_bf16 v[44:47], a[12:15], a[180:183], v[44:47]
ds_read_b64_tr_b16 v[154:155], v231 offset:43008
s_waitcnt lgkmcnt(6)
v_mfma_f32_16x16x32_bf16 v[48:51], v[132:135], a[176:179], v[48:51]
s_waitcnt vmcnt(15)
v_cmp_ne_u64 vcc, s[54:55], v[242:243]
s_nop 1
s_cbranch_vccnz L_f2_slow
L_f2_ok:
s_waitcnt vmcnt(35)
s_barrier
v_mfma_f32_16x16x32_bf16 v[48:51], v[128:131], a[184:187], v[48:51]
ds_read_b64_tr_b16 v[156:157], v231 offset:45056
ds_read_b64_tr_b16 v[158:159], v231 offset:47104
v_mfma_f32_16x16x32_bf16 v[52:55], v[128:131], a[188:191], v[52:55]
buffer_load_dwordx4 a[24:27], v248, s[32:35], s38 offen sc1
v_mfma_f32_16x16x32_bf16 v[52:55], v[132:135], a[180:183], v[52:55]
ds_read_b64_tr_b16 a[0:1], v228 offset:49152
ds_read_b64_tr_b16 a[2:3], v228 offset:51200
v_mfma_f32_16x16x32_bf16 v[56:59], v[140:143], a[176:179], v[56:59]
buffer_load_dwordx4 a[28:31], v249, s[32:35], s38 offen sc1
v_mfma_f32_16x16x32_bf16 v[56:59], v[136:139], a[184:187], v[56:59]
ds_read_b64_tr_b16 a[4:5], v228 offset:53248
ds_read_b64_tr_b16 a[6:7], v228 offset:55296
v_mfma_f32_16x16x32_bf16 v[60:63], v[136:139], a[188:191], v[60:63]
ds_read_b64_tr_b16 a[8:9], v229 offset:49152
v_mfma_f32_16x16x32_bf16 v[60:63], v[140:143], a[180:183], v[60:63]
ds_read_b64_tr_b16 a[10:11], v229 offset:51200
s_waitcnt lgkmcnt(6)
v_mfma_f32_16x16x32_bf16 v[64:67], v[144:147], a[176:179], v[64:67]
buffer_load_dwordx4 a[32:35], v198, s[32:35], s82 offen sc1
v_mfma_f32_16x16x32_bf16 v[64:67], v[148:151], a[184:187], v[64:67]
ds_read_b64_tr_b16 a[12:13], v229 offset:53248
ds_read_b64_tr_b16 a[14:15], v229 offset:55296
v_mfma_f32_16x16x32_bf16 v[68:71], v[148:151], a[188:191], v[68:71]
ds_read_b64_tr_b16 v[128:129], v230 offset:49152
v_mfma_f32_16x16x32_bf16 v[68:71], v[144:147], a[180:183], v[68:71]
ds_read_b64_tr_b16 v[130:131], v230 offset:51200
v_mfma_f32_16x16x32_bf16 v[72:75], v[152:155], a[176:179], v[72:75]
buffer_load_dwordx4 a[36:39], v239, s[32:35], s82 offen sc1
v_mfma_f32_16x16x32_bf16 v[72:75], v[156:159], a[184:187], v[72:75]
ds_read_b64_tr_b16 v[132:133], v230 offset:53248
ds_read_b64_tr_b16 v[134:135], v230 offset:55296
v_mfma_f32_16x16x32_bf16 v[76:79], v[156:159], a[188:191], v[76:79]
ds_read_b64_tr_b16 v[136:137], v231 offset:49152
v_mfma_f32_16x16x32_bf16 v[76:79], v[152:155], a[180:183], v[76:79]
ds_read_b64_tr_b16 v[138:139], v231 offset:51200
s_waitcnt lgkmcnt(6)
v_mfma_f32_16x16x32_bf16 v[16:19], a[0:3], a[192:195], v[16:19]
buffer_load_dwordx4 a[40:43], v248, s[32:35], s82 offen sc1
v_mfma_f32_16x16x32_bf16 v[16:19], a[4:7], a[200:203], v[16:19]
ds_read_b64_tr_b16 v[140:141], v231 offset:53248
ds_read_b64_tr_b16 v[142:143], v231 offset:55296
v_mfma_f32_16x16x32_bf16 v[20:23], a[4:7], a[204:207], v[20:23]
ds_read_b64_tr_b16 v[148:149], v232 offset:0
v_mfma_f32_16x16x32_bf16 v[20:23], a[0:3], a[196:199], v[20:23]
ds_read_b64_tr_b16 v[150:151], v232 offset:2048
v_mfma_f32_16x16x32_bf16 v[24:27], a[8:11], a[192:195], v[24:27]
buffer_load_dwordx4 a[44:47], v249, s[32:35], s82 offen sc1
v_mfma_f32_16x16x32_bf16 v[24:27], a[12:15], a[200:203], v[24:27]
ds_read_b64_tr_b16 v[144:145], v232 offset:4096
ds_read_b64_tr_b16 v[146:147], v232 offset:6144
v_mfma_f32_16x16x32_bf16 v[28:31], a[12:15], a[204:207], v[28:31]
ds_read_b64_tr_b16 v[156:157], v233 offset:0
v_mfma_f32_16x16x32_bf16 v[28:31], a[8:11], a[196:199], v[28:31]
ds_read_b64_tr_b16 v[158:159], v233 offset:2048
s_waitcnt lgkmcnt(6)
v_mfma_f32_16x16x32_bf16 v[32:35], v[128:131], a[192:195], v[32:35]
buffer_load_dwordx4 a[48:51], v198, s[32:35], s83 offen sc1
v_mfma_f32_16x16x32_bf16 v[32:35], v[132:135], a[200:203], v[32:35]
ds_read_b64_tr_b16 v[152:153], v233 offset:4096
ds_read_b64_tr_b16 v[154:155], v233 offset:6144
v_mfma_f32_16x16x32_bf16 v[36:39], v[132:135], a[204:207], v[36:39]
ds_read_b64_tr_b16 a[4:5], v234 offset:0
v_mfma_f32_16x16x32_bf16 v[36:39], v[128:131], a[196:199], v[36:39]
ds_read_b64_tr_b16 a[6:7], v234 offset:2048
v_mfma_f32_16x16x32_bf16 v[40:43], v[136:139], a[192:195], v[40:43]
buffer_load_dwordx4 a[52:55], v239, s[32:35], s83 offen sc1
v_mfma_f32_16x16x32_bf16 v[40:43], v[140:143], a[200:203], v[40:43]
ds_read_b64_tr_b16 a[0:1], v234 offset:4096
ds_read_b64_tr_b16 a[2:3], v234 offset:6144
v_mfma_f32_16x16x32_bf16 v[44:47], v[140:143], a[204:207], v[44:47]
ds_read_b64_tr_b16 a[12:13], v235 offset:0
v_mfma_f32_16x16x32_bf16 v[44:47], v[136:139], a[196:199], v[44:47]
ds_read_b64_tr_b16 a[14:15], v235 offset:2048
s_waitcnt lgkmcnt(6)
v_mfma_f32_16x16x32_bf16 v[48:51], v[148:151], a[192:195], v[48:51]
s_waitcnt vmcnt(37)
s_barrier
v_mfma_f32_16x16x32_bf16 v[48:51], v[144:147], a[200:203], v[48:51]
ds_read_b64_tr_b16 a[8:9], v235 offset:4096
ds_read_b64_tr_b16 a[10:11], v235 offset:6144
v_mfma_f32_16x16x32_bf16 v[52:55], v[144:147], a[204:207], v[52:55]
buffer_load_dwordx4 a[56:59], v248, s[32:35], s83 offen sc1
v_mfma_f32_16x16x32_bf16 v[52:55], v[148:151], a[196:199], v[52:55]
ds_read_b64_tr_b16 v[132:133], v228 offset:57344
ds_read_b64_tr_b16 v[134:135], v228 offset:59392
v_mfma_f32_16x16x32_bf16 v[56:59], v[156:159], a[192:195], v[56:59]
buffer_load_dwordx4 a[60:63], v249, s[32:35], s83 offen sc1
v_mfma_f32_16x16x32_bf16 v[56:59], v[152:155], a[200:203], v[56:59]
ds_read_b64_tr_b16 v[128:129], v228 offset:61440
ds_read_b64_tr_b16 v[130:131], v228 offset:63488
v_mfma_f32_16x16x32_bf16 v[60:63], v[152:155], a[204:207], v[60:63]
ds_read_b64_tr_b16 v[140:141], v229 offset:57344
v_mfma_f32_16x16x32_bf16 v[60:63], v[156:159], a[196:199], v[60:63]
ds_read_b64_tr_b16 v[142:143], v229 offset:59392
s_waitcnt lgkmcnt(6)
v_mfma_f32_16x16x32_bf16 v[64:67], a[4:7], a[192:195], v[64:67]
buffer_load_dwordx4 a[64:67], v198, s[32:35], s84 offen sc1
v_mfma_f32_16x16x32_bf16 v[64:67], a[0:3], a[200:203], v[64:67]
ds_read_b64_tr_b16 v[136:137], v229 offset:61440
ds_read_b64_tr_b16 v[138:139], v229 offset:63488
v_mfma_f32_16x16x32_bf16 v[68:71], a[0:3], a[204:207], v[68:71]
ds_read_b64_tr_b16 v[144:145], v230 offset:57344
v_mfma_f32_16x16x32_bf16 v[68:71], a[4:7], a[196:199], v[68:71]
ds_read_b64_tr_b16 v[146:147], v230 offset:59392
v_mfma_f32_16x16x32_bf16 v[72:75], a[12:15], a[192:195], v[72:75]
buffer_load_dwordx4 a[68:71], v239, s[32:35], s84 offen sc1
v_mfma_f32_16x16x32_bf16 v[72:75], a[8:11], a[200:203], v[72:75]
ds_read_b64_tr_b16 v[148:149], v230 offset:61440
ds_read_b64_tr_b16 v[150:151], v230 offset:63488
v_mfma_f32_16x16x32_bf16 v[76:79], a[8:11], a[204:207], v[76:79]
ds_read_b64_tr_b16 v[152:153], v231 offset:57344
v_mfma_f32_16x16x32_bf16 v[76:79], a[12:15], a[196:199], v[76:79]
ds_read_b64_tr_b16 v[154:155], v231 offset:59392
s_waitcnt lgkmcnt(6)
v_mfma_f32_16x16x32_bf16 v[16:19], v[132:135], a[208:211], v[16:19]
buffer_load_dwordx4 a[72:75], v248, s[32:35], s84 offen sc1
v_mfma_f32_16x16x32_bf16 v[16:19], v[128:131], a[216:219], v[16:19]
ds_read_b64_tr_b16 v[156:157], v231 offset:61440
ds_read_b64_tr_b16 v[158:159], v231 offset:63488
v_mfma_f32_16x16x32_bf16 v[20:23], v[128:131], a[220:223], v[20:23]
ds_read_b64_tr_b16 a[0:1], v232 offset:8192
v_mfma_f32_16x16x32_bf16 v[20:23], v[132:135], a[212:215], v[20:23]
ds_read_b64_tr_b16 a[2:3], v232 offset:10240
v_mfma_f32_16x16x32_bf16 v[24:27], v[140:143], a[208:211], v[24:27]
buffer_load_dwordx4 a[76:79], v249, s[32:35], s84 offen sc1
v_mfma_f32_16x16x32_bf16 v[24:27], v[136:139], a[216:219], v[24:27]
ds_read_b64_tr_b16 a[4:5], v232 offset:12288
ds_read_b64_tr_b16 a[6:7], v232 offset:14336
v_mfma_f32_16x16x32_bf16 v[28:31], v[136:139], a[220:223], v[28:31]
ds_read_b64_tr_b16 a[8:9], v233 offset:8192
v_mfma_f32_16x16x32_bf16 v[28:31], v[140:143], a[212:215], v[28:31]
ds_read_b64_tr_b16 a[10:11], v233 offset:10240
s_waitcnt lgkmcnt(6)
v_mfma_f32_16x16x32_bf16 v[32:35], v[144:147], a[208:211], v[32:35]
buffer_load_dwordx4 a[80:83], v198, s[32:35], s85 offen sc1
v_mfma_f32_16x16x32_bf16 v[32:35], v[148:151], a[216:219], v[32:35]
ds_read_b64_tr_b16 a[12:13], v233 offset:12288
ds_read_b64_tr_b16 a[14:15], v233 offset:14336
v_mfma_f32_16x16x32_bf16 v[36:39], v[148:151], a[220:223], v[36:39]
ds_read_b64_tr_b16 v[128:129], v234 offset:8192
v_mfma_f32_16x16x32_bf16 v[36:39], v[144:147], a[212:215], v[36:39]
ds_read_b64_tr_b16 v[130:131], v234 offset:10240
v_mfma_f32_16x16x32_bf16 v[40:43], v[152:155], a[208:211], v[40:43]
buffer_load_dwordx4 a[84:87], v239, s[32:35], s85 offen sc1
v_mfma_f32_16x16x32_bf16 v[40:43], v[156:159], a[216:219], v[40:43]
ds_read_b64_tr_b16 v[132:133], v234 offset:12288
ds_read_b64_tr_b16 v[134:135], v234 offset:14336
v_mfma_f32_16x16x32_bf16 v[44:47], v[156:159], a[220:223], v[44:47]
ds_read_b64_tr_b16 v[136:137], v235 offset:8192
v_mfma_f32_16x16x32_bf16 v[44:47], v[152:155], a[212:215], v[44:47]
ds_read_b64_tr_b16 v[138:139], v235 offset:10240
s_waitcnt lgkmcnt(6)
v_mfma_f32_16x16x32_bf16 v[48:51], a[0:3], a[208:211], v[48:51]
s_waitcnt vmcnt(33)
s_barrier
v_mfma_f32_16x16x32_bf16 v[48:51], a[4:7], a[216:219], v[48:51]
ds_read_b64_tr_b16 v[140:141], v235 offset:12288
ds_read_b64_tr_b16 v[142:143], v235 offset:14336
v_mfma_f32_16x16x32_bf16 v[52:55], a[4:7], a[220:223], v[52:55]
buffer_load_dwordx4 a[88:91], v248, s[32:35], s85 offen sc1
v_mfma_f32_16x16x32_bf16 v[52:55], a[0:3], a[212:215], v[52:55]
ds_read_b64_tr_b16 v[148:149], v232 offset:16384
ds_read_b64_tr_b16 v[150:151], v232 offset:18432
v_mfma_f32_16x16x32_bf16 v[56:59], a[8:11], a[208:211], v[56:59]
buffer_load_dwordx4 a[92:95], v249, s[32:35], s85 offen sc1
v_mfma_f32_16x16x32_bf16 v[56:59], a[12:15], a[216:219], v[56:59]
ds_read_b64_tr_b16 v[144:145], v232 offset:20480
ds_read_b64_tr_b16 v[146:147], v232 offset:22528
v_mfma_f32_16x16x32_bf16 v[60:63], a[12:15], a[220:223], v[60:63]
ds_read_b64_tr_b16 v[156:157], v232 offset:24576
v_mfma_f32_16x16x32_bf16 v[60:63], a[8:11], a[212:215], v[60:63]
ds_read_b64_tr_b16 v[158:159], v232 offset:26624
s_waitcnt lgkmcnt(6)
v_mfma_f32_16x16x32_bf16 v[64:67], v[128:131], a[208:211], v[64:67]
buffer_load_dwordx4 a[96:99], v198, s[32:35], s86 offen sc1
v_mfma_f32_16x16x32_bf16 v[64:67], v[132:135], a[216:219], v[64:67]
ds_read_b64_tr_b16 v[152:153], v232 offset:28672
ds_read_b64_tr_b16 v[154:155], v232 offset:30720
v_mfma_f32_16x16x32_bf16 v[68:71], v[132:135], a[220:223], v[68:71]
ds_read_b64_tr_b16 a[4:5], v233 offset:16384
v_mfma_f32_16x16x32_bf16 v[68:71], v[128:131], a[212:215], v[68:71]
ds_read_b64_tr_b16 a[6:7], v233 offset:18432
v_mfma_f32_16x16x32_bf16 v[72:75], v[136:139], a[208:211], v[72:75]
buffer_load_dwordx4 a[100:103], v239, s[32:35], s86 offen sc1
v_mfma_f32_16x16x32_bf16 v[72:75], v[140:143], a[216:219], v[72:75]
ds_read_b64_tr_b16 a[0:1], v233 offset:20480
ds_read_b64_tr_b16 a[2:3], v233 offset:22528
v_mfma_f32_16x16x32_bf16 v[76:79], v[140:143], a[220:223], v[76:79]
ds_read_b64_tr_b16 a[12:13], v233 offset:24576
v_mfma_f32_16x16x32_bf16 v[76:79], v[136:139], a[212:215], v[76:79]
ds_read_b64_tr_b16 a[14:15], v233 offset:26624
s_waitcnt lgkmcnt(6)
v_mfma_f32_16x16x32_bf16 v[16:19], v[148:151], a[224:227], v[16:19]
buffer_load_dwordx4 a[104:107], v248, s[32:35], s86 offen sc1
v_mfma_f32_16x16x32_bf16 v[16:19], v[144:147], a[232:235], v[16:19]
ds_read_b64_tr_b16 a[8:9], v233 offset:28672
ds_read_b64_tr_b16 a[10:11], v233 offset:30720
v_mfma_f32_16x16x32_bf16 v[16:19], v[156:159], a[240:243], v[16:19]
ds_read_b64_tr_b16 v[132:133], v234 offset:16384
v_mfma_f32_16x16x32_bf16 v[16:19], v[152:155], a[248:251], v[16:19]
ds_read_b64_tr_b16 v[134:135], v234 offset:18432
v_mfma_f32_16x16x32_bf16 v[20:23], v[152:155], a[252:255], v[20:23]
buffer_load_dwordx4 a[108:111], v249, s[32:35], s86 offen sc1
v_mfma_f32_16x16x32_bf16 v[20:23], v[156:159], a[244:247], v[20:23]
ds_read_b64_tr_b16 v[128:129], v234 offset:20480
ds_read_b64_tr_b16 v[130:131], v234 offset:22528
v_mfma_f32_16x16x32_bf16 v[20:23], v[144:147], a[236:239], v[20:23]
ds_read_b64_tr_b16 v[140:141], v234 offset:24576
v_mfma_f32_16x16x32_bf16 v[20:23], v[148:151], a[228:231], v[20:23]
ds_read_b64_tr_b16 v[142:143], v234 offset:26624
s_waitcnt lgkmcnt(6)
v_mfma_f32_16x16x32_bf16 v[24:27], a[4:7], a[224:227], v[24:27]
buffer_load_dwordx4 a[112:115], v198, s[32:35], s87 offen sc1
v_mfma_f32_16x16x32_bf16 v[24:27], a[0:3], a[232:235], v[24:27]
ds_read_b64_tr_b16 v[136:137], v234 offset:28672
ds_read_b64_tr_b16 v[138:139], v234 offset:30720
v_mfma_f32_16x16x32_bf16 v[24:27], a[12:15], a[240:243], v[24:27]
ds_read_b64_tr_b16 v[152:153], v235 offset:16384
v_mfma_f32_16x16x32_bf16 v[24:27], a[8:11], a[248:251], v[24:27]
ds_read_b64_tr_b16 v[154:155], v235 offset:18432
v_mfma_f32_16x16x32_bf16 v[28:31], a[8:11], a[252:255], v[28:31]
buffer_load_dwordx4 a[116:119], v239, s[32:35], s87 offen sc1
v_mfma_f32_16x16x32_bf16 v[28:31], a[12:15], a[244:247], v[28:31]
ds_read_b64_tr_b16 v[156:157], v235 offset:20480
ds_read_b64_tr_b16 v[158:159], v235 offset:22528
v_mfma_f32_16x16x32_bf16 v[28:31], a[0:3], a[236:239], v[28:31]
ds_read_b64_tr_b16 v[144:145], v235 offset:24576
v_mfma_f32_16x16x32_bf16 v[28:31], a[4:7], a[228:231], v[28:31]
ds_read_b64_tr_b16 v[146:147], v235 offset:26624
s_waitcnt lgkmcnt(6)
v_mfma_f32_16x16x32_bf16 v[32:35], v[132:135], a[224:227], v[32:35]
s_waitcnt vmcnt(22)
s_barrier
v_mfma_f32_16x16x32_bf16 v[32:35], v[128:131], a[232:235], v[32:35]
ds_read_b64_tr_b16 v[148:149], v235 offset:28672
ds_read_b64_tr_b16 v[150:151], v235 offset:30720
v_mfma_f32_16x16x32_bf16 v[32:35], v[140:143], a[240:243], v[32:35]
buffer_load_dwordx4 a[120:123], v248, s[32:35], s87 offen sc1
v_mfma_f32_16x16x32_bf16 v[32:35], v[136:139], a[248:251], v[32:35]
ds_read_b64_tr_b16 a[8:9], v224 offset:32768
ds_read_b64_tr_b16 a[10:11], v224 offset:34816
v_mfma_f32_16x16x32_bf16 v[36:39], v[136:139], a[252:255], v[36:39]
buffer_load_dwordx4 a[124:127], v249, s[32:35], s87 offen sc1
v_mfma_f32_16x16x32_bf16 v[36:39], v[140:143], a[244:247], v[36:39]
ds_read_b64_tr_b16 a[12:13], v224 offset:36864
ds_read_b64_tr_b16 a[14:15], v224 offset:38912
v_mfma_f32_16x16x32_bf16 v[36:39], v[128:131], a[236:239], v[36:39]
ds_read_b64_tr_b16 a[0:1], v224 offset:40960
s_add_u32 m0, s62, 16384
v_mfma_f32_16x16x32_bf16 v[36:39], v[132:135], a[228:231], v[36:39]
ds_read_b64_tr_b16 a[2:3], v224 offset:43008
s_waitcnt lgkmcnt(6)
v_mfma_f32_16x16x32_bf16 v[40:43], v[152:155], a[224:227], v[40:43]
ds_read_b64_tr_b16 a[4:5], v224 offset:45056
s_lshl_b32 s63, s88, 4
v_mfma_f32_16x16x32_bf16 v[40:43], v[156:159], a[232:235], v[40:43]
ds_read_b64_tr_b16 a[6:7], v224 offset:47104
v_mfma_f32_16x16x32_bf16 v[40:43], v[144:147], a[240:243], v[40:43]
buffer_load_dwordx4 v236, s[92:95], s63 offen offset:0  lds
v_mfma_f32_16x16x32_bf16 v[40:43], v[148:151], a[248:251], v[40:43]
ds_read_b64_tr_b16 v[136:137], v225 offset:32768
ds_read_b64_tr_b16 v[138:139], v225 offset:34816
v_mfma_f32_16x16x32_bf16 v[44:47], v[148:151], a[252:255], v[44:47]
buffer_load_dwordx4 v237, s[92:95], s63 offen offset:1024  lds
v_mfma_f32_16x16x32_bf16 v[44:47], v[144:147], a[244:247], v[44:47]
ds_read_b64_tr_b16 v[140:141], v225 offset:36864
ds_read_b64_tr_b16 v[142:143], v225 offset:38912
v_mfma_f32_16x16x32_bf16 v[44:47], v[156:159], a[236:239], v[44:47]
ds_read_b64_tr_b16 v[128:129], v225 offset:40960
s_add_u32 m0, s62, 24576
v_mfma_f32_16x16x32_bf16 v[44:47], v[152:155], a[228:231], v[44:47]
ds_read_b64_tr_b16 v[130:131], v225 offset:43008
s_waitcnt lgkmcnt(6)
v_mfma_f32_16x16x32_bf16 v[16:19], a[8:11], v[176:179], v[16:19]
ds_read_b64_tr_b16 v[132:133], v225 offset:45056
s_lshl_b32 s63, s89, 4
v_mfma_f32_16x16x32_bf16 v[16:19], a[12:15], v[184:187], v[16:19]
ds_read_b64_tr_b16 v[134:135], v225 offset:47104
v_mfma_f32_16x16x32_bf16 v[16:19], a[0:3], v[192:195], v[16:19]
buffer_load_dwordx4 v236, s[92:95], s63 offen offset:0  lds
v_mfma_f32_16x16x32_bf16 v[16:19], a[4:7], a[24:27], v[16:19]
ds_read_b64_tr_b16 v[148:149], v226 offset:32768
ds_read_b64_tr_b16 v[150:151], v226 offset:34816
v_mfma_f32_16x16x32_bf16 v[20:23], a[4:7], a[28:31], v[20:23]
buffer_load_dwordx4 v237, s[92:95], s63 offen offset:1024  lds
v_mfma_f32_16x16x32_bf16 v[20:23], a[0:3], v[12:15], v[20:23]
ds_read_b64_tr_b16 v[144:145], v226 offset:36864
ds_read_b64_tr_b16 v[146:147], v226 offset:38912
v_mfma_f32_16x16x32_bf16 v[20:23], a[12:15], v[188:191], v[20:23]
ds_read_b64_tr_b16 v[156:157], v226 offset:40960
v_mfma_f32_16x16x32_bf16 v[20:23], a[8:11], v[180:183], v[20:23]
ds_read_b64_tr_b16 v[158:159], v226 offset:43008
s_waitcnt lgkmcnt(6)
v_mfma_f32_16x16x32_bf16 v[24:27], v[136:139], v[176:179], v[24:27]
buffer_load_dwordx4 a[128:131], v198, s[32:35], s88 offen sc1
v_mfma_f32_16x16x32_bf16 v[24:27], v[140:143], v[184:187], v[24:27]
ds_read_b64_tr_b16 v[152:153], v226 offset:45056
ds_read_b64_tr_b16 v[154:155], v226 offset:47104
v_mfma_f32_16x16x32_bf16 v[24:27], v[128:131], v[192:195], v[24:27]
ds_read_b64_tr_b16 a[4:5], v227 offset:32768
v_mfma_f32_16x16x32_bf16 v[24:27], v[132:135], a[24:27], v[24:27]
ds_read_b64_tr_b16 a[6:7], v227 offset:34816
v_mfma_f32_16x16x32_bf16 v[28:31], v[132:135], a[28:31], v[28:31]
buffer_load_dwordx4 a[132:135], v239, s[32:35], s88 offen sc1
v_mfma_f32_16x16x32_bf16 v[28:31], v[128:131], v[12:15], v[28:31]
ds_read_b64_tr_b16 a[0:1], v227 offset:36864
ds_read_b64_tr_b16 a[2:3], v227 offset:38912
v_mfma_f32_16x16x32_bf16 v[28:31], v[140:143], v[188:191], v[28:31]
ds_read_b64_tr_b16 a[12:13], v227 offset:40960
v_mfma_f32_16x16x32_bf16 v[28:31], v[136:139], v[180:183], v[28:31]
ds_read_b64_tr_b16 a[14:15], v227 offset:43008
s_waitcnt lgkmcnt(6)
v_mfma_f32_16x16x32_bf16 v[32:35], v[148:151], v[176:179], v[32:35]
s_waitcnt vmcnt(22)
s_barrier
v_mfma_f32_16x16x32_bf16 v[32:35], v[144:147], v[184:187], v[32:35]
ds_read_b64_tr_b16 a[8:9], v227 offset:45056
ds_read_b64_tr_b16 a[10:11], v227 offset:47104
v_mfma_f32_16x16x32_bf16 v[32:35], v[156:159], v[192:195], v[32:35]
buffer_load_dwordx4 a[136:139], v248, s[32:35], s88 offen sc1
v_mfma_f32_16x16x32_bf16 v[32:35], v[152:155], a[24:27], v[32:35]
ds_read_b64_tr_b16 v[132:133], v224 offset:49152
ds_read_b64_tr_b16 v[134:135], v224 offset:51200
v_mfma_f32_16x16x32_bf16 v[36:39], v[152:155], a[28:31], v[36:39]
buffer_load_dwordx4 a[140:143], v249, s[32:35], s88 offen sc1
v_mfma_f32_16x16x32_bf16 v[36:39], v[156:159], v[12:15], v[36:39]
ds_read_b64_tr_b16 v[128:129], v224 offset:53248
ds_read_b64_tr_b16 v[130:131], v224 offset:55296
v_mfma_f32_16x16x32_bf16 v[36:39], v[144:147], v[188:191], v[36:39]
ds_read_b64_tr_b16 v[140:141], v224 offset:57344
v_mfma_f32_16x16x32_bf16 v[36:39], v[148:151], v[180:183], v[36:39]
ds_read_b64_tr_b16 v[142:143], v224 offset:59392
s_waitcnt lgkmcnt(6)
v_mfma_f32_16x16x32_bf16 v[40:43], a[4:7], v[176:179], v[40:43]
buffer_load_dwordx4 a[144:147], v198, s[32:35], s89 offen sc1
v_mfma_f32_16x16x32_bf16 v[40:43], a[0:3], v[184:187], v[40:43]
ds_read_b64_tr_b16 v[136:137], v224 offset:61440
ds_read_b64_tr_b16 v[138:139], v224 offset:63488
v_mfma_f32_16x16x32_bf16 v[40:43], a[12:15], v[192:195], v[40:43]
ds_read_b64_tr_b16 v[152:153], v225 offset:49152
v_mfma_f32_16x16x32_bf16 v[40:43], a[8:11], a[24:27], v[40:43]
ds_read_b64_tr_b16 v[154:155], v225 offset:51200
v_mfma_f32_16x16x32_bf16 v[44:47], a[8:11], a[28:31], v[44:47]
buffer_load_dwordx4 a[148:151], v239, s[32:35], s89 offen sc1
v_mfma_f32_16x16x32_bf16 v[44:47], a[12:15], v[12:15], v[44:47]
ds_read_b64_tr_b16 v[156:157], v225 offset:53248
ds_read_b64_tr_b16 v[158:159], v225 offset:55296
v_mfma_f32_16x16x32_bf16 v[44:47], a[0:3], v[188:191], v[44:47]
ds_read_b64_tr_b16 v[144:145], v225 offset:57344
v_mfma_f32_16x16x32_bf16 v[44:47], a[4:7], v[180:183], v[44:47]
ds_read_b64_tr_b16 v[146:147], v225 offset:59392
s_waitcnt lgkmcnt(6)
v_mfma_f32_16x16x32_bf16 v[16:19], v[132:135], a[32:35], v[16:19]
buffer_load_dwordx4 a[152:155], v248, s[32:35], s89 offen sc1
v_mfma_f32_16x16x32_bf16 v[16:19], v[128:131], a[40:43], v[16:19]
ds_read_b64_tr_b16 v[148:149], v225 offset:61440
ds_read_b64_tr_b16 v[150:151], v225 offset:63488
v_mfma_f32_16x16x32_bf16 v[16:19], v[140:143], a[48:51], v[16:19]
ds_read_b64_tr_b16 a[8:9], v226 offset:49152
v_mfma_f32_16x16x32_bf16 v[16:19], v[136:139], a[56:59], v[16:19]
ds_read_b64_tr_b16 a[10:11], v226 offset:51200
v_mfma_f32_16x16x32_bf16 v[20:23], v[136:139], a[60:63], v[20:23]
buffer_load_dwordx4 a[156:159], v249, s[32:35], s89 offen sc1
v_mfma_f32_16x16x32_bf16 v[20:23], v[140:143], a[52:55], v[20:23]
ds_read_b64_tr_b16 a[12:13], v226 offset:53248
ds_read_b64_tr_b16 a[14:15], v226 offset:55296
v_mfma_f32_16x16x32_bf16 v[20:23], v[128:131], a[44:47], v[20:23]
L_pg7:
s_cbranch_execz L_pg8
ds_read_b64_tr_b16 a[0:1], v226 offset:57344
v_mfma_f32_16x16x32_bf16 v[20:23], v[132:135], a[36:39], v[20:23]
ds_read_b64_tr_b16 a[2:3], v226 offset:59392
s_waitcnt lgkmcnt(6)
v_mfma_f32_16x16x32_bf16 v[24:27], v[152:155], a[32:35], v[24:27]
ds_read_b64_tr_b16 a[4:5], v226 offset:61440
s_add_u32 m0, s62, 90112
v_mfma_f32_16x16x32_bf16 v[24:27], v[156:159], a[40:43], v[24:27]
ds_read_b64_tr_b16 a[6:7], v226 offset:63488
s_lshl_b32 s63, s91, 4
v_mfma_f32_16x16x32_bf16 v[24:27], v[144:147], a[48:51], v[24:27]
buffer_load_dwordx4 v236, s[92:95], s63 offen offset:0  lds
v_mfma_f32_16x16x32_bf16 v[24:27], v[148:151], a[56:59], v[24:27]
ds_read_b64_tr_b16 v[136:137], v227 offset:49152
ds_read_b64_tr_b16 v[138:139], v227 offset:51200
v_mfma_f32_16x16x32_bf16 v[28:31], v[148:151], a[60:63], v[28:31]
buffer_load_dwordx4 v237, s[92:95], s63 offen offset:1024  lds
v_mfma_f32_16x16x32_bf16 v[28:31], v[144:147], a[52:55], v[28:31]
ds_read_b64_tr_b16 v[140:141], v227 offset:53248
ds_read_b64_tr_b16 v[142:143], v227 offset:55296
v_mfma_f32_16x16x32_bf16 v[28:31], v[156:159], a[44:47], v[28:31]
ds_read_b64_tr_b16 v[128:129], v227 offset:57344
v_mfma_f32_16x16x32_bf16 v[28:31], v[152:155], a[36:39], v[28:31]
ds_read_b64_tr_b16 v[130:131], v227 offset:59392
s_waitcnt lgkmcnt(6)
v_mfma_f32_16x16x32_bf16 v[32:35], a[8:11], a[32:35], v[32:35]
s_waitcnt vmcnt(22)
s_barrier
v_mfma_f32_16x16x32_bf16 v[32:35], a[12:15], a[40:43], v[32:35]
ds_read_b64_tr_b16 v[132:133], v227 offset:61440
ds_read_b64_tr_b16 v[134:135], v227 offset:63488
v_mfma_f32_16x16x32_bf16 v[32:35], a[0:3], a[48:51], v[32:35]
buffer_load_dwordx4 a[160:163], v198, s[32:35], s90 offen sc1
v_mfma_f32_16x16x32_bf16 v[32:35], a[4:7], a[56:59], v[32:35]
ds_read_b64_tr_b16 v[148:149], v228 offset:0
ds_read_b64_tr_b16 v[150:151], v228 offset:2048
v_mfma_f32_16x16x32_bf16 v[36:39], a[4:7], a[60:63], v[36:39]
buffer_load_dwordx4 a[164:167], v239, s[32:35], s90 offen sc1
v_mfma_f32_16x16x32_bf16 v[36:39], a[0:3], a[52:55], v[36:39]
ds_read_b64_tr_b16 v[144:145], v228 offset:4096
ds_read_b64_tr_b16 v[146:147], v228 offset:6144
v_mfma_f32_16x16x32_bf16 v[36:39], a[12:15], a[44:47], v[36:39]
ds_read_b64_tr_b16 v[156:157], v228 offset:8192
v_mfma_f32_16x16x32_bf16 v[36:39], a[8:11], a[36:39], v[36:39]
ds_read_b64_tr_b16 v[158:159], v228 offset:10240
s_waitcnt lgkmcnt(6)
v_mfma_f32_16x16x32_bf16 v[40:43], v[136:139], a[32:35], v[40:43]
buffer_load_dwordx4 a[168:171], v248, s[32:35], s90 offen sc1
v_mfma_f32_16x16x32_bf16 v[40:43], v[140:143], a[40:43], v[40:43]
ds_read_b64_tr_b16 v[152:153], v228 offset:12288
ds_read_b64_tr_b16 v[154:155], v228 offset:14336
v_mfma_f32_16x16x32_bf16 v[40:43], v[128:131], a[48:51], v[40:43]
ds_read_b64_tr_b16 a[4:5], v229 offset:0
v_mfma_f32_16x16x32_bf16 v[40:43], v[132:135], a[56:59], v[40:43]
ds_read_b64_tr_b16 a[6:7], v229 offset:2048
v_mfma_f32_16x16x32_bf16 v[44:47], v[132:135], a[60:63], v[44:47]
buffer_load_dwordx4 a[172:175], v249, s[32:35], s90 offen sc1
v_mfma_f32_16x16x32_bf16 v[44:47], v[128:131], a[52:55], v[44:47]
ds_read_b64_tr_b16 a[0:1], v229 offset:4096
ds_read_b64_tr_b16 a[2:3], v229 offset:6144
v_mfma_f32_16x16x32_bf16 v[44:47], v[140:143], a[44:47], v[44:47]
ds_read_b64_tr_b16 a[12:13], v229 offset:8192
s_add_u32 m0, s62, 81920
v_mfma_f32_16x16x32_bf16 v[44:47], v[136:139], a[36:39], v[44:47]
ds_read_b64_tr_b16 a[14:15], v229 offset:10240
s_waitcnt lgkmcnt(6)
v_mfma_f32_16x16x32_bf16 v[16:19], v[148:151], a[64:67], v[16:19]
ds_read_b64_tr_b16 a[8:9], v229 offset:12288
s_lshl_b32 s63, s90, 4
v_mfma_f32_16x16x32_bf16 v[16:19], v[144:147], a[72:75], v[16:19]
ds_read_b64_tr_b16 a[10:11], v229 offset:14336
v_mfma_f32_16x16x32_bf16 v[16:19], v[156:159], a[80:83], v[16:19]
buffer_load_dwordx4 v236, s[92:95], s63 offen offset:0  lds
v_mfma_f32_16x16x32_bf16 v[16:19], v[152:155], a[88:91], v[16:19]
ds_read_b64_tr_b16 v[132:133], v230 offset:0
ds_read_b64_tr_b16 v[134:135], v230 offset:2048
v_mfma_f32_16x16x32_bf16 v[20:23], v[152:155], a[92:95], v[20:23]
buffer_load_dwordx4 v237, s[92:95], s63 offen offset:1024  lds
v_mfma_f32_16x16x32_bf16 v[20:23], v[156:159], a[84:87], v[20:23]
ds_read_b64_tr_b16 v[128:129], v230 offset:4096
ds_read_b64_tr_b16 v[130:131], v230 offset:6144
v_mfma_f32_16x16x32_bf16 v[20:23], v[144:147], a[76:79], v[20:23]
ds_read_b64_tr_b16 v[140:141], v230 offset:8192
v_mfma_f32_16x16x32_bf16 v[20:23], v[148:151], a[68:71], v[20:23]
ds_read_b64_tr_b16 v[142:143], v230 offset:10240
s_waitcnt lgkmcnt(6)
v_mfma_f32_16x16x32_bf16 v[24:27], a[4:7], a[64:67], v[24:27]
buffer_load_dwordx4 a[176:179], v198, s[32:35], s91 offen sc1
v_mfma_f32_16x16x32_bf16 v[24:27], a[0:3], a[72:75], v[24:27]
ds_read_b64_tr_b16 v[136:137], v230 offset:12288
ds_read_b64_tr_b16 v[138:139], v230 offset:14336
v_mfma_f32_16x16x32_bf16 v[24:27], a[12:15], a[80:83], v[24:27]
ds_read_b64_tr_b16 v[152:153], v231 offset:0
v_mfma_f32_16x16x32_bf16 v[24:27], a[8:11], a[88:91], v[24:27]
ds_read_b64_tr_b16 v[154:155], v231 offset:2048
v_mfma_f32_16x16x32_bf16 v[28:31], a[8:11], a[92:95], v[28:31]
buffer_load_dwordx4 a[180:183], v239, s[32:35], s91 offen sc1
v_mfma_f32_16x16x32_bf16 v[28:31], a[12:15], a[84:87], v[28:31]
ds_read_b64_tr_b16 v[156:157], v231 offset:4096
ds_read_b64_tr_b16 v[158:159], v231 offset:6144
v_mfma_f32_16x16x32_bf16 v[28:31], a[0:3], a[76:79], v[28:31]
ds_read_b64_tr_b16 v[144:145], v231 offset:8192
v_mfma_f32_16x16x32_bf16 v[28:31], a[4:7], a[68:71], v[28:31]
ds_read_b64_tr_b16 v[146:147], v231 offset:10240
s_waitcnt lgkmcnt(6)
v_mfma_f32_16x16x32_bf16 v[32:35], v[132:135], a[64:67], v[32:35]
s_waitcnt vmcnt(22)
s_barrier
v_mfma_f32_16x16x32_bf16 v[32:35], v[128:131], a[72:75], v[32:35]
ds_read_b64_tr_b16 v[148:149], v231 offset:12288
ds_read_b64_tr_b16 v[150:151], v231 offset:14336
v_mfma_f32_16x16x32_bf16 v[32:35], v[140:143], a[80:83], v[32:35]
buffer_load_dwordx4 a[184:187], v248, s[32:35], s91 offen sc1
v_mfma_f32_16x16x32_bf16 v[32:35], v[136:139], a[88:91], v[32:35]
ds_read_b64_tr_b16 a[8:9], v224 offset:0
ds_read_b64_tr_b16 a[10:11], v224 offset:2048
v_mfma_f32_16x16x32_bf16 v[36:39], v[136:139], a[92:95], v[36:39]
ds_read_b64_tr_b16 a[12:13], v224 offset:4096
v_mfma_f32_16x16x32_bf16 v[36:39], v[140:143], a[84:87], v[36:39]
ds_read_b64_tr_b16 a[14:15], v224 offset:6144
v_mfma_f32_16x16x32_bf16 v[36:39], v[128:131], a[76:79], v[36:39]
buffer_load_dwordx4 a[188:191], v249, s[32:35], s91 offen sc1
v_mfma_f32_16x16x32_bf16 v[36:39], v[132:135], a[68:71], v[36:39]
ds_read_b64_tr_b16 a[0:1], v224 offset:8192
s_waitcnt lgkmcnt(5)
v_mfma_f32_16x16x32_bf16 v[40:43], v[152:155], a[64:67], v[40:43]
ds_read_b64_tr_b16 a[2:3], v224 offset:10240
ds_read_b64_tr_b16 a[4:5], v224 offset:12288
v_mfma_f32_16x16x32_bf16 v[40:43], v[156:159], a[72:75], v[40:43]
ds_read_b64_tr_b16 a[6:7], v224 offset:14336
s_add_u32 m0, s62, 98304
v_mfma_f32_16x16x32_bf16 v[40:43], v[144:147], a[80:83], v[40:43]
ds_read_b64_tr_b16 v[136:137], v225 offset:0
s_lshl_b32 s63, s78, 4
v_mfma_f32_16x16x32_bf16 v[40:43], v[148:151], a[88:91], v[40:43]
buffer_load_dwordx4 v236, s[96:99], s63 offen offset:0  lds
v_mfma_f32_16x16x32_bf16 v[44:47], v[148:151], a[92:95], v[44:47]
ds_read_b64_tr_b16 v[138:139], v225 offset:2048
ds_read_b64_tr_b16 v[140:141], v225 offset:4096
v_mfma_f32_16x16x32_bf16 v[44:47], v[144:147], a[84:87], v[44:47]
ds_read_b64_tr_b16 v[142:143], v225 offset:6144
v_mfma_f32_16x16x32_bf16 v[44:47], v[156:159], a[76:79], v[44:47]
ds_read_b64_tr_b16 v[128:129], v225 offset:8192
v_mfma_f32_16x16x32_bf16 v[44:47], v[152:155], a[68:71], v[44:47]
ds_read_b64_tr_b16 v[130:131], v225 offset:10240
s_waitcnt lgkmcnt(6)
v_mfma_f32_16x16x32_bf16 v[16:19], a[8:11], a[96:99], v[16:19]
buffer_load_dwordx4 v237, s[96:99], s63 offen offset:1024  lds
v_mfma_f32_16x16x32_bf16 v[16:19], a[12:15], a[104:107], v[16:19]
ds_read_b64_tr_b16 v[132:133], v225 offset:12288
ds_read_b64_tr_b16 v[134:135], v225 offset:14336
v_mfma_f32_16x16x32_bf16 v[16:19], a[0:3], a[112:115], v[16:19]
ds_read_b64_tr_b16 v[148:149], v226 offset:0
v_mfma_f32_16x16x32_bf16 v[16:19], a[4:7], a[120:123], v[16:19]
ds_read_b64_tr_b16 v[150:151], v226 offset:2048
s_add_u32 m0, s62, 106496
v_mfma_f32_16x16x32_bf16 v[20:23], a[4:7], a[124:127], v[20:23]
ds_read_b64_tr_b16 v[144:145], v226 offset:4096
s_lshl_b32 s63, s79, 4
v_mfma_f32_16x16x32_bf16 v[20:23], a[0:3], a[116:119], v[20:23]
buffer_load_dwordx4 v236, s[96:99], s63 offen offset:0  lds
v_mfma_f32_16x16x32_bf16 v[20:23], a[12:15], a[108:111], v[20:23]
ds_read_b64_tr_b16 v[146:147], v226 offset:6144
ds_read_b64_tr_b16 v[156:157], v226 offset:8192
v_mfma_f32_16x16x32_bf16 v[20:23], a[8:11], a[100:103], v[20:23]
ds_read_b64_tr_b16 v[158:159], v226 offset:10240
s_waitcnt lgkmcnt(6)
v_mfma_f32_16x16x32_bf16 v[24:27], v[136:139], a[96:99], v[24:27]
ds_read_b64_tr_b16 v[152:153], v226 offset:12288
v_mfma_f32_16x16x32_bf16 v[24:27], v[140:143], a[104:107], v[24:27]
ds_read_b64_tr_b16 v[154:155], v226 offset:14336
v_mfma_f32_16x16x32_bf16 v[24:27], v[128:131], a[112:115], v[24:27]
buffer_load_dwordx4 v237, s[96:99], s63 offen offset:1024  lds
v_mfma_f32_16x16x32_bf16 v[24:27], v[132:135], a[120:123], v[24:27]
ds_read_b64_tr_b16 a[4:5], v227 offset:0
ds_read_b64_tr_b16 a[6:7], v227 offset:2048
v_mfma_f32_16x16x32_bf16 v[28:31], v[132:135], a[124:127], v[28:31]
ds_read_b64_tr_b16 a[0:1], v227 offset:4096
v_mfma_f32_16x16x32_bf16 v[28:31], v[128:131], a[116:119], v[28:31]
ds_read_b64_tr_b16 a[2:3], v227 offset:6144
v_mfma_f32_16x16x32_bf16 v[28:31], v[140:143], a[108:111], v[28:31]
ds_read_b64_tr_b16 a[12:13], v227 offset:8192
v_mfma_f32_16x16x32_bf16 v[28:31], v[136:139], a[100:103], v[28:31]
ds_read_b64_tr_b16 a[14:15], v227 offset:10240
s_waitcnt lgkmcnt(6)
v_mfma_f32_16x16x32_bf16 v[32:35], v[148:151], a[96:99], v[32:35]
s_waitcnt vmcnt(16)
s_barrier
v_mfma_f32_16x16x32_bf16 v[32:35], v[144:147], a[104:107], v[32:35]
ds_read_b64_tr_b16 a[8:9], v227 offset:12288
ds_read_b64_tr_b16 a[10:11], v227 offset:14336
v_mfma_f32_16x16x32_bf16 v[32:35], v[156:159], a[112:115], v[32:35]
ds_read_b64_tr_b16 v[132:133], v224 offset:16384
s_add_u32 m0, s62, 114688
v_mfma_f32_16x16x32_bf16 v[32:35], v[152:155], a[120:123], v[32:35]
ds_read_b64_tr_b16 v[134:135], v224 offset:18432
s_lshl_b32 s63, s80, 4
v_mfma_f32_16x16x32_bf16 v[36:39], v[152:155], a[124:127], v[36:39]
buffer_load_dwordx4 v236, s[96:99], s63 offen offset:0  lds
v_mfma_f32_16x16x32_bf16 v[36:39], v[156:159], a[116:119], v[36:39]
ds_read_b64_tr_b16 v[128:129], v224 offset:20480
ds_read_b64_tr_b16 v[130:131], v224 offset:22528
v_mfma_f32_16x16x32_bf16 v[36:39], v[144:147], a[108:111], v[36:39]
ds_read_b64_tr_b16 v[140:141], v224 offset:24576
v_mfma_f32_16x16x32_bf16 v[36:39], v[148:151], a[100:103], v[36:39]
ds_read_b64_tr_b16 v[142:143], v224 offset:26624
s_waitcnt lgkmcnt(6)
v_mfma_f32_16x16x32_bf16 v[40:43], a[4:7], a[96:99], v[40:43]
buffer_load_dwordx4 v237, s[96:99], s63 offen offset:1024  lds
v_mfma_f32_16x16x32_bf16 v[40:43], a[0:3], a[104:107], v[40:43]
ds_read_b64_tr_b16 v[136:137], v224 offset:28672
ds_read_b64_tr_b16 v[138:139], v224 offset:30720
v_mfma_f32_16x16x32_bf16 v[40:43], a[12:15], a[112:115], v[40:43]
ds_read_b64_tr_b16 v[152:153], v225 offset:16384
v_mfma_f32_16x16x32_bf16 v[40:43], a[8:11], a[120:123], v[40:43]
ds_read_b64_tr_b16 v[154:155], v225 offset:18432
v_mfma_f32_16x16x32_bf16 v[44:47], a[8:11], a[124:127], v[44:47]
ds_read_b64_tr_b16 v[156:157], v225 offset:20480
v_mfma_f32_16x16x32_bf16 v[44:47], a[12:15], a[116:119], v[44:47]
ds_read_b64_tr_b16 v[158:159], v225 offset:22528
v_mfma_f32_16x16x32_bf16 v[44:47], a[0:3], a[108:111], v[44:47]
ds_read_b64_tr_b16 v[144:145], v225 offset:24576
s_add_u32 m0, s62, 122880
v_mfma_f32_16x16x32_bf16 v[44:47], a[4:7], a[100:103], v[44:47]
ds_read_b64_tr_b16 v[146:147], v225 offset:26624
s_waitcnt lgkmcnt(6)
v_mfma_f32_16x16x32_bf16 v[16:19], v[132:135], a[128:131], v[16:19]
ds_read_b64_tr_b16 v[148:149], v225 offset:28672
s_lshl4_add_u32 s63, s81, s37
v_mfma_f32_16x16x32_bf16 v[16:19], v[128:131], a[136:139], v[16:19]
ds_read_b64_tr_b16 v[150:151], v225 offset:30720
v_mfma_f32_16x16x32_bf16 v[16:19], v[140:143], a[144:147], v[16:19]
buffer_load_dwordx4 v236, s[96:99], s63 offen offset:0  lds
v_mfma_f32_16x16x32_bf16 v[16:19], v[136:139], a[152:155], v[16:19]
ds_read_b64_tr_b16 a[8:9], v226 offset:16384
ds_read_b64_tr_b16 a[10:11], v226 offset:18432
v_mfma_f32_16x16x32_bf16 v[20:23], v[136:139], a[156:159], v[20:23]
ds_read_b64_tr_b16 a[12:13], v226 offset:20480
v_mfma_f32_16x16x32_bf16 v[20:23], v[140:143], a[148:151], v[20:23]
ds_read_b64_tr_b16 a[14:15], v226 offset:22528
v_mfma_f32_16x16x32_bf16 v[20:23], v[128:131], a[140:143], v[20:23]
ds_read_b64_tr_b16 a[0:1], v226 offset:24576
v_mfma_f32_16x16x32_bf16 v[20:23], v[132:135], a[132:135], v[20:23]
ds_read_b64_tr_b16 a[2:3], v226 offset:26624
s_waitcnt lgkmcnt(6)
v_mfma_f32_16x16x32_bf16 v[24:27], v[152:155], a[128:131], v[24:27]
buffer_load_dwordx4 v237, s[96:99], s63 offen offset:1024  lds
v_mfma_f32_16x16x32_bf16 v[24:27], v[156:159], a[136:139], v[24:27]
ds_read_b64_tr_b16 a[4:5], v226 offset:28672
ds_read_b64_tr_b16 a[6:7], v226 offset:30720
v_mfma_f32_16x16x32_bf16 v[24:27], v[144:147], a[144:147], v[24:27]
ds_read_b64_tr_b16 v[136:137], v227 offset:16384
v_mfma_f32_16x16x32_bf16 v[24:27], v[148:151], a[152:155], v[24:27]
ds_read_b64_tr_b16 v[138:139], v227 offset:18432
v_mfma_f32_16x16x32_bf16 v[28:31], v[148:151], a[156:159], v[28:31]
ds_read_b64_tr_b16 v[140:141], v227 offset:20480
v_mfma_f32_16x16x32_bf16 v[28:31], v[144:147], a[148:151], v[28:31]
ds_read_b64_tr_b16 v[142:143], v227 offset:22528
v_mfma_f32_16x16x32_bf16 v[28:31], v[156:159], a[140:143], v[28:31]
ds_read_b64_tr_b16 v[128:129], v227 offset:24576
v_mfma_f32_16x16x32_bf16 v[28:31], v[152:155], a[132:135], v[28:31]
ds_read_b64_tr_b16 v[130:131], v227 offset:26624
s_waitcnt lgkmcnt(6)
v_mfma_f32_16x16x32_bf16 v[32:35], a[8:11], a[128:131], v[32:35]
s_waitcnt vmcnt(8)
s_barrier
v_mfma_f32_16x16x32_bf16 v[32:35], a[12:15], a[136:139], v[32:35]
ds_read_b64_tr_b16 v[132:133], v227 offset:28672
ds_read_b64_tr_b16 v[134:135], v227 offset:30720
v_mfma_f32_16x16x32_bf16 v[32:35], a[0:3], a[144:147], v[32:35]
ds_read_b64_tr_b16 v[148:149], v228 offset:16384
s_add_u32 m0, s62, 131072
v_mfma_f32_16x16x32_bf16 v[32:35], a[4:7], a[152:155], v[32:35]
ds_read_b64_tr_b16 v[150:151], v228 offset:18432
s_lshl_b32 s63, s82, 4
v_mfma_f32_16x16x32_bf16 v[36:39], a[4:7], a[156:159], v[36:39]
buffer_load_dwordx4 v236, s[96:99], s63 offen offset:0  lds
v_mfma_f32_16x16x32_bf16 v[36:39], a[0:3], a[148:151], v[36:39]
ds_read_b64_tr_b16 v[144:145], v228 offset:20480
ds_read_b64_tr_b16 v[146:147], v228 offset:22528
v_mfma_f32_16x16x32_bf16 v[36:39], a[12:15], a[140:143], v[36:39]
ds_read_b64_tr_b16 v[156:157], v228 offset:24576
v_mfma_f32_16x16x32_bf16 v[36:39], a[8:11], a[132:135], v[36:39]
ds_read_b64_tr_b16 v[158:159], v228 offset:26624
s_waitcnt lgkmcnt(6)
v_mfma_f32_16x16x32_bf16 v[40:43], v[136:139], a[128:131], v[40:43]
buffer_load_dwordx4 v237, s[96:99], s63 offen offset:1024  lds
v_mfma_f32_16x16x32_bf16 v[40:43], v[140:143], a[136:139], v[40:43]
ds_read_b64_tr_b16 v[152:153], v228 offset:28672
ds_read_b64_tr_b16 v[154:155], v228 offset:30720
v_mfma_f32_16x16x32_bf16 v[40:43], v[128:131], a[144:147], v[40:43]
ds_read_b64_tr_b16 a[4:5], v229 offset:16384
v_mfma_f32_16x16x32_bf16 v[40:43], v[132:135], a[152:155], v[40:43]
ds_read_b64_tr_b16 a[6:7], v229 offset:18432
v_mfma_f32_16x16x32_bf16 v[44:47], v[132:135], a[156:159], v[44:47]
ds_read_b64_tr_b16 a[0:1], v229 offset:20480
v_mfma_f32_16x16x32_bf16 v[44:47], v[128:131], a[148:151], v[44:47]
ds_read_b64_tr_b16 a[2:3], v229 offset:22528
v_mfma_f32_16x16x32_bf16 v[44:47], v[140:143], a[140:143], v[44:47]
ds_read_b64_tr_b16 a[12:13], v229 offset:24576
s_add_u32 m0, s62, 139264
v_mfma_f32_16x16x32_bf16 v[44:47], v[136:139], a[132:135], v[44:47]
ds_read_b64_tr_b16 a[14:15], v229 offset:26624
s_waitcnt lgkmcnt(6)
v_mfma_f32_16x16x32_bf16 v[16:19], v[148:151], a[160:163], v[16:19]
ds_read_b64_tr_b16 a[8:9], v229 offset:28672
s_lshl_b32 s63, s83, 4
v_mfma_f32_16x16x32_bf16 v[16:19], v[144:147], a[168:171], v[16:19]
ds_read_b64_tr_b16 a[10:11], v229 offset:30720
v_mfma_f32_16x16x32_bf16 v[16:19], v[156:159], a[176:179], v[16:19]
buffer_load_dwordx4 v236, s[96:99], s63 offen offset:0  lds
v_mfma_f32_16x16x32_bf16 v[16:19], v[152:155], a[184:187], v[16:19]
ds_read_b64_tr_b16 v[132:133], v230 offset:16384
ds_read_b64_tr_b16 v[134:135], v230 offset:18432
v_mfma_f32_16x16x32_bf16 v[20:23], v[152:155], a[188:191], v[20:23]
ds_read_b64_tr_b16 v[128:129], v230 offset:20480
v_mfma_f32_16x16x32_bf16 v[20:23], v[156:159], a[180:183], v[20:23]
ds_read_b64_tr_b16 v[130:131], v230 offset:22528
v_mfma_f32_16x16x32_bf16 v[20:23], v[144:147], a[172:175], v[20:23]
ds_read_b64_tr_b16 v[140:141], v230 offset:24576
v_mfma_f32_16x16x32_bf16 v[20:23], v[148:151], a[164:167], v[20:23]
ds_read_b64_tr_b16 v[142:143], v230 offset:26624
s_waitcnt lgkmcnt(6)
v_mfma_f32_16x16x32_bf16 v[24:27], a[4:7], a[160:163], v[24:27]
buffer_load_dwordx4 v237, s[96:99], s63 offen offset:1024  lds
v_mfma_f32_16x16x32_bf16 v[24:27], a[0:3], a[168:171], v[24:27]
ds_read_b64_tr_b16 v[136:137], v230 offset:28672
ds_read_b64_tr_b16 v[138:139], v230 offset:30720
v_mfma_f32_16x16x32_bf16 v[24:27], a[12:15], a[176:179], v[24:27]
ds_read_b64_tr_b16 v[152:153], v231 offset:16384
v_mfma_f32_16x16x32_bf16 v[24:27], a[8:11], a[184:187], v[24:27]
ds_read_b64_tr_b16 v[154:155], v231 offset:18432
v_mfma_f32_16x16x32_bf16 v[28:31], a[8:11], a[188:191], v[28:31]
ds_read_b64_tr_b16 v[156:157], v231 offset:20480
v_mfma_f32_16x16x32_bf16 v[28:31], a[12:15], a[180:183], v[28:31]
ds_read_b64_tr_b16 v[158:159], v231 offset:22528
v_mfma_f32_16x16x32_bf16 v[28:31], a[0:3], a[172:175], v[28:31]
v_cvt_pk_bf16_f32 v112, v16, v17
v_cvt_pk_bf16_f32 v113, v18, v19
v_mfma_f32_16x16x32_bf16 v[28:31], a[4:7], a[164:167], v[28:31]
v_cvt_pk_bf16_f32 v114, v20, v21
v_cvt_pk_bf16_f32 v115, v22, v23
s_waitcnt lgkmcnt(4)
v_mfma_f32_16x16x32_bf16 v[32:35], v[132:135], a[160:163], v[32:35]
s_waitcnt vmcnt(8)
s_barrier
v_mfma_f32_16x16x32_bf16 v[32:35], v[128:131], a[168:171], v[32:35]
buffer_store_dwordx4 v[112:115], v198, s[32:35], s12 offen sc1
ds_read_b64_tr_b16 v[144:145], v231 offset:24576
ds_read_b64_tr_b16 v[146:147], v231 offset:26624
ds_read_b64_tr_b16 v[148:149], v231 offset:28672
ds_read_b64_tr_b16 v[150:151], v231 offset:30720
v_mfma_f32_16x16x32_bf16 v[32:35], v[140:143], a[176:179], v[32:35]
ds_read_b64_tr_b16 a[8:9], v228 offset:32768
s_add_u32 m0, s62, 147456
v_mfma_f32_16x16x32_bf16 v[32:35], v[136:139], a[184:187], v[32:35]
ds_read_b64_tr_b16 a[10:11], v228 offset:34816
s_lshl_b32 s63, s84, 4
v_mfma_f32_16x16x32_bf16 v[36:39], v[136:139], a[188:191], v[36:39]
buffer_load_dwordx4 v236, s[96:99], s63 offen offset:0  lds
v_mfma_f32_16x16x32_bf16 v[36:39], v[140:143], a[180:183], v[36:39]
ds_read_b64_tr_b16 a[12:13], v228 offset:36864
ds_read_b64_tr_b16 a[14:15], v228 offset:38912
v_mfma_f32_16x16x32_bf16 v[36:39], v[128:131], a[172:175], v[36:39]
v_cvt_pk_bf16_f32 v116, v24, v25
v_cvt_pk_bf16_f32 v117, v26, v27
v_mfma_f32_16x16x32_bf16 v[36:39], v[132:135], a[164:167], v[36:39]
v_cvt_pk_bf16_f32 v118, v28, v29
v_cvt_pk_bf16_f32 v119, v30, v31
s_waitcnt lgkmcnt(4)
v_mfma_f32_16x16x32_bf16 v[40:43], v[152:155], a[160:163], v[40:43]
buffer_store_dwordx4 v[116:119], v239, s[32:35], s12 offen sc1
v_mfma_f32_16x16x32_bf16 v[40:43], v[156:159], a[168:171], v[40:43]
ds_read_b64_tr_b16 a[0:1], v228 offset:40960
ds_read_b64_tr_b16 a[2:3], v228 offset:43008
ds_read_b64_tr_b16 a[4:5], v228 offset:45056
ds_read_b64_tr_b16 a[6:7], v228 offset:47104
v_mfma_f32_16x16x32_bf16 v[40:43], v[144:147], a[176:179], v[40:43]
buffer_load_dwordx4 v237, s[96:99], s63 offen offset:1024  lds
v_mfma_f32_16x16x32_bf16 v[40:43], v[148:151], a[184:187], v[40:43]
ds_read_b64_tr_b16 v[136:137], v229 offset:32768
ds_read_b64_tr_b16 v[138:139], v229 offset:34816
v_mfma_f32_16x16x32_bf16 v[44:47], v[148:151], a[188:191], v[44:47]
ds_read_b64_tr_b16 v[140:141], v229 offset:36864
v_mfma_f32_16x16x32_bf16 v[44:47], v[144:147], a[180:183], v[44:47]
ds_read_b64_tr_b16 v[142:143], v229 offset:38912
v_mfma_f32_16x16x32_bf16 v[44:47], v[156:159], a[172:175], v[44:47]
v_cvt_pk_bf16_f32 v120, v32, v33
v_cvt_pk_bf16_f32 v121, v34, v35
v_mfma_f32_16x16x32_bf16 v[44:47], v[152:155], a[164:167], v[44:47]
v_cvt_pk_bf16_f32 v122, v36, v37
v_cvt_pk_bf16_f32 v123, v38, v39
s_waitcnt lgkmcnt(4)
v_mfma_f32_16x16x32_bf16 v[48:51], a[8:11], a[224:227], v[48:51]
buffer_store_dwordx4 v[120:123], v248, s[32:35], s12 offen sc1
v_mfma_f32_16x16x32_bf16 v[48:51], a[12:15], a[232:235], v[48:51]
ds_read_b64_tr_b16 v[128:129], v229 offset:40960
ds_read_b64_tr_b16 v[130:131], v229 offset:43008
ds_read_b64_tr_b16 v[132:133], v229 offset:45056
ds_read_b64_tr_b16 v[134:135], v229 offset:47104
s_add_u32 m0, s62, 155648
s_lshl_b32 s63, s85, 4
v_mfma_f32_16x16x32_bf16 v[48:51], a[0:3], a[240:243], v[48:51]
buffer_load_dwordx4 v236, s[96:99], s63 offen offset:0  lds
v_mfma_f32_16x16x32_bf16 v[48:51], a[4:7], a[248:251], v[48:51]
ds_read_b64_tr_b16 v[148:149], v230 offset:32768
ds_read_b64_tr_b16 v[150:151], v230 offset:34816
v_mfma_f32_16x16x32_bf16 v[52:55], a[4:7], a[252:255], v[52:55]
ds_read_b64_tr_b16 v[144:145], v230 offset:36864
v_mfma_f32_16x16x32_bf16 v[52:55], a[0:3], a[244:247], v[52:55]
ds_read_b64_tr_b16 v[146:147], v230 offset:38912
v_mfma_f32_16x16x32_bf16 v[52:55], a[12:15], a[236:239], v[52:55]
v_cvt_pk_bf16_f32 v124, v40, v41
v_cvt_pk_bf16_f32 v125, v42, v43
v_mfma_f32_16x16x32_bf16 v[52:55], a[8:11], a[228:231], v[52:55]
v_cvt_pk_bf16_f32 v126, v44, v45
v_cvt_pk_bf16_f32 v127, v46, v47
s_waitcnt lgkmcnt(4)
v_mfma_f32_16x16x32_bf16 v[56:59], v[136:139], a[224:227], v[56:59]
buffer_store_dwordx4 v[124:127], v249, s[32:35], s12 offen sc1
v_mfma_f32_16x16x32_bf16 v[56:59], v[140:143], a[232:235], v[56:59]
ds_read_b64_tr_b16 v[156:157], v230 offset:40960
ds_read_b64_tr_b16 v[158:159], v230 offset:43008
ds_read_b64_tr_b16 v[152:153], v230 offset:45056
ds_read_b64_tr_b16 v[154:155], v230 offset:47104
v_mfma_f32_16x16x32_bf16 v[56:59], v[128:131], a[240:243], v[56:59]
buffer_load_dwordx4 v237, s[96:99], s63 offen offset:1024  lds
v_mfma_f32_16x16x32_bf16 v[56:59], v[132:135], a[248:251], v[56:59]
ds_read_b64_tr_b16 a[4:5], v231 offset:32768
ds_read_b64_tr_b16 a[6:7], v231 offset:34816
v_mfma_f32_16x16x32_bf16 v[60:63], v[132:135], a[252:255], v[60:63]
ds_read_b64_tr_b16 a[0:1], v231 offset:36864
v_mfma_f32_16x16x32_bf16 v[60:63], v[128:131], a[244:247], v[60:63]
ds_read_b64_tr_b16 a[2:3], v231 offset:38912
v_mfma_f32_16x16x32_bf16 v[60:63], v[140:143], a[236:239], v[60:63]
ds_read_b64_tr_b16 a[12:13], v231 offset:40960
v_mfma_f32_16x16x32_bf16 v[60:63], v[136:139], a[228:231], v[60:63]
ds_read_b64_tr_b16 a[14:15], v231 offset:43008
s_waitcnt lgkmcnt(6)
v_mfma_f32_16x16x32_bf16 v[64:67], v[148:151], a[224:227], v[64:67]
s_waitcnt vmcnt(12)
s_barrier
v_mfma_f32_16x16x32_bf16 v[64:67], v[144:147], a[232:235], v[64:67]
ds_read_b64_tr_b16 a[8:9], v231 offset:45056
ds_read_b64_tr_b16 a[10:11], v231 offset:47104
v_mfma_f32_16x16x32_bf16 v[64:67], v[156:159], a[240:243], v[64:67]
ds_read_b64_tr_b16 v[132:133], v228 offset:49152
s_add_u32 m0, s62, 32768
v_mfma_f32_16x16x32_bf16 v[64:67], v[152:155], a[248:251], v[64:67]
ds_read_b64_tr_b16 v[134:135], v228 offset:51200
s_lshl_b32 s63, s86, 4
v_mfma_f32_16x16x32_bf16 v[68:71], v[152:155], a[252:255], v[68:71]
buffer_load_dwordx4 v236, s[96:99], s63 offen offset:0  lds
v_mfma_f32_16x16x32_bf16 v[68:71], v[156:159], a[244:247], v[68:71]
ds_read_b64_tr_b16 v[128:129], v228 offset:53248
ds_read_b64_tr_b16 v[130:131], v228 offset:55296
v_mfma_f32_16x16x32_bf16 v[68:71], v[144:147], a[236:239], v[68:71]
ds_read_b64_tr_b16 v[140:141], v228 offset:57344
v_mfma_f32_16x16x32_bf16 v[68:71], v[148:151], a[228:231], v[68:71]
ds_read_b64_tr_b16 v[142:143], v228 offset:59392
s_waitcnt lgkmcnt(6)
v_mfma_f32_16x16x32_bf16 v[72:75], a[4:7], a[224:227], v[72:75]
ds_read_b64_tr_b16 v[136:137], v228 offset:61440
v_mfma_f32_16x16x32_bf16 v[72:75], a[0:3], a[232:235], v[72:75]
ds_read_b64_tr_b16 v[138:139], v228 offset:63488
v_mfma_f32_16x16x32_bf16 v[72:75], a[12:15], a[240:243], v[72:75]
ds_read_b64_tr_b16 v[152:153], v229 offset:49152
v_mfma_f32_16x16x32_bf16 v[72:75], a[8:11], a[248:251], v[72:75]
buffer_load_dwordx4 v237, s[96:99], s63 offen offset:1024  lds
v_mfma_f32_16x16x32_bf16 v[76:79], a[8:11], a[252:255], v[76:79]
ds_read_b64_tr_b16 v[154:155], v229 offset:51200
ds_read_b64_tr_b16 v[156:157], v229 offset:53248
v_mfma_f32_16x16x32_bf16 v[76:79], a[12:15], a[244:247], v[76:79]
ds_read_b64_tr_b16 v[158:159], v229 offset:55296
v_mfma_f32_16x16x32_bf16 v[76:79], a[0:3], a[236:239], v[76:79]
ds_read_b64_tr_b16 v[144:145], v229 offset:57344
v_mfma_f32_16x16x32_bf16 v[76:79], a[4:7], a[228:231], v[76:79]
ds_read_b64_tr_b16 v[146:147], v229 offset:59392
s_waitcnt lgkmcnt(6)
v_mfma_f32_16x16x32_bf16 v[48:51], v[132:135], v[176:179], v[48:51]
ds_read_b64_tr_b16 v[148:149], v229 offset:61440
s_add_u32 m0, s62, 40960
v_mfma_f32_16x16x32_bf16 v[48:51], v[128:131], v[184:187], v[48:51]
ds_read_b64_tr_b16 v[150:151], v229 offset:63488
s_lshl_b32 s63, s87, 4
v_mfma_f32_16x16x32_bf16 v[48:51], v[140:143], v[192:195], v[48:51]
buffer_load_dwordx4 v236, s[96:99], s63 offen offset:0  lds
v_mfma_f32_16x16x32_bf16 v[48:51], v[136:139], a[24:27], v[48:51]
ds_read_b64_tr_b16 a[8:9], v230 offset:49152
ds_read_b64_tr_b16 a[10:11], v230 offset:51200
v_mfma_f32_16x16x32_bf16 v[52:55], v[136:139], a[28:31], v[52:55]
ds_read_b64_tr_b16 a[12:13], v230 offset:53248
v_mfma_f32_16x16x32_bf16 v[52:55], v[140:143], v[12:15], v[52:55]
ds_read_b64_tr_b16 a[14:15], v230 offset:55296
v_mfma_f32_16x16x32_bf16 v[52:55], v[128:131], v[188:191], v[52:55]
ds_read_b64_tr_b16 a[0:1], v230 offset:57344
v_mfma_f32_16x16x32_bf16 v[52:55], v[132:135], v[180:183], v[52:55]
ds_read_b64_tr_b16 a[2:3], v230 offset:59392
s_waitcnt lgkmcnt(6)
v_mfma_f32_16x16x32_bf16 v[56:59], v[152:155], v[176:179], v[56:59]
ds_read_b64_tr_b16 a[4:5], v230 offset:61440
v_mfma_f32_16x16x32_bf16 v[56:59], v[156:159], v[184:187], v[56:59]
ds_read_b64_tr_b16 a[6:7], v230 offset:63488
v_mfma_f32_16x16x32_bf16 v[56:59], v[144:147], v[192:195], v[56:59]
buffer_load_dwordx4 v237, s[96:99], s63 offen offset:1024  lds
v_mfma_f32_16x16x32_bf16 v[56:59], v[148:151], a[24:27], v[56:59]
ds_read_b64_tr_b16 v[136:137], v231 offset:49152
ds_read_b64_tr_b16 v[138:139], v231 offset:51200
v_mfma_f32_16x16x32_bf16 v[60:63], v[148:151], a[28:31], v[60:63]
ds_read_b64_tr_b16 v[140:141], v231 offset:53248
v_mfma_f32_16x16x32_bf16 v[60:63], v[144:147], v[12:15], v[60:63]
ds_read_b64_tr_b16 v[142:143], v231 offset:55296
v_mfma_f32_16x16x32_bf16 v[60:63], v[156:159], v[188:191], v[60:63]
ds_read_b64_tr_b16 v[128:129], v231 offset:57344
v_mfma_f32_16x16x32_bf16 v[60:63], v[152:155], v[180:183], v[60:63]
ds_read_b64_tr_b16 v[130:131], v231 offset:59392
s_waitcnt lgkmcnt(6)
v_mfma_f32_16x16x32_bf16 v[64:67], a[8:11], v[176:179], v[64:67]
s_waitcnt vmcnt(12)
s_barrier
v_mfma_f32_16x16x32_bf16 v[64:67], a[12:15], v[184:187], v[64:67]
ds_read_b64_tr_b16 v[132:133], v231 offset:61440
ds_read_b64_tr_b16 v[134:135], v231 offset:63488
v_mfma_f32_16x16x32_bf16 v[64:67], a[0:3], v[192:195], v[64:67]
ds_read_b64_tr_b16 v[148:149], v232 offset:0
s_add_u32 m0, s62, 49152
v_mfma_f32_16x16x32_bf16 v[64:67], a[4:7], a[24:27], v[64:67]
ds_read_b64_tr_b16 v[150:151], v232 offset:2048
s_lshl_b32 s63, s88, 4
v_mfma_f32_16x16x32_bf16 v[68:71], a[4:7], a[28:31], v[68:71]
buffer_load_dwordx4 v236, s[96:99], s63 offen offset:0  lds
v_mfma_f32_16x16x32_bf16 v[68:71], a[0:3], v[12:15], v[68:71]
ds_read_b64_tr_b16 v[144:145], v232 offset:4096
ds_read_b64_tr_b16 v[146:147], v232 offset:6144
v_mfma_f32_16x16x32_bf16 v[68:71], a[12:15], v[188:191], v[68:71]
ds_read_b64_tr_b16 v[156:157], v232 offset:8192
v_mfma_f32_16x16x32_bf16 v[68:71], a[8:11], v[180:183], v[68:71]
L_pg8:
s_cbranch_execz L_pg_ret
s_waitcnt lgkmcnt(5)
v_mfma_f32_16x16x32_bf16 v[72:75], v[136:139], v[176:179], v[72:75]
buffer_load_dwordx4 v237, s[96:99], s63 offen offset:1024  lds
v_mfma_f32_16x16x32_bf16 v[72:75], v[140:143], v[184:187], v[72:75]
ds_read_b64_tr_b16 v[158:159], v232 offset:10240
ds_read_b64_tr_b16 v[152:153], v232 offset:12288
ds_read_b64_tr_b16 v[154:155], v232 offset:14336
v_mfma_f32_16x16x32_bf16 v[72:75], v[128:131], v[192:195], v[72:75]
ds_read_b64_tr_b16 a[4:5], v233 offset:0
v_mfma_f32_16x16x32_bf16 v[72:75], v[132:135], a[24:27], v[72:75]
ds_read_b64_tr_b16 a[6:7], v233 offset:2048
v_mfma_f32_16x16x32_bf16 v[76:79], v[132:135], a[28:31], v[76:79]
ds_read_b64_tr_b16 a[0:1], v233 offset:4096
v_mfma_f32_16x16x32_bf16 v[76:79], v[128:131], v[12:15], v[76:79]
ds_read_b64_tr_b16 a[2:3], v233 offset:6144
v_mfma_f32_16x16x32_bf16 v[76:79], v[140:143], v[188:191], v[76:79]
ds_read_b64_tr_b16 a[12:13], v233 offset:8192
s_add_u32 m0, s62, 57344
v_mfma_f32_16x16x32_bf16 v[76:79], v[136:139], v[180:183], v[76:79]
ds_read_b64_tr_b16 a[14:15], v233 offset:10240
s_waitcnt lgkmcnt(6)
v_mfma_f32_16x16x32_bf16 v[48:51], v[148:151], a[32:35], v[48:51]
ds_read_b64_tr_b16 a[8:9], v233 offset:12288
s_lshl_b32 s63, s89, 4
v_mfma_f32_16x16x32_bf16 v[48:51], v[144:147], a[40:43], v[48:51]
ds_read_b64_tr_b16 a[10:11], v233 offset:14336
v_mfma_f32_16x16x32_bf16 v[48:51], v[156:159], a[48:51], v[48:51]
buffer_load_dwordx4 v236, s[96:99], s63 offen offset:0  lds
v_mfma_f32_16x16x32_bf16 v[48:51], v[152:155], a[56:59], v[48:51]
ds_read_b64_tr_b16 v[132:133], v234 offset:0
ds_read_b64_tr_b16 v[134:135], v234 offset:2048
v_mfma_f32_16x16x32_bf16 v[52:55], v[152:155], a[60:63], v[52:55]
ds_read_b64_tr_b16 v[128:129], v234 offset:4096
v_mfma_f32_16x16x32_bf16 v[52:55], v[156:159], a[52:55], v[52:55]
ds_read_b64_tr_b16 v[130:131], v234 offset:6144
v_mfma_f32_16x16x32_bf16 v[52:55], v[144:147], a[44:47], v[52:55]
ds_read_b64_tr_b16 v[140:141], v234 offset:8192
s_waitcnt vmcnt(8)
v_mfma_f32_16x16x32_bf16 v[52:55], v[148:151], a[36:39], v[52:55]
buffer_store_dwordx2 v[240:241], v247, s[32:35], s10 offen sc1
s_waitcnt lgkmcnt(5)
v_mfma_f32_16x16x32_bf16 v[56:59], a[4:7], a[32:35], v[56:59]
buffer_load_dwordx4 v237, s[96:99], s63 offen offset:1024  lds
v_mfma_f32_16x16x32_bf16 v[56:59], a[0:3], a[40:43], v[56:59]
ds_read_b64_tr_b16 v[142:143], v234 offset:10240
ds_read_b64_tr_b16 v[136:137], v234 offset:12288
ds_read_b64_tr_b16 v[138:139], v234 offset:14336
v_mfma_f32_16x16x32_bf16 v[56:59], a[12:15], a[48:51], v[56:59]
ds_read_b64_tr_b16 v[152:153], v235 offset:0
v_mfma_f32_16x16x32_bf16 v[56:59], a[8:11], a[56:59], v[56:59]
ds_read_b64_tr_b16 v[154:155], v235 offset:2048
v_mfma_f32_16x16x32_bf16 v[60:63], a[8:11], a[60:63], v[60:63]
ds_read_b64_tr_b16 v[156:157], v235 offset:4096
v_mfma_f32_16x16x32_bf16 v[60:63], a[12:15], a[52:55], v[60:63]
ds_read_b64_tr_b16 v[158:159], v235 offset:6144
v_mfma_f32_16x16x32_bf16 v[60:63], a[0:3], a[44:47], v[60:63]
ds_read_b64_tr_b16 v[144:145], v235 offset:8192
v_mfma_f32_16x16x32_bf16 v[60:63], a[4:7], a[36:39], v[60:63]
ds_read_b64_tr_b16 v[146:147], v235 offset:10240
s_waitcnt lgkmcnt(6)
v_mfma_f32_16x16x32_bf16 v[64:67], v[132:135], a[32:35], v[64:67]
s_waitcnt vmcnt(9)
s_barrier
v_mfma_f32_16x16x32_bf16 v[64:67], v[128:131], a[40:43], v[64:67]
ds_read_b64_tr_b16 v[148:149], v235 offset:12288
ds_read_b64_tr_b16 v[150:151], v235 offset:14336
v_mfma_f32_16x16x32_bf16 v[64:67], v[140:143], a[48:51], v[64:67]
ds_read_b64_tr_b16 a[8:9], v232 offset:16384
s_add_u32 m0, s62, 65536
v_mfma_f32_16x16x32_bf16 v[64:67], v[136:139], a[56:59], v[64:67]
ds_read_b64_tr_b16 a[10:11], v232 offset:18432
s_lshl_b32 s63, s90, 4
v_mfma_f32_16x16x32_bf16 v[68:71], v[136:139], a[60:63], v[68:71]
buffer_load_dwordx4 v236, s[96:99], s63 offen offset:0  lds
v_mfma_f32_16x16x32_bf16 v[68:71], v[140:143], a[52:55], v[68:71]
ds_read_b64_tr_b16 a[12:13], v232 offset:20480
ds_read_b64_tr_b16 a[14:15], v232 offset:22528
v_mfma_f32_16x16x32_bf16 v[68:71], v[128:131], a[44:47], v[68:71]
ds_read_b64_tr_b16 a[0:1], v232 offset:24576
v_mfma_f32_16x16x32_bf16 v[68:71], v[132:135], a[36:39], v[68:71]
ds_read_b64_tr_b16 a[2:3], v232 offset:26624
s_waitcnt lgkmcnt(6)
v_mfma_f32_16x16x32_bf16 v[72:75], v[152:155], a[32:35], v[72:75]
buffer_load_dwordx4 v237, s[96:99], s63 offen offset:1024  lds
v_mfma_f32_16x16x32_bf16 v[72:75], v[156:159], a[40:43], v[72:75]
ds_read_b64_tr_b16 a[4:5], v232 offset:28672
ds_read_b64_tr_b16 a[6:7], v232 offset:30720
v_mfma_f32_16x16x32_bf16 v[72:75], v[144:147], a[48:51], v[72:75]
ds_read_b64_tr_b16 v[136:137], v233 offset:16384
v_mfma_f32_16x16x32_bf16 v[72:75], v[148:151], a[56:59], v[72:75]
ds_read_b64_tr_b16 v[138:139], v233 offset:18432
v_mfma_f32_16x16x32_bf16 v[76:79], v[148:151], a[60:63], v[76:79]
ds_read_b64_tr_b16 v[140:141], v233 offset:20480
v_mfma_f32_16x16x32_bf16 v[76:79], v[144:147], a[52:55], v[76:79]
ds_read_b64_tr_b16 v[142:143], v233 offset:22528
v_mfma_f32_16x16x32_bf16 v[76:79], v[156:159], a[44:47], v[76:79]
ds_read_b64_tr_b16 v[128:129], v233 offset:24576
s_add_u32 m0, s62, 73728
v_mfma_f32_16x16x32_bf16 v[76:79], v[152:155], a[36:39], v[76:79]
ds_read_b64_tr_b16 v[130:131], v233 offset:26624
s_waitcnt lgkmcnt(6)
v_mfma_f32_16x16x32_bf16 v[48:51], a[8:11], a[64:67], v[48:51]
ds_read_b64_tr_b16 v[132:133], v233 offset:28672
s_lshl_b32 s63, s91, 4
v_mfma_f32_16x16x32_bf16 v[48:51], a[12:15], a[72:75], v[48:51]
ds_read_b64_tr_b16 v[134:135], v233 offset:30720
v_mfma_f32_16x16x32_bf16 v[48:51], a[0:3], a[80:83], v[48:51]
buffer_load_dwordx4 v236, s[96:99], s63 offen offset:0  lds
v_mfma_f32_16x16x32_bf16 v[48:51], a[4:7], a[88:91], v[48:51]
ds_read_b64_tr_b16 v[148:149], v234 offset:16384
ds_read_b64_tr_b16 v[150:151], v234 offset:18432
v_mfma_f32_16x16x32_bf16 v[52:55], a[4:7], a[92:95], v[52:55]
ds_read_b64_tr_b16 v[144:145], v234 offset:20480
v_mfma_f32_16x16x32_bf16 v[52:55], a[0:3], a[84:87], v[52:55]
ds_read_b64_tr_b16 v[146:147], v234 offset:22528
v_mfma_f32_16x16x32_bf16 v[52:55], a[12:15], a[76:79], v[52:55]
ds_read_b64_tr_b16 v[156:157], v234 offset:24576
v_mfma_f32_16x16x32_bf16 v[52:55], a[8:11], a[68:71], v[52:55]
ds_read_b64_tr_b16 v[158:159], v234 offset:26624
s_waitcnt lgkmcnt(6)
v_mfma_f32_16x16x32_bf16 v[56:59], v[136:139], a[64:67], v[56:59]
buffer_load_dwordx4 v237, s[96:99], s63 offen offset:1024  lds
v_mfma_f32_16x16x32_bf16 v[56:59], v[140:143], a[72:75], v[56:59]
ds_read_b64_tr_b16 v[152:153], v234 offset:28672
ds_read_b64_tr_b16 v[154:155], v234 offset:30720
v_mfma_f32_16x16x32_bf16 v[56:59], v[128:131], a[80:83], v[56:59]
ds_read_b64_tr_b16 a[4:5], v235 offset:16384
v_mfma_f32_16x16x32_bf16 v[56:59], v[132:135], a[88:91], v[56:59]
ds_read_b64_tr_b16 a[6:7], v235 offset:18432
v_mfma_f32_16x16x32_bf16 v[60:63], v[132:135], a[92:95], v[60:63]
ds_read_b64_tr_b16 a[0:1], v235 offset:20480
v_mfma_f32_16x16x32_bf16 v[60:63], v[128:131], a[84:87], v[60:63]
ds_read_b64_tr_b16 a[2:3], v235 offset:22528
v_mfma_f32_16x16x32_bf16 v[60:63], v[140:143], a[76:79], v[60:63]
ds_read_b64_tr_b16 a[12:13], v235 offset:24576
v_mfma_f32_16x16x32_bf16 v[60:63], v[136:139], a[68:71], v[60:63]
ds_read_b64_tr_b16 a[14:15], v235 offset:26624
s_waitcnt lgkmcnt(6)
v_mfma_f32_16x16x32_bf16 v[64:67], v[148:151], a[64:67], v[64:67]
s_waitcnt vmcnt(9)
s_barrier
v_mfma_f32_16x16x32_bf16 v[64:67], v[144:147], a[72:75], v[64:67]
ds_read_b64_tr_b16 a[8:9], v235 offset:28672
ds_read_b64_tr_b16 a[10:11], v235 offset:30720
v_mfma_f32_16x16x32_bf16 v[64:67], v[156:159], a[80:83], v[64:67]
ds_read_b64_tr_b16 v[132:133], v224 offset:32768
v_mfma_f32_16x16x32_bf16 v[64:67], v[152:155], a[88:91], v[64:67]
ds_read_b64_tr_b16 v[134:135], v224 offset:34816
v_mfma_f32_16x16x32_bf16 v[68:71], v[152:155], a[92:95], v[68:71]
ds_read_b64_tr_b16 v[128:129], v224 offset:36864
v_mfma_f32_16x16x32_bf16 v[68:71], v[156:159], a[84:87], v[68:71]
ds_read_b64_tr_b16 v[130:131], v224 offset:38912
v_mfma_f32_16x16x32_bf16 v[68:71], v[144:147], a[76:79], v[68:71]
ds_read_b64_tr_b16 v[140:141], v224 offset:40960
v_mfma_f32_16x16x32_bf16 v[68:71], v[148:151], a[68:71], v[68:71]
ds_read_b64_tr_b16 v[142:143], v224 offset:43008
s_waitcnt lgkmcnt(6)
v_mfma_f32_16x16x32_bf16 v[72:75], a[4:7], a[64:67], v[72:75]
ds_read_b64_tr_b16 v[136:137], v224 offset:45056
v_mfma_f32_16x16x32_bf16 v[72:75], a[0:3], a[72:75], v[72:75]
ds_read_b64_tr_b16 v[138:139], v224 offset:47104
v_mfma_f32_16x16x32_bf16 v[72:75], a[12:15], a[80:83], v[72:75]
ds_read_b64_tr_b16 v[152:153], v225 offset:32768
v_mfma_f32_16x16x32_bf16 v[72:75], a[8:11], a[88:91], v[72:75]
ds_read_b64_tr_b16 v[154:155], v225 offset:34816
v_mfma_f32_16x16x32_bf16 v[76:79], a[8:11], a[92:95], v[76:79]
ds_read_b64_tr_b16 v[156:157], v225 offset:36864
v_mfma_f32_16x16x32_bf16 v[76:79], a[12:15], a[84:87], v[76:79]
ds_read_b64_tr_b16 v[158:159], v225 offset:38912
v_mfma_f32_16x16x32_bf16 v[76:79], a[0:3], a[76:79], v[76:79]
ds_read_b64_tr_b16 v[144:145], v225 offset:40960
v_mfma_f32_16x16x32_bf16 v[76:79], a[4:7], a[68:71], v[76:79]
ds_read_b64_tr_b16 v[146:147], v225 offset:43008
s_waitcnt lgkmcnt(6)
v_mfma_f32_16x16x32_bf16 v[48:51], v[132:135], a[96:99], v[48:51]
ds_read_b64_tr_b16 v[148:149], v225 offset:45056
v_mfma_f32_16x16x32_bf16 v[48:51], v[128:131], a[104:107], v[48:51]
ds_read_b64_tr_b16 v[150:151], v225 offset:47104
v_mfma_f32_16x16x32_bf16 v[48:51], v[140:143], a[112:115], v[48:51]
buffer_load_dwordx2 v[242:243], v246, s[32:35], s11 offen sc1
v_mfma_f32_16x16x32_bf16 v[48:51], v[136:139], a[120:123], v[48:51]
ds_read_b64_tr_b16 a[8:9], v226 offset:32768
ds_read_b64_tr_b16 a[10:11], v226 offset:34816
v_mfma_f32_16x16x32_bf16 v[52:55], v[136:139], a[124:127], v[52:55]
ds_read_b64_tr_b16 a[12:13], v226 offset:36864
v_mfma_f32_16x16x32_bf16 v[52:55], v[140:143], a[116:119], v[52:55]
ds_read_b64_tr_b16 a[14:15], v226 offset:38912
v_mfma_f32_16x16x32_bf16 v[52:55], v[128:131], a[108:111], v[52:55]
ds_read_b64_tr_b16 a[0:1], v226 offset:40960
v_mfma_f32_16x16x32_bf16 v[52:55], v[132:135], a[100:103], v[52:55]
ds_read_b64_tr_b16 a[2:3], v226 offset:43008
s_waitcnt lgkmcnt(6)
v_mfma_f32_16x16x32_bf16 v[56:59], v[152:155], a[96:99], v[56:59]
ds_read_b64_tr_b16 a[4:5], v226 offset:45056
v_mfma_f32_16x16x32_bf16 v[56:59], v[156:159], a[104:107], v[56:59]
ds_read_b64_tr_b16 a[6:7], v226 offset:47104
v_mfma_f32_16x16x32_bf16 v[56:59], v[144:147], a[112:115], v[56:59]
ds_read_b64_tr_b16 v[136:137], v227 offset:32768
v_mfma_f32_16x16x32_bf16 v[56:59], v[148:151], a[120:123], v[56:59]
ds_read_b64_tr_b16 v[138:139], v227 offset:34816
v_mfma_f32_16x16x32_bf16 v[60:63], v[148:151], a[124:127], v[60:63]
ds_read_b64_tr_b16 v[140:141], v227 offset:36864
v_mfma_f32_16x16x32_bf16 v[60:63], v[144:147], a[116:119], v[60:63]
ds_read_b64_tr_b16 v[142:143], v227 offset:38912
v_mfma_f32_16x16x32_bf16 v[60:63], v[156:159], a[108:111], v[60:63]
ds_read_b64_tr_b16 v[128:129], v227 offset:40960
v_mfma_f32_16x16x32_bf16 v[60:63], v[152:155], a[100:103], v[60:63]
ds_read_b64_tr_b16 v[130:131], v227 offset:43008
s_waitcnt lgkmcnt(6)
v_mfma_f32_16x16x32_bf16 v[64:67], a[8:11], a[96:99], v[64:67]
s_waitcnt vmcnt(5)
s_barrier
v_mfma_f32_16x16x32_bf16 v[64:67], a[12:15], a[104:107], v[64:67]
ds_read_b64_tr_b16 v[132:133], v227 offset:45056
ds_read_b64_tr_b16 v[134:135], v227 offset:47104
v_mfma_f32_16x16x32_bf16 v[64:67], a[0:3], a[112:115], v[64:67]
ds_read_b64_tr_b16 v[148:149], v224 offset:49152
v_mfma_f32_16x16x32_bf16 v[64:67], a[4:7], a[120:123], v[64:67]
ds_read_b64_tr_b16 v[150:151], v224 offset:51200
v_mfma_f32_16x16x32_bf16 v[68:71], a[4:7], a[124:127], v[68:71]
ds_read_b64_tr_b16 v[144:145], v224 offset:53248
v_mfma_f32_16x16x32_bf16 v[68:71], a[0:3], a[116:119], v[68:71]
ds_read_b64_tr_b16 v[146:147], v224 offset:55296
v_mfma_f32_16x16x32_bf16 v[68:71], a[12:15], a[108:111], v[68:71]
ds_read_b64_tr_b16 v[156:157], v224 offset:57344
v_mfma_f32_16x16x32_bf16 v[68:71], a[8:11], a[100:103], v[68:71]
ds_read_b64_tr_b16 v[158:159], v224 offset:59392
s_waitcnt lgkmcnt(6)
v_mfma_f32_16x16x32_bf16 v[72:75], v[136:139], a[96:99], v[72:75]
ds_read_b64_tr_b16 v[152:153], v224 offset:61440
v_mfma_f32_16x16x32_bf16 v[72:75], v[140:143], a[104:107], v[72:75]
ds_read_b64_tr_b16 v[154:155], v224 offset:63488
v_mfma_f32_16x16x32_bf16 v[72:75], v[128:131], a[112:115], v[72:75]
ds_read_b64_tr_b16 a[4:5], v225 offset:49152
v_mfma_f32_16x16x32_bf16 v[72:75], v[132:135], a[120:123], v[72:75]
ds_read_b64_tr_b16 a[6:7], v225 offset:51200
v_mfma_f32_16x16x32_bf16 v[76:79], v[132:135], a[124:127], v[76:79]
ds_read_b64_tr_b16 a[0:1], v225 offset:53248
v_mfma_f32_16x16x32_bf16 v[76:79], v[128:131], a[116:119], v[76:79]
ds_read_b64_tr_b16 a[2:3], v225 offset:55296
v_mfma_f32_16x16x32_bf16 v[76:79], v[140:143], a[108:111], v[76:79]
ds_read_b64_tr_b16 a[12:13], v225 offset:57344
v_mfma_f32_16x16x32_bf16 v[76:79], v[136:139], a[100:103], v[76:79]
ds_read_b64_tr_b16 a[14:15], v225 offset:59392
s_waitcnt lgkmcnt(6)
v_mfma_f32_16x16x32_bf16 v[48:51], v[148:151], a[128:131], v[48:51]
s_waitcnt vmcnt(0)
v_cmp_ne_u64 vcc, s[100:101], v[242:243]
s_nop 1
s_cbranch_vccnz L_fx_slow
L_fx_ok:
v_mfma_f32_16x16x32_bf16 v[48:51], v[144:147], a[136:139], v[48:51]
ds_read_b64_tr_b16 a[8:9], v225 offset:61440
ds_read_b64_tr_b16 a[10:11], v225 offset:63488
v_mfma_f32_16x16x32_bf16 v[48:51], v[156:159], a[144:147], v[48:51]
buffer_load_dwordx4 v[112:115], v198, s[32:35], s13 offen sc1
v_mfma_f32_16x16x32_bf16 v[48:51], v[152:155], a[152:155], v[48:51]
ds_read_b64_tr_b16 v[132:133], v226 offset:49152
ds_read_b64_tr_b16 v[134:135], v226 offset:51200
v_mfma_f32_16x16x32_bf16 v[52:55], v[152:155], a[156:159], v[52:55]
buffer_load_dwordx4 v[116:119], v239, s[32:35], s13 offen sc1
v_mfma_f32_16x16x32_bf16 v[52:55], v[156:159], a[148:151], v[52:55]
ds_read_b64_tr_b16 v[128:129], v226 offset:53248
ds_read_b64_tr_b16 v[130:131], v226 offset:55296
v_mfma_f32_16x16x32_bf16 v[52:55], v[144:147], a[140:143], v[52:55]
ds_read_b64_tr_b16 v[140:141], v226 offset:57344
v_mfma_f32_16x16x32_bf16 v[52:55], v[148:151], a[132:135], v[52:55]
ds_read_b64_tr_b16 v[142:143], v226 offset:59392
s_waitcnt lgkmcnt(6)
v_mfma_f32_16x16x32_bf16 v[56:59], a[4:7], a[128:131], v[56:59]
buffer_load_dwordx4 v[120:123], v248, s[32:35], s13 offen sc1
v_mfma_f32_16x16x32_bf16 v[56:59], a[0:3], a[136:139], v[56:59]
ds_read_b64_tr_b16 v[136:137], v226 offset:61440
ds_read_b64_tr_b16 v[138:139], v226 offset:63488
v_mfma_f32_16x16x32_bf16 v[56:59], a[12:15], a[144:147], v[56:59]
buffer_load_dwordx4 v[124:127], v249, s[32:35], s13 offen sc1
v_mfma_f32_16x16x32_bf16 v[56:59], a[8:11], a[152:155], v[56:59]
ds_read_b64_tr_b16 v[152:153], v227 offset:49152
ds_read_b64_tr_b16 v[154:155], v227 offset:51200
v_mfma_f32_16x16x32_bf16 v[60:63], a[8:11], a[156:159], v[60:63]
ds_read_b64_tr_b16 v[156:157], v227 offset:53248
v_mfma_f32_16x16x32_bf16 v[60:63], a[12:15], a[148:151], v[60:63]
ds_read_b64_tr_b16 v[158:159], v227 offset:55296
v_mfma_f32_16x16x32_bf16 v[60:63], a[0:3], a[140:143], v[60:63]
ds_read_b64_tr_b16 v[144:145], v227 offset:57344
v_mfma_f32_16x16x32_bf16 v[60:63], a[4:7], a[132:135], v[60:63]
ds_read_b64_tr_b16 v[146:147], v227 offset:59392
s_waitcnt lgkmcnt(6)
v_mfma_f32_16x16x32_bf16 v[64:67], v[132:135], a[128:131], v[64:67]
s_waitcnt vmcnt(5)
s_barrier
v_mfma_f32_16x16x32_bf16 v[64:67], v[128:131], a[136:139], v[64:67]
ds_read_b64_tr_b16 v[148:149], v227 offset:61440
ds_read_b64_tr_b16 v[150:151], v227 offset:63488
v_mfma_f32_16x16x32_bf16 v[64:67], v[140:143], a[144:147], v[64:67]
ds_read_b64_tr_b16 a[8:9], v228 offset:0
v_mfma_f32_16x16x32_bf16 v[64:67], v[136:139], a[152:155], v[64:67]
ds_read_b64_tr_b16 a[10:11], v228 offset:2048
v_mfma_f32_16x16x32_bf16 v[68:71], v[136:139], a[156:159], v[68:71]
ds_read_b64_tr_b16 a[12:13], v228 offset:4096
v_mfma_f32_16x16x32_bf16 v[68:71], v[140:143], a[148:151], v[68:71]
ds_read_b64_tr_b16 a[14:15], v228 offset:6144
v_mfma_f32_16x16x32_bf16 v[68:71], v[128:131], a[140:143], v[68:71]
ds_read_b64_tr_b16 a[0:1], v228 offset:8192
v_mfma_f32_16x16x32_bf16 v[68:71], v[132:135], a[132:135], v[68:71]
ds_read_b64_tr_b16 a[2:3], v228 offset:10240
s_waitcnt lgkmcnt(6)
v_mfma_f32_16x16x32_bf16 v[72:75], v[152:155], a[128:131], v[72:75]
ds_read_b64_tr_b16 a[4:5], v228 offset:12288
v_mfma_f32_16x16x32_bf16 v[72:75], v[156:159], a[136:139], v[72:75]
ds_read_b64_tr_b16 a[6:7], v228 offset:14336
v_mfma_f32_16x16x32_bf16 v[72:75], v[144:147], a[144:147], v[72:75]
ds_read_b64_tr_b16 v[136:137], v229 offset:0
v_mfma_f32_16x16x32_bf16 v[72:75], v[148:151], a[152:155], v[72:75]
ds_read_b64_tr_b16 v[138:139], v229 offset:2048
v_mfma_f32_16x16x32_bf16 v[76:79], v[148:151], a[156:159], v[76:79]
ds_read_b64_tr_b16 v[140:141], v229 offset:4096
v_mfma_f32_16x16x32_bf16 v[76:79], v[144:147], a[148:151], v[76:79]
ds_read_b64_tr_b16 v[142:143], v229 offset:6144
v_mfma_f32_16x16x32_bf16 v[76:79], v[156:159], a[140:143], v[76:79]
ds_read_b64_tr_b16 v[128:129], v229 offset:8192
v_mfma_f32_16x16x32_bf16 v[76:79], v[152:155], a[132:135], v[76:79]
ds_read_b64_tr_b16 v[130:131], v229 offset:10240
s_waitcnt lgkmcnt(6)
v_mfma_f32_16x16x32_bf16 v[48:51], a[8:11], a[160:163], v[48:51]
ds_read_b64_tr_b16 v[132:133], v229 offset:12288
v_mfma_f32_16x16x32_bf16 v[48:51], a[12:15], a[168:171], v[48:51]
ds_read_b64_tr_b16 v[134:135], v229 offset:14336
s_waitcnt vmcnt(2)
v_mfma_f32_16x16x32_bf16 v[48:51], a[0:3], a[176:179], v[48:51]
ds_read_b64_tr_b16 v[148:149], v230 offset:0
v_lshlrev_b32 v80, 16, v112
v_mfma_f32_16x16x32_bf16 v[48:51], a[4:7], a[184:187], v[48:51]
ds_read_b64_tr_b16 v[150:151], v230 offset:2048
v_and_b32 v81, 0xffff0000, v112
v_mfma_f32_16x16x32_bf16 v[52:55], a[4:7], a[188:191], v[52:55]
ds_read_b64_tr_b16 v[144:145], v230 offset:4096
v_lshlrev_b32 v82, 16, v113
v_mfma_f32_16x16x32_bf16 v[52:55], a[0:3], a[180:183], v[52:55]
ds_read_b64_tr_b16 v[146:147], v230 offset:6144
v_and_b32 v83, 0xffff0000, v113
v_mfma_f32_16x16x32_bf16 v[52:55], a[12:15], a[172:175], v[52:55]
ds_read_b64_tr_b16 v[156:157], v230 offset:8192
v_lshlrev_b32 v88, 16, v116
v_mfma_f32_16x16x32_bf16 v[52:55], a[8:11], a[164:167], v[52:55]
v_and_b32 v89, 0xffff0000, v116
v_lshlrev_b32 v90, 16, v117
s_waitcnt lgkmcnt(5)
v_mfma_f32_16x16x32_bf16 v[56:59], v[136:139], a[160:163], v[56:59]
ds_read_b64_tr_b16 v[158:159], v230 offset:10240
v_and_b32 v91, 0xffff0000, v117
v_mfma_f32_16x16x32_bf16 v[56:59], v[140:143], a[168:171], v[56:59]
ds_read_b64_tr_b16 v[152:153], v230 offset:12288
ds_read_b64_tr_b16 v[154:155], v230 offset:14336
s_waitcnt vmcnt(2)
v_lshlrev_b32 v84, 16, v114
v_mfma_f32_16x16x32_bf16 v[56:59], v[128:131], a[176:179], v[56:59]
ds_read_b64_tr_b16 a[4:5], v231 offset:0
v_and_b32 v85, 0xffff0000, v114
v_mfma_f32_16x16x32_bf16 v[56:59], v[132:135], a[184:187], v[56:59]
v_lshlrev_b32 v86, 16, v115
v_and_b32 v87, 0xffff0000, v115
v_mfma_f32_16x16x32_bf16 v[60:63], v[132:135], a[188:191], v[60:63]
ds_read_b64_tr_b16 a[6:7], v231 offset:2048
v_lshlrev_b32 v92, 16, v118
v_mfma_f32_16x16x32_bf16 v[60:63], v[128:131], a[180:183], v[60:63]
v_and_b32 v93, 0xffff0000, v118
v_lshlrev_b32 v94, 16, v119
v_mfma_f32_16x16x32_bf16 v[60:63], v[140:143], a[172:175], v[60:63]
ds_read_b64_tr_b16 a[0:1], v231 offset:4096
v_and_b32 v95, 0xffff0000, v119
v_mfma_f32_16x16x32_bf16 v[60:63], v[136:139], a[164:167], v[60:63]
s_waitcnt vmcnt(0)
v_lshlrev_b32 v96, 16, v120
s_waitcnt lgkmcnt(3)
v_mfma_f32_16x16x32_bf16 v[64:67], v[148:151], a[160:163], v[64:67]
ds_read_b64_tr_b16 a[2:3], v231 offset:6144
v_and_b32 v97, 0xffff0000, v120
v_mfma_f32_16x16x32_bf16 v[64:67], v[144:147], a[168:171], v[64:67]
ds_read_b64_tr_b16 a[12:13], v231 offset:8192
ds_read_b64_tr_b16 a[14:15], v231 offset:10240
ds_read_b64_tr_b16 a[8:9], v231 offset:12288
ds_read_b64_tr_b16 a[10:11], v231 offset:14336
v_lshlrev_b32 v98, 16, v121
v_and_b32 v99, 0xffff0000, v121
v_mfma_f32_16x16x32_bf16 v[64:67], v[156:159], a[176:179], v[64:67]
v_lshlrev_b32 v104, 16, v124
v_and_b32 v105, 0xffff0000, v124
v_mfma_f32_16x16x32_bf16 v[64:67], v[152:155], a[184:187], v[64:67]
v_lshlrev_b32 v106, 16, v125
v_and_b32 v107, 0xffff0000, v125
v_mfma_f32_16x16x32_bf16 v[68:71], v[152:155], a[188:191], v[68:71]
s_waitcnt vmcnt(0)
v_lshlrev_b32 v100, 16, v122
v_mfma_f32_16x16x32_bf16 v[68:71], v[156:159], a[180:183], v[68:71]
v_and_b32 v101, 0xffff0000, v122
v_lshlrev_b32 v102, 16, v123
v_mfma_f32_16x16x32_bf16 v[68:71], v[144:147], a[172:175], v[68:71]
v_and_b32 v103, 0xffff0000, v123
v_lshlrev_b32 v108, 16, v126
v_mfma_f32_16x16x32_bf16 v[68:71], v[148:151], a[164:167], v[68:71]
v_and_b32 v109, 0xffff0000, v126
s_waitcnt lgkmcnt(0)
v_mfma_f32_16x16x32_bf16 v[72:75], a[4:7], a[160:163], v[72:75]
v_lshlrev_b32 v110, 16, v127
v_and_b32 v111, 0xffff0000, v127
v_mfma_f32_16x16x32_bf16 v[72:75], a[0:3], a[168:171], v[72:75]
v_mfma_f32_16x16x32_bf16 v[72:75], a[12:15], a[176:179], v[72:75]
v_mfma_f32_16x16x32_bf16 v[72:75], a[8:11], a[184:187], v[72:75]
v_add_f32 v48, v48, v80
v_add_f32 v49, v49, v81
v_add_f32 v50, v50, v82
v_add_f32 v51, v51, v83
v_mfma_f32_16x16x32_bf16 v[76:79], a[8:11], a[188:191], v[76:79]
v_cvt_pk_bf16_f32 v208, v48, v49
v_cvt_pk_bf16_f32 v209, v50, v51
v_add_f32 v56, v56, v88
v_add_f32 v57, v57, v89
v_add_f32 v58, v58, v90
v_mfma_f32_16x16x32_bf16 v[76:79], a[12:15], a[180:183], v[76:79]
v_add_f32 v59, v59, v91
v_cvt_pk_bf16_f32 v210, v56, v57
v_cvt_pk_bf16_f32 v211, v58, v59
s_nop 1
v_permlane16_swap_b32 v208, v210
v_permlane16_swap_b32 v209, v211
v_mfma_f32_16x16x32_bf16 v[76:79], a[0:3], a[172:175], v[76:79]
buffer_store_dwordx4 v[208:211], v238, s[28:31], 0 offen offset:0 sc1
v_add_f32 v52, v52, v84
v_add_f32 v53, v53, v85
v_add_f32 v54, v54, v86
v_add_f32 v55, v55, v87
v_cvt_pk_bf16_f32 v216, v52, v53
v_cvt_pk_bf16_f32 v217, v54, v55
v_add_f32 v60, v60, v92
v_add_f32 v61, v61, v93
v_add_f32 v62, v62, v94
v_mfma_f32_16x16x32_bf16 v[76:79], a[4:7], a[164:167], v[76:79]
v_add_f32 v63, v63, v95
v_cvt_pk_bf16_f32 v218, v60, v61
v_cvt_pk_bf16_f32 v219, v62, v63
s_nop 1
v_permlane16_swap_b32 v216, v218
v_permlane16_swap_b32 v217, v219
buffer_store_dwordx4 v[216:219], v238, s[28:31], s57 offen offset:0 sc1
s_nop 6
v_pk_add_f32 v[64:65], v[64:65], v[96:97]
v_pk_add_f32 v[66:67], v[66:67], v[98:99]
v_cvt_pk_bf16_f32 v212, v64, v65
v_cvt_pk_bf16_f32 v213, v66, v67
v_pk_add_f32 v[72:73], v[72:73], v[104:105]
v_pk_add_f32 v[74:75], v[74:75], v[106:107]
v_cvt_pk_bf16_f32 v214, v72, v73
v_cvt_pk_bf16_f32 v215, v74, v75
s_nop 1
v_permlane16_swap_b32 v212, v214
v_permlane16_swap_b32 v213, v215
buffer_store_dwordx4 v[212:215], v238, s[28:31], 0 offen offset:64 sc1
v_pk_add_f32 v[68:69], v[68:69], v[100:101]
v_pk_add_f32 v[70:71], v[70:71], v[102:103]
v_cvt_pk_bf16_f32 v220, v68, v69
v_cvt_pk_bf16_f32 v221, v70, v71
v_pk_add_f32 v[76:77], v[76:77], v[108:109]
v_pk_add_f32 v[78:79], v[78:79], v[110:111]
v_cvt_pk_bf16_f32 v222, v76, v77
v_cvt_pk_bf16_f32 v223, v78, v79
s_nop 1
v_permlane16_swap_b32 v220, v222
v_permlane16_swap_b32 v221, v223
buffer_store_dwordx4 v[220:223], v238, s[28:31], s57 offen offset:64 sc1
L_end:
s_endpgm
L_f1_slow:
s_mov_b32 s46, 2000000
L_f1_spin:
buffer_load_dwordx2 v[242:243], v199, s[32:35], s8 offen sc1
s_waitcnt vmcnt(0)
s_sub_u32 s46, s46, 1
s_cmp_eq_u32 s46, 0
s_cbranch_scc1 L_f1_ok
v_cmp_ne_u64 vcc, s[54:55], v[242:243]
s_nop 1
s_cbranch_vccnz L_f1_spin
s_branch L_f1_ok
L_f2_slow:
s_mov_b32 s46, 2000000
L_f2_spin:
buffer_load_dwordx2 v[242:243], v199, s[32:35], s9 offen sc1
s_waitcnt vmcnt(0)
s_sub_u32 s46, s46, 1
s_cmp_eq_u32 s46, 0
s_cbranch_scc1 L_f2_ok
v_cmp_ne_u64 vcc, s[54:55], v[242:243]
s_nop 1
s_cbranch_vccnz L_f2_spin
s_branch L_f2_ok
L_mk0:
s_memrealtime s[46:47]
s_waitcnt lgkmcnt(0)
s_or_b32 s46, s46, 1
v_mov_b32 v240, s46
v_mov_b32 v241, s47
buffer_store_dwordx2 v[240:241], v247, s[4:7], 0 offen sc1
s_branch L_mk_done
L_n_slow:
s_mov_b32 s46, 2000000
L_n_spin:
buffer_load_dwordx2 v[240:241], v246, s[4:7], 0 offen sc1
s_waitcnt vmcnt(0)
v_readfirstlane_b32 s100, v240
s_sub_u32 s46, s46, 1
s_cmp_eq_u32 s46, 0
s_cbranch_scc1 L_n_ok
s_cmp_eq_u32 s100, 0
s_cbranch_scc1 L_n_spin
s_branch L_n_ok
L_t0:
buffer_load_dword v2, v245, s[92:95], 0 offen
s_branch L_t0_ok
L_t1:
buffer_load_dword v2, v245, s[92:95], 0 offen
s_branch L_t1_ok
L_t2:
buffer_load_dword v2, v245, s[92:95], 0 offen
s_branch L_t2_ok
L_t3:
buffer_load_dword v2, v245, s[92:95], 0 offen
s_branch L_t3_ok
L_t4:
buffer_load_dword v2, v245, s[92:95], 0 offen
s_branch L_t4_ok
L_t5:
buffer_load_dword v2, v245, s[92:95], 0 offen
s_branch L_t5_ok
L_fx_slow:
s_mov_b32 s46, 2000000
L_fx_spin:
buffer_load_dwordx2 v[242:243], v246, s[32:35], s11 offen sc1
s_waitcnt vmcnt(0)
s_sub_u32 s46, s46, 1
s_cmp_eq_u32 s46, 0
s_cbranch_scc1 L_fx_ok
v_cmp_ne_u64 vcc, s[100:101], v[242:243]
s_nop 1
s_cbranch_vccnz L_fx_spin
s_branch L_fx_ok
.section .rodata,"a"
.p2align 6
.amdhsa_kernel standalone__dense_activation_silu__prompt_kernel
  .amdhsa_next_free_vgpr 512
  .amdhsa_next_free_sgpr 102
  .amdhsa_accum_offset 256
  .amdhsa_group_segment_fixed_size 0
  .amdhsa_kernarg_size 48
  .amdhsa_user_sgpr_count 2
  .amdhsa_user_sgpr_kernarg_segment_ptr 1
  .amdhsa_system_sgpr_workgroup_id_x 1
  .amdhsa_float_denorm_mode_32 3
.end_amdhsa_kernel
```
